```python
import torch

def _softmax(x, axis=-1):
    return torch.softmax(x, dim=axis)
def _gelu(x):
    return torch.nn.functional.gelu(x, approximate="tanh")
def _silu(x):
    return torch.nn.functional.silu(x)
def _sigmoid(x):
    return torch.sigmoid(x)
def _layernorm(x, axis=-1, eps=1e-5):
    m = x.mean(dim=axis, keepdim=True)
    v = x.var(dim=axis, keepdim=True, unbiased=False)
    return (x - m) / torch.sqrt(v + eps)
def _scatter_add(tgt, idx, src, axis=0):
    return tgt.clone().index_add_(axis, idx, src)
def _segment_sum(src, seg, n):
    out = torch.zeros((n,) + src.shape[1:], dtype=src.dtype)
    return out.index_add_(0, seg, src)
def _pad(x, pw):
    flat = tuple(v for pair in reversed(pw) for v in pair)
    return torch.nn.functional.pad(x, flat)

kernel_name = 'standalone__mpnn_edge_mlp__graph'

def setup_inputs():

    _w = (lambda a: (lambda t: t.to(torch.bfloat16) if t.is_floating_point() else t)(torch.as_tensor(a)))
    N, deg, D, De = 10000, 32, 128, max(4, 1)
    E = N * deg
    return {
        "x": _w((lambda *s: torch.randn(*s, dtype=torch.bfloat16) * 0.05)(N, D)),
        "e_attr": _w((lambda *s: torch.randn(*s, dtype=torch.bfloat16) * 0.4)(E, De)),
        "src": _w((lambda lo, hi, *s: torch.randint(lo, hi, s))(0, N, E).to(torch.int64)),
        "dst": _w((lambda lo, hi, *s: torch.randint(lo, hi, s))(0, N, E).to(torch.int64)),
        "w_msg": _w((lambda *s: torch.randn(*s, dtype=torch.bfloat16) * 0.4)(2 * D + De, D)),
        "w_upd": _w((lambda *s: torch.randn(*s, dtype=torch.bfloat16) * 0.05)(2 * D, D)),
    }

def reference(x, e_attr, src, dst, w_msg, w_upd):
    N, D = x.shape
    m_in = torch.concatenate([x[src], x[dst], e_attr], axis=-1)
    msg = _silu(m_in @ w_msg)
    agg = _segment_sum(msg, dst, N)
    return _silu(torch.concatenate([x, agg], axis=-1) @ w_upd)
```

```asm
; @launch grid=(256,1,1) block=(1024,1,1) lds=163648
.amdgcn_target "amdgcn-amd-amdhsa--gfx950"
.text
.globl standalone__mpnn_edge_mlp__graph_kernel
.p2align 8
.type standalone__mpnn_edge_mlp__graph_kernel,@function
standalone__mpnn_edge_mlp__graph_kernel:
    s_cmp_ge_u32 s2, 256
    s_cbranch_scc1 K2_END
    s_load_dwordx2 s[20:21], s[0:1], 24
    s_load_dwordx2 s[36:37], s[0:1], 16
    s_load_dwordx4 s[40:43], s[0:1], 32
    s_load_dwordx2 s[16:17], s[0:1], 64
    s_load_dwordx2 s[4:5], s[0:1], 0
    s_load_dwordx2 s[56:57], s[0:1], 8
    s_load_dwordx2 s[24:25], s[0:1], 48
    s_getpc_b64 s[50:51]
K1_PC0:
    v_cmp_gt_u32 vcc, 64, v0
    v_lshlrev_b32 v4, 7, v0
    s_sub_u32 s50, s50, K1_PC0-standalone__mpnn_edge_mlp__graph_kernel
    s_subb_u32 s51, s51, 0
    s_cbranch_vccz K1_PC1
    v_mov_b32 v5, s51
    v_add_co_u32 v4, vcc, s50, v4
    v_addc_co_u32 v5, vcc, 0, v5, vcc
    global_load_dword v123, v[4:5], off
K1_PC1:
    v_lshrrev_b32 v3, 6, v0
    v_and_b32 v1, 63, v0
    v_lshlrev_b32 v66, 4, v0
    v_readfirstlane_b32 s32, v3
    s_mov_b32 s66, 0
    s_cmp_lt_u32 s32, 10
    s_cbranch_scc1 K1_P
K1_HELP:
    s_mov_b32 s68, 2
    v_add_u32 v3, -10240, v66
    v_mov_b64 v[8:9], 0
    v_mov_b64 v[10:11], 0
    ds_write_b128 v3, v[8:11] offset:0
    ds_write_b128 v3, v[8:11] offset:6144
    ds_write_b128 v3, v[8:11] offset:12288
    ds_write_b128 v3, v[8:11] offset:18432
    ds_write_b128 v3, v[8:11] offset:24576
    s_cmp_ge_u32 s32, 12
    s_cbranch_scc1 K1_H0
    ds_write_b128 v3, v[8:11] offset:30720
K1_H0:
    s_cmp_lg_u32 s32, 15
    s_cbranch_scc1 K1_HP
    s_getpc_b64 s[50:51]
K1_PC:
    s_lshr_b32 s3, s2, 3
    s_lshl_b32 s3, s3, 11
    s_add_u32 s3, s3, 8192
    v_lshl_add_u32 v4, v1, 7, s3
    s_sub_u32 s50, s50, K1_PC-standalone__mpnn_edge_mlp__graph_kernel
    s_subb_u32 s51, s51, 0
    v_cmp_gt_u32 vcc, K2_GLOOP-standalone__mpnn_edge_mlp__graph_kernel, v4
    s_and_b64 vcc, vcc, 0xffff
    s_cbranch_scc0 K1_HP
    v_mov_b32 v5, s51
    s_mov_b64 s[54:55], vcc
    v_add_co_u32 v4, vcc, s50, v4
    v_addc_co_u32 v5, vcc, 0, v5, vcc
    s_mov_b64 exec, s[54:55]
    global_load_dword v119, v[4:5], off
    s_mov_b64 exec, -1
K1_HP:
    s_waitcnt lgkmcnt(0)
    s_barrier
    s_barrier
    s_branch K2_INIT
K1_GEMM:
    s_mov_b32 s68, 1
    s_sub_u32 s3, s2, 125
    v_mov_b32 v60, 0
    v_lshrrev_b32 v2, 4, v1
    v_and_b32 v3, 15, v1
    v_lshlrev_b32 v4, 1, v2
    v_xor_b32 v4, v4, v3
    v_lshlrev_b32 v4, 4, v4
    v_lshl_add_u32 v4, v2, 8, v4
    s_cmp_eq_u32 s3, 127
    s_cselect_b32 s28, 32768, 0
    s_waitcnt lgkmcnt(0)
    s_cmp_lg_u32 s32, 0
    s_cbranch_scc1 K1_ELg
    global_load_dwordx2 v[56:57], v60, s[16:17]
K1_ELg:
    s_cmp_eq_u32 s3, 125
    s_cbranch_scc1 K1_G1
    s_cmp_ge_u32 s3, 128
    s_cbranch_scc1 K1_G1
    s_cmp_ge_u32 s3, 126
    s_cselect_b32 s40, s42, s40
    s_cselect_b32 s41, s43, s41
    s_mov_b32 s42, 65536
    s_mov_b32 s43, 0x00020000
    s_add_u32 s50, s32, 0
    s_lshl_b32 s51, s50, 6
    s_and_b32 s51, s51, 128
    v_xor_b32 v5, s51, v4
    s_lshl_b32 s50, s50, 10
    s_add_u32 m0, s50, 83968
    s_add_u32 s50, s50, s28
    buffer_load_dwordx4 v5, s[40:43], s50 offen lds
    s_add_u32 s50, s32, 10
    s_lshl_b32 s51, s50, 6
    s_and_b32 s51, s51, 128
    v_xor_b32 v6, s51, v4
    s_lshl_b32 s50, s50, 10
    s_add_u32 m0, s50, 83968
    s_add_u32 s50, s50, s28
    buffer_load_dwordx4 v6, s[40:43], s50 offen lds
    s_add_u32 s50, s32, 20
    s_lshl_b32 s51, s50, 6
    s_and_b32 s51, s51, 128
    v_xor_b32 v7, s51, v4
    s_lshl_b32 s50, s50, 10
    s_add_u32 m0, s50, 83968
    s_add_u32 s50, s50, s28
    buffer_load_dwordx4 v7, s[40:43], s50 offen lds
    s_cmp_ge_u32 s32, 2
    s_cbranch_scc1 K1_G1
    s_add_u32 s50, s32, 30
    s_lshl_b32 s51, s50, 6
    s_and_b32 s51, s51, 128
    v_xor_b32 v8, s51, v4
    s_lshl_b32 s50, s50, 10
    s_add_u32 m0, s50, 83968
    s_add_u32 s50, s50, s28
    buffer_load_dwordx4 v8, s[40:43], s50 offen lds
K1_G1:
    s_mov_b32 s6, 2560000
    s_mov_b32 s7, 0x00020000
    s_and_b32 s64, s3, 7
    s_min_u32 s65, s64, 5
    s_mul_i32 s64, s64, 15
    s_add_u32 s64, s64, s65
    s_lshr_b32 s28, s3, 3
    s_add_u32 s28, s28, s64
    s_mul_i32 s28, s28, 20480
    v_xor_b32 v9, v2, v3
    v_lshlrev_b32 v9, 4, v9
    v_lshl_add_u32 v9, v2, 8, v9
    s_lshl_b32 s51, s32, 7
    s_and_b32 s51, s51, 128
    v_xor_b32 v10, s51, v9
    v_xor_b32 v11, 64, v10
    s_lshl_b32 s50, s32, 11
    s_add_u32 m0, s50, 32768
    s_add_u32 s50, s50, s28
    s_cmp_ge_u32 s3, 125
    s_barrier
    s_cbranch_scc1 K2_INIT
    buffer_load_dwordx4 v10, s[4:7], s50 offen  lds
    buffer_load_dwordx4 v11, s[4:7], s50 offen offset:1024  lds
    s_branch K2_INIT
K1_P:
    s_setprio 3
    s_cmp_ge_u32 s2, 125
    s_cbranch_scc1 K1_GEMM
    s_mov_b32 s68, 0
    s_and_b32 s64, s2, 7
    s_min_u32 s65, s64, 5
    s_mul_i32 s64, s64, 15
    s_add_u32 s64, s64, s65
    s_lshr_b32 s28, s2, 3
    s_add_u32 s28, s28, s64
    s_mov_b32 s55, 83968
    s_mul_i32 s3, s28, 10240
    v_lshl_add_u32 v2, v0, 2, s55
    v_mov_b32 v3, 3
    v_mov_b64 v[60:61], 0
    ds_write_b32 v2, v3
    s_mov_b32 s22, 1280000
    s_mov_b32 s23, 0x00020000
    s_mov_b32 s38, 1280000
    s_mov_b32 s39, 0x00020000
    s_waitcnt lgkmcnt(0)
    s_cmp_lg_u32 s32, 0
    s_cbranch_scc1 K1_ELs
    global_load_dwordx2 v[56:57], v60, s[16:17]
K1_ELs:
    buffer_load_dwordx4 v[2:5], v66, s[20:23], s3 offen
    buffer_load_dwordx4 v[6:9], v66, s[36:39], s3 offen
    v_add_u32 v51, s55, v66
    v_mov_b64 v[62:63], 0
    ds_write_b128 v51, v[60:63] offset:2560
    s_cmp_ge_u32 s32, 3
    s_cbranch_scc1 K2_INIT
    ds_write_b128 v51, v[60:63] offset:12800
K2_INIT:
    s_and_b32 s45, s2, 7
    s_lshl_b32 s45, s45, 5
    s_lshr_b32 s46, s2, 3
    s_or_b32 s48, s45, s46
    s_lshr_b32 s45, s48, 2
    s_lshl_b32 s45, s45, 4
    s_and_b32 s46, s48, 1
    s_lshl3_add_u32 s45, s46, s45
    s_and_b32 s46, s48, 2
    s_lshl_b32 s46, s46, 9
    s_add_u32 s29, s45, s46
    s_add_u32 s29, s29, 7340032
    s_mov_b32 s12, s16
    s_mov_b32 s13, s17
    s_mov_b32 s14, 7602176
    s_mov_b32 s15, 0x00020000
    s_mov_b32 s62, 1
    s_mov_b64 s[60:61], 0x3f80
    s_mov_b32 s18, 33554432
    s_mov_b32 s19, 0x00020000
    v_lshrrev_b32 v108, 4, v1
    v_and_b32 v109, 15, v1
    s_mul_i32 s33, s48, 625
    s_add_u32 s34, s33, 625
    s_lshr_b32 s33, s33, 4
    s_lshr_b32 s34, s34, 4
    s_sub_u32 s34, s34, s33
    s_mov_b32 s52, 0
    s_mov_b32 s49, 0
    s_mov_b32 s54, 0
    v_and_b32 v111, 12, v1
    v_xor_b32 v124, v108, v109
    v_lshlrev_b32 v124, 4, v124
    v_lshl_add_u32 v124, v109, 8, v124
    v_add_u32 v124, 73728, v124
    v_xor_b32 v125, 64, v124
    v_xor_b32 v126, 128, v124
    v_xor_b32 v127, 192, v124
    s_and_b32 s53, s32, 7
    s_lshl_b32 s53, s53, 12
    s_add_u32 s53, s53, 7864320
    v_lshlrev_b32 v108, 2, v108
    s_cmp_eq_u32 s68, 2
    s_cbranch_scc1 K1_HELP2
    s_cmp_eq_u32 s68, 1
    s_cbranch_scc1 K1_GEMM2
    s_cmp_eq_u32 s68, 3
    s_cbranch_scc1 K2_RC
    s_mov_b32 s58, 2560000
    s_mov_b32 s59, 0x00020000
    s_mul_i32 s50, s28, 2048
    s_mul_i32 s51, s28, 13312
    s_lshl_b32 s63, s3, 1
    s_mov_b32 s28, 6871948
    v_mov_b32 v48, 1
    v_lshl_add_u32 v49, v1, 4, s55
    v_lshlrev_b32 v50, 5, v0
    v_lshlrev_b32 v52, 4, v1
    s_movk_i32 s46, 256
    s_add_u32 s50, s50, 7340032
    v_mov_b32 v53, 288
    v_mov_b32 v58, 272
    v_mov_b32 v59, 1
    s_lshl_b32 s45, s51, 1
    s_add_u32 s51, s51, 9437184
    s_add_u32 s45, s45, 11534336
    s_lshl_b32 s47, s32, 10
    v_add_u32 v47, s47, v66
    s_mov_b32 s4, 0x9e37b5a7
    s_mov_b32 s5, 0x85ebca6b
    s_mov_b32 s6, 0xc2b3ae35
    s_mov_b32 s7, 0x27d5eb2f
    s_mov_b32 s12, 0x165767b1
    s_mov_b32 s13, 0xd3a3646d
    s_mov_b32 s14, 0xfd7146c5
    s_mov_b32 s15, 0xb55b4f09
    s_barrier
    s_waitcnt vmcnt(1)
    v_lshl_add_u32 v43, v2, 4, 15
    v_mul_hi_u32_u24 v18, s28, v43
    v_lshl_add_u32 v30, v18, 2, s55
    ds_add_rtn_u32 v22, v30, v48
    v_lshl_add_u32 v43, v3, 4, 15
    v_mul_hi_u32_u24 v19, s28, v43
    v_lshl_add_u32 v31, v19, 2, s55
    ds_add_rtn_u32 v23, v31, v48
    v_lshl_add_u32 v43, v4, 4, 15
    v_mul_hi_u32_u24 v20, s28, v43
    v_lshl_add_u32 v32, v20, 2, s55
    ds_add_rtn_u32 v24, v32, v48
    v_lshl_add_u32 v43, v5, 4, 15
    v_mul_hi_u32_u24 v21, s28, v43
    v_lshl_add_u32 v33, v21, 2, s55
    ds_add_rtn_u32 v25, v33, v48
    s_cmp_lg_u32 s32, 0
    s_cbranch_scc1 K1_S0
    v_add_co_u32 v56, vcc, 0x7F4A7C15, v56
    v_mov_b32 v54, 0x9E3779B9
    v_addc_co_u32 v57, vcc, v54, v57, vcc
    v_mov_b32 v54, 1
    s_mov_b64 exec, 1
    ds_write_b128 v53, v[54:57]
    s_mov_b64 exec, -1
K1_S0:
    v_mul_u32_u24 v43, 625, v18
    v_lshrrev_b32 v43, 4, v43
    v_sub_u32 v26, v2, v43
    v_lshl_add_u32 v26, v26, 2, s46
    v_mul_u32_u24 v43, 625, v19
    v_lshrrev_b32 v43, 4, v43
    v_sub_u32 v27, v3, v43
    v_lshl_add_u32 v27, v27, 2, s46
    v_mul_u32_u24 v43, 625, v20
    v_lshrrev_b32 v43, 4, v43
    v_sub_u32 v28, v4, v43
    v_lshl_add_u32 v28, v28, 2, s46
    v_mul_u32_u24 v43, 625, v21
    v_lshrrev_b32 v43, 4, v43
    v_sub_u32 v29, v5, v43
    v_lshl_add_u32 v29, v29, 2, s46
    s_waitcnt lgkmcnt(0)
    s_barrier
    ds_read_b128 v[34:37], v49
    ds_read_b64 v[56:57], v53 offset:8
    s_waitcnt vmcnt(0)
    buffer_load_dwordx4 v[10:13], v50, s[56:59], s63 offen
    buffer_load_dwordx4 v[14:17], v50, s[56:59], s63 offen offset:16
    v_lshl_add_u32 v26, v6, 8, v26
    v_lshl_add_u32 v27, v7, 8, v27
    v_lshl_add_u32 v28, v8, 8, v28
    v_lshl_add_u32 v29, v9, 8, v29
    s_waitcnt lgkmcnt(1)
    v_and_b32 v18, -4, v34
    v_and_b32 v19, -4, v35
    v_and_b32 v20, -4, v36
    v_and_b32 v21, -4, v37
    v_add_u32 v40, v18, v19
    v_add_u32 v41, v40, v20
    v_add_u32 v38, v41, v21
    s_waitcnt lgkmcnt(0)
    v_readfirstlane_b32 s70, v56
    v_add_u32 v42, 3, v38
    v_add_u32_dpp v38, v38, v38 row_shr:1 row_mask:0xf bank_mask:0xf bound_ctrl:0
    v_readfirstlane_b32 s71, v57
    s_mov_b32 s46, 0xffc00003
    v_add_u32_dpp v38, v38, v38 row_shr:2 row_mask:0xf bank_mask:0xf bound_ctrl:0
    s_nop 1
    v_add_u32_dpp v38, v38, v38 row_shr:4 row_mask:0xf bank_mask:0xf bound_ctrl:0
    s_and_b32 s64, s71, 0xffc00003
    s_lshl_b32 s65, s71, 12
    v_add_u32_dpp v38, v38, v38 row_shr:8 row_mask:0xf bank_mask:0xf bound_ctrl:0
    s_bfe_u32 s67, s71, 0x20014
    s_and_b32 s65, s65, 0xc00003
    s_or_b32 s65, s65, s67
    v_add_u32_dpp v38, v38, v38 row_bcast:15 row_mask:0xa bank_mask:0xf
    s_add_u32 s47, s45, 20480
    s_and_b32 s28, s71, 0xf000f000
    v_add_u32_dpp v38, v38, v38 row_bcast:31 row_mask:0xc bank_mask:0xf
    v_sub_u32 v42, v38, v42
    v_readlane_b32 s3, v38, 63
    v_add_u32 v43, v42, v18
    v_add_u32 v44, v42, v40
    v_add_u32 v45, v42, v41
    ds_write_b128 v49, v[42:45] offset:1024
    s_lshl_b32 s3, s3, 2
    s_cmp_lg_u32 s32, 0
    s_cbranch_scc1 K1_S1
    s_add_u32 s28, s28, 0xfffd0003
    v_lshl_add_u32 v80, v34, 16, v42
    v_mov_b32 v81, v56
    v_add_u32 v80, s28, v80
    v_lshl_add_u32 v82, v35, 16, v43
    v_mov_b32 v83, v56
    v_add_u32 v82, s28, v82
    v_lshl_add_u32 v84, v36, 16, v44
    v_mov_b32 v85, v56
    v_add_u32 v84, s28, v84
    v_lshl_add_u32 v86, v37, 16, v45
    v_mov_b32 v87, v56
    v_add_u32 v86, s28, v86
    buffer_store_dwordx4 v[80:83], v52, s[16:19], s50 offen sc0 sc1
    buffer_store_dwordx4 v[84:87], v52, s[16:19], s50 offen offset:1024 sc0 sc1
K1_S1:
    s_sub_u32 s3, s3, 10240
    s_waitcnt lgkmcnt(0)
    ds_read_b32 v38, v30 offset:1024
    ds_read_b32 v39, v31 offset:1024
    ds_read_b32 v40, v32 offset:1024
    ds_read_b32 v41, v33 offset:1024
    v_cmp_gt_u32 s[20:21], s3, v66
    s_lshl_b32 s3, s3, 1
    v_cmp_gt_u32 s[22:23], s3, v47
    s_sub_u32 s3, s3, 1024
    v_cmp_gt_i32 s[36:37], s3, v47
    s_waitcnt lgkmcnt(3)
    v_add_u32 v38, v38, v22
    v_lshl_add_u32 v43, v38, 2, s55
    v_lshlrev_b32 v38, 3, v38
    ds_write_b32 v43, v26 offset:2560
    s_waitcnt lgkmcnt(3)
    v_add_u32 v39, v39, v23
    v_lshl_add_u32 v43, v39, 2, s55
    v_lshlrev_b32 v39, 3, v39
    ds_write_b32 v43, v27 offset:2560
    s_waitcnt lgkmcnt(3)
    v_add_u32 v40, v40, v24
    v_lshl_add_u32 v43, v40, 2, s55
    v_lshlrev_b32 v40, 3, v40
    ds_write_b32 v43, v28 offset:2560
    s_waitcnt lgkmcnt(3)
    v_add_u32 v41, v41, v25
    v_lshl_add_u32 v43, v41, 2, s55
    v_lshlrev_b32 v41, 3, v41
    ds_write_b32 v43, v29 offset:2560
    s_cmp_eq_u32 s32, 0
    s_waitcnt vmcnt(2)
    s_cbranch_scc1 K1_S3
    s_waitcnt vmcnt(0)
K1_S3:
    ds_write_b64 v38, v[10:11] offset:32768
    ds_write_b64 v39, v[12:13] offset:32768
    ds_write_b64 v40, v[14:15] offset:32768
    ds_write_b64 v41, v[16:17] offset:32768
    s_mov_b64 exec, 1
    ds_add_u32 v58, v59
    s_mov_b64 exec, -1
    s_setprio 0
K1_Ys:
    ds_read_b32 v59, v58
    s_waitcnt lgkmcnt(0)
    v_cmp_gt_u32 vcc, 10, v59
    s_cbranch_vccnz K1_Ys
    s_setprio 3
    ds_read_b128 v[2:5], v50 offset:32768
    ds_read_b128 v[6:9], v50 offset:32784
    ds_read_b128 v[80:83], v51 offset:2560
    ds_read_b128 v[84:87], v47 offset:32768
    ds_read_b128 v[88:91], v47 offset:33792
    s_cmp_eq_u64 s[20:21], 0
    s_cbranch_scc0 K1_S5
    s_waitcnt lgkmcnt(3)
K1_S6:
    v_dot2_u32_u16 v18, v2, s4, v56
    v_dot2_u32_u16 v18, v3, s5, v18
    v_dot2_u32_u16 v18, v4, s6, v18
    v_dot2_u32_u16 v18, v5, s7, v18
    v_dot2_u32_u16 v18, v6, s12, v18
    v_dot2_u32_u16 v18, v7, s13, v18
    v_dot2_u32_u16 v18, v8, s14, v18
    v_dot2_u32_u16 v18, v9, s15, v18
    v_alignbit_b32 v19, v18, v18, 20
    v_lshrrev_b32 v20, 2, v18
    s_waitcnt lgkmcnt(2)
    v_or_b32 v80, s64, v80
    v_or_b32 v81, s65, v81
    v_and_or_b32 v82, v18, s46, v82
    v_and_or_b32 v83, v19, s46, v83
    v_lshl_or_b32 v81, v20, 24, v81
    buffer_store_dwordx4 v[80:83], v66, s[16:19], s51 offen sc0 sc1
    s_setprio 0
    s_mov_b32 s50, s45
    s_waitcnt lgkmcnt(0)
    v_mov_b32 v26, 268
    v_mov_b32 v27, 1
    s_mov_b64 exec, 1
    ds_add_u32 v26, v27
    s_mov_b64 exec, -1
    s_mov_b64 s[20:21], s[36:37]
    buffer_store_dwordx4 v[84:87], v47, s[16:19], s50 offen sc0 sc1
    buffer_store_dwordx4 v[88:91], v47, s[16:19], s50 offen offset:1024 sc0 sc1
    s_mov_b64 exec, s[22:23]
    s_cbranch_execz K1_S7
    buffer_store_dwordx4 v[10:13], v47, s[16:19], s47 offen sc0 sc1
    s_mov_b64 exec, s[20:21]
    s_cbranch_execz K1_S7
    buffer_store_dwordx4 v[14:17], v47, s[16:19], s47 offen offset:1024 sc0 sc1
K1_S7:
    s_mov_b64 exec, -1
    s_mov_b32 s8, s16
    s_or_b32 s9, s17, 0x1000000
    s_mov_b32 s10, 10032
    s_mov_b32 s11, 0x00020000
    s_lshl_b32 s35, s32, 12
    s_add_u32 s35, s35, 83968
    s_mov_b32 m0, s35
    s_mov_b32 s39, 0
    s_mov_b32 s42, 0x0f0f0f0f
    s_mov_b32 s43, 0xf0f0f0f0
    v_xor_b32 v79, v108, v109
    v_lshlrev_b32 v79, 4, v79
    v_add_u32 v73, 3072, v79
    v_add_u32 v75, 2048, v79
    v_add_u32 v77, 1024, v79
    v_xor_b32 v77, 128, v77
    v_xor_b32 v79, 128, v79
    s_mov_b32 s44, 328
    s_mov_b32 s63, 0x4e800000
    v_and_b32 v102, 3, v0
    v_lshlrev_b32 v103, 3, v108
    v_lshl_add_u32 v103, v102, 3, v103
    v_and_b32 v106, 8, v111
    v_mul_u32_u24 v106, 40, v106
    v_xor_b32 v103, v103, v106
    v_and_b32 v106, 4, v111
    v_mul_u32_u24 v106, 544, v106
    v_xor_b32 v103, v103, v106
    v_add_u32 v96, s35, v103
    v_xor_b32 v97, 128, v96
    v_add_u32 v103, v108, v102
    v_mov_b32 v101, 149504
    v_lshl_add_u32 v101, v103, 3, v101
    v_lshlrev_b32 v102, 4, v102
    v_lshlrev_b64 v[62:63], v102, s[60:61]
    v_lshrrev_b32 v103, 2, v1
    v_and_b32 v103, 6, v103
    v_bfe_u32 v102, v1, 1, 1
    v_or_b32 v103, v103, v102
    v_lshlrev_b32 v110, 4, v103
    v_add_u32 v110, 8192, v110
    s_and_b32 s45, s32, 3
    s_lshr_b32 s46, s32, 2
    s_lshl2_add_u32 s45, s45, 3
    s_sub_u32 s59, s45, s46
    v_mov_b64 v[58:59], 0
    v_mov_b64 v[60:61], 0
    v_and_b32 v103, 7, v1
    v_lshlrev_b32 v105, v103, 1
    s_mov_b32 s26, 2560000
    s_mov_b32 s27, 0x00020000
    s_lshl_b32 s45, s32, 4
    v_lshlrev_b32 v67, 2, v1
    v_xor_b32 v67, s45, v67
    s_lshl_b32 s45, s32, 8
    s_add_u32 s45, s45, 83968
    v_add_u32 v67, s45, v67
    v_mul_u32_u24 v68, 272, v109
    v_lshl_add_u32 v68, v108, 1, v68
    s_lshl_b32 s45, s32, 5
    s_lshr_b32 s46, s32, 3
    s_mul_i32 s46, s46, 8448
    s_add_u32 s45, s45, s46
    s_add_u32 s45, s45, 100352
    v_add_u32 v68, s45, v68
    v_lshrrev_b32 v69, 4, v0
    v_mul_u32_u24 v69, 272, v69
    v_lshl_add_u32 v69, v109, 4, v69
    v_add_u32 v69, 100352, v69
    s_branch K1_Q
K1_S5:
    ds_read_b128 v[22:25], v50 offset:53248
    ds_read_b128 v[26:29], v50 offset:53264
    ds_read_b128 v[92:95], v51 offset:12800
    ds_read_b128 v[10:13], v47 offset:53248
    ds_read_b128 v[14:17], v47 offset:54272
    s_add_u32 s50, s51, 10240
    s_mov_b64 exec, s[20:21]
    s_waitcnt lgkmcnt(2)
    v_dot2_u32_u16 v18, v22, s4, v56
    v_dot2_u32_u16 v18, v23, s5, v18
    v_dot2_u32_u16 v18, v24, s6, v18
    v_dot2_u32_u16 v18, v25, s7, v18
    v_dot2_u32_u16 v18, v26, s12, v18
    v_dot2_u32_u16 v18, v27, s13, v18
    v_dot2_u32_u16 v18, v28, s14, v18
    v_dot2_u32_u16 v18, v29, s15, v18
    v_alignbit_b32 v19, v18, v18, 20
    v_lshrrev_b32 v20, 2, v18
    v_or_b32 v92, s64, v92
    v_or_b32 v93, s65, v93
    v_and_or_b32 v94, v18, s46, v94
    v_and_or_b32 v95, v19, s46, v95
    v_lshl_or_b32 v93, v20, 24, v93
    buffer_store_dwordx4 v[92:95], v66, s[16:19], s50 offen sc0 sc1
    s_mov_b64 exec, -1
    s_branch K1_S6
K1_GEMM2:
    s_cmp_ge_u32 s3, 125
    s_cbranch_scc1 K1_TR
    s_lshl_b32 s55, s32, 7
    s_and_b32 s55, s55, 128
    s_lshr_b32 s50, s32, 1
    s_lshl_b32 s50, s50, 12
    s_add_u32 s28, s28, s50
    s_add_u32 s50, s50, -40960
    v_add_u32 v103, s50, v124
    v_add_u32 v104, s50, v125
    v_add_u32 v106, s50, v126
    v_add_u32 v107, s50, v127
    s_and_b32 s50, s32, 14
    s_lshl_b32 s51, 1, s50
    v_mov_b32 v116, 284
    v_mov_b32 v117, s51
    s_lshl_b32 s51, s51, 1
    v_and_b32 v98, 3, v0
    v_lshlrev_b32 v102, 9, v108
    v_lshl_add_u32 v102, v98, 3, v102
    v_mul_u32_u24 v98, 72, v111
    v_add_u32 v102, v102, v98
    v_and_b32 v98, 4, v108
    v_lshl_add_u32 v102, v98, 5, v102
    v_add_u32 v102, 83968, v102
    v_xor_b32 v98, s55, v102
    v_xor_b32 v99, 32, v98
    v_xor_b32 v100, 64, v98
    v_xor_b32 v102, 96, v98
    v_and_b32 v76, 7, v109
    v_lshlrev_b32 v76, 8, v76
    v_lshrrev_b32 v78, 3, v109
    v_lshl_add_u32 v76, v78, 6, v76
    v_and_b32 v78, 4, v108
    v_lshl_add_u32 v76, v78, 3, v76
    v_and_b32 v78, 8, v108
    v_lshl_add_u32 v76, v78, 1, v76
    s_add_u32 s28, s28, s55
    s_add_u32 s28, s28, 3328
    s_mov_b32 s46, 0xbfb8aa3b
    s_mov_b32 s47, 0xbfb8aa3b
    s_waitcnt vmcnt(2)
    s_cmp_lg_u32 s32, 0
    s_cbranch_scc1 K1_G2
    v_add_co_u32 v56, vcc, 0x7F4A7C15, v56
    v_mov_b32 v54, 0x9E3779B9
    v_addc_co_u32 v57, vcc, v54, v57, vcc
    v_mov_b32 v58, 288
    v_mov_b32 v54, 1
    s_mov_b64 exec, 1
    ds_write_b128 v58, v[54:57]
    s_mov_b64 exec, -1
K1_G2:
    s_barrier
    ds_read_b64_tr_b16 v[2:3], v98 offset:0
    ds_read_b64_tr_b16 v[4:5], v98 offset:1024
    ds_read_b64_tr_b16 v[6:7], v99 offset:0
    ds_read_b64_tr_b16 v[8:9], v99 offset:1024
    ds_read_b64_tr_b16 v[10:11], v100 offset:0
    ds_read_b64_tr_b16 v[12:13], v100 offset:1024
    ds_read_b64_tr_b16 v[14:15], v102 offset:0
    ds_read_b64_tr_b16 v[16:17], v102 offset:1024
    ds_read_b64_tr_b16 v[18:19], v98 offset:8192
    ds_read_b64_tr_b16 v[20:21], v98 offset:9216
    ds_read_b64_tr_b16 v[22:23], v99 offset:8192
    ds_read_b64_tr_b16 v[24:25], v99 offset:9216
    ds_read_b64_tr_b16 v[26:27], v100 offset:8192
    ds_read_b64_tr_b16 v[28:29], v100 offset:9216
    ds_read_b64_tr_b16 v[30:31], v102 offset:8192
    ds_read_b64_tr_b16 v[32:33], v102 offset:9216
    ds_read_b64_tr_b16 v[34:35], v98 offset:16384
    ds_read_b64_tr_b16 v[36:37], v98 offset:17408
    ds_read_b64_tr_b16 v[38:39], v99 offset:16384
    ds_read_b64_tr_b16 v[40:41], v99 offset:17408
    ds_read_b64_tr_b16 v[42:43], v100 offset:16384
    ds_read_b64_tr_b16 v[44:45], v100 offset:17408
    ds_read_b64_tr_b16 v[46:47], v102 offset:16384
    ds_read_b64_tr_b16 v[48:49], v102 offset:17408
    ds_read_b64_tr_b16 v[50:51], v98 offset:24576
    ds_read_b64_tr_b16 v[52:53], v98 offset:25600
    ds_read_b64_tr_b16 v[54:55], v99 offset:24576
    ds_read_b64_tr_b16 v[56:57], v99 offset:25600
    ds_read_b64_tr_b16 v[58:59], v100 offset:24576
    ds_read_b64_tr_b16 v[60:61], v100 offset:25600
    ds_read_b64_tr_b16 v[62:63], v102 offset:24576
    ds_read_b64_tr_b16 v[64:65], v102 offset:25600
    s_mov_b64 exec, 1
    s_waitcnt vmcnt(0)
    ds_add_rtn_u32 v118, v116, v117
    s_waitcnt lgkmcnt(0)
    v_add_u32 v118, v118, v117
K1_GP:
    v_and_b32 v118, s51, v118
    v_cmp_eq_u32 vcc, 0, v118
    s_cbranch_vccz K1_GPX
    ds_read_b32 v118, v116
    s_waitcnt lgkmcnt(0)
    s_branch K1_GP
K1_GPX:
    s_mov_b64 exec, -1
    ds_read_b128 v[80:83], v103
    ds_read_b128 v[84:87], v104
    ds_read_b128 v[88:91], v106
    ds_read_b128 v[92:95], v107
    s_waitcnt lgkmcnt(3)
    v_mfma_f32_16x16x32_bf16 v[68:71], v[2:5], v[80:83], 0
    v_mfma_f32_16x16x32_bf16 v[72:75], v[6:9], v[80:83], 0
    v_mfma_f32_16x16x32_bf16 v[112:115], v[10:13], v[80:83], 0
    v_mfma_f32_16x16x32_bf16 v[120:123], v[14:17], v[80:83], 0
    s_waitcnt lgkmcnt(2)
    v_mfma_f32_16x16x32_bf16 v[68:71], v[18:21], v[84:87], v[68:71]
    v_mfma_f32_16x16x32_bf16 v[72:75], v[22:25], v[84:87], v[72:75]
    v_mfma_f32_16x16x32_bf16 v[112:115], v[26:29], v[84:87], v[112:115]
    v_mfma_f32_16x16x32_bf16 v[120:123], v[30:33], v[84:87], v[120:123]
    s_waitcnt lgkmcnt(1)
    v_mfma_f32_16x16x32_bf16 v[68:71], v[34:37], v[88:91], v[68:71]
    v_mfma_f32_16x16x32_bf16 v[72:75], v[38:41], v[88:91], v[72:75]
    v_mfma_f32_16x16x32_bf16 v[112:115], v[42:45], v[88:91], v[112:115]
    v_mfma_f32_16x16x32_bf16 v[120:123], v[46:49], v[88:91], v[120:123]
    s_waitcnt lgkmcnt(0)
    v_mfma_f32_16x16x32_bf16 v[68:71], v[50:53], v[92:95], v[68:71]
    v_mfma_f32_16x16x32_bf16 v[72:75], v[54:57], v[92:95], v[72:75]
    v_mfma_f32_16x16x32_bf16 v[112:115], v[58:61], v[92:95], v[112:115]
    v_mfma_f32_16x16x32_bf16 v[120:123], v[62:65], v[92:95], v[120:123]
    v_mov_b32 v116, 272
    v_mov_b32 v117, 1
    s_mov_b64 exec, 1
    ds_add_u32 v116, v117
    s_mov_b64 exec, -1
    s_nop 2
    v_pk_mul_f32 v[68:69], v[68:69], s[46:47]
    v_pk_mul_f32 v[70:71], v[70:71], s[46:47]
    v_cvt_pk_bf16_f32 v18, v68, v69
    v_cvt_pk_bf16_f32 v19, v70, v71
    v_pk_mul_f32 v[72:73], v[72:73], s[46:47]
    v_pk_mul_f32 v[74:75], v[74:75], s[46:47]
    v_cvt_pk_bf16_f32 v20, v72, v73
    v_cvt_pk_bf16_f32 v21, v74, v75
    v_pk_mul_f32 v[112:113], v[112:113], s[46:47]
    v_pk_mul_f32 v[114:115], v[114:115], s[46:47]
    v_cvt_pk_bf16_f32 v22, v112, v113
    v_cvt_pk_bf16_f32 v23, v114, v115
    v_pk_mul_f32 v[120:121], v[120:121], s[46:47]
    v_pk_mul_f32 v[122:123], v[122:123], s[46:47]
    v_cvt_pk_bf16_f32 v24, v120, v121
    v_cvt_pk_bf16_f32 v25, v122, v123
    s_nop 1
    v_permlane16_swap_b32 v18, v20
    v_permlane16_swap_b32 v19, v21
    v_permlane16_swap_b32 v22, v24
    v_permlane16_swap_b32 v23, v25
    s_nop 1
    v_mov_b32 v26, v22
    v_mov_b32 v27, v23
    v_mov_b32 v28, v24
    v_mov_b32 v29, v25
    v_mov_b32_dpp v22, v18 row_ror:8 row_mask:0xf bank_mask:0x3
    v_mov_b32_dpp v23, v19 row_ror:8 row_mask:0xf bank_mask:0x3
    v_mov_b32_dpp v24, v20 row_ror:8 row_mask:0xf bank_mask:0x3
    v_mov_b32_dpp v25, v21 row_ror:8 row_mask:0xf bank_mask:0x3
    v_mov_b32_dpp v18, v26 row_ror:8 row_mask:0xf bank_mask:0xc
    v_mov_b32_dpp v19, v27 row_ror:8 row_mask:0xf bank_mask:0xc
    v_mov_b32_dpp v20, v28 row_ror:8 row_mask:0xf bank_mask:0xc
    v_mov_b32_dpp v21, v29 row_ror:8 row_mask:0xf bank_mask:0xc
    buffer_store_dwordx4 v[22:25], v76, s[16:19], s28 offen offset:2048 sc0 sc1
    buffer_store_dwordx4 v[18:21], v76, s[16:19], s28 offen sc0 sc1
K1_TAIL:
    v_mov_b32 v32, 268
    v_mov_b32 v33, 1
    s_mov_b64 exec, 1
    ds_add_u32 v32, v33
    s_mov_b64 exec, -1
    v_mov_b32 v34, 288
K1_Tg:
    ds_read_b128 v[36:39], v34
    s_waitcnt lgkmcnt(0)
    v_cmp_eq_u32 vcc, 0, v36
    v_readfirstlane_b32 s70, v38
    v_readfirstlane_b32 s71, v39
    s_cbranch_vccnz K1_Tg
    s_lshl_b32 s50, s3, 3
    s_add_u32 s50, s50, 7995392
    v_mul_u32_u24 v29, 2048, v1
    v_mov_b32 v30, s70
    v_mov_b32 v31, s71
    s_setprio 0
    s_mov_b32 s8, s16
    s_or_b32 s9, s17, 0x1000000
    s_mov_b32 s10, 10032
    s_mov_b32 s11, 0x00020000
    s_lshl_b32 s35, s32, 12
    s_add_u32 s35, s35, 83968
    s_mov_b32 m0, s35
    s_mov_b32 s39, 0
    s_mov_b32 s42, 0x0f0f0f0f
    s_mov_b32 s43, 0xf0f0f0f0
    v_xor_b32 v79, v108, v109
    v_lshlrev_b32 v79, 4, v79
    v_add_u32 v73, 3072, v79
    v_add_u32 v75, 2048, v79
    v_add_u32 v77, 1024, v79
    v_xor_b32 v77, 128, v77
    v_xor_b32 v79, 128, v79
    s_setprio 3
    v_mov_b32 v32, 280
    v_mov_b32 v33, 1
    s_mov_b64 exec, 1
    s_waitcnt vmcnt(0)
    ds_add_rtn_u32 v33, v32, v33
    s_waitcnt lgkmcnt(0)
    v_cmp_eq_u32 vcc, 9, v33
    s_mov_b64 exec, -1
    s_cbranch_vccz K1_GQ
    s_mov_b64 exec, 0xff
    buffer_store_dwordx2 v[30:31], v29, s[16:19], s50 offen sc0 sc1
    s_mov_b64 exec, -1
K1_GQ:
    s_setprio 0
    s_mov_b32 s44, 328
    s_mov_b32 s63, 0x4e800000
    v_and_b32 v102, 3, v0
    v_lshlrev_b32 v103, 3, v108
    v_lshl_add_u32 v103, v102, 3, v103
    v_and_b32 v106, 8, v111
    v_mul_u32_u24 v106, 40, v106
    v_xor_b32 v103, v103, v106
    v_and_b32 v106, 4, v111
    v_mul_u32_u24 v106, 544, v106
    v_xor_b32 v103, v103, v106
    v_add_u32 v96, s35, v103
    v_xor_b32 v97, 128, v96
    v_add_u32 v103, v108, v102
    v_mov_b32 v101, 149504
    v_lshl_add_u32 v101, v103, 3, v101
    v_lshlrev_b32 v102, 4, v102
    v_lshlrev_b64 v[62:63], v102, s[60:61]
    v_lshrrev_b32 v103, 2, v1
    v_and_b32 v103, 6, v103
    v_bfe_u32 v102, v1, 1, 1
    v_or_b32 v103, v103, v102
    v_lshlrev_b32 v110, 4, v103
    v_add_u32 v110, 8192, v110
    s_and_b32 s45, s32, 3
    s_lshr_b32 s46, s32, 2
    s_lshl2_add_u32 s45, s45, 3
    s_sub_u32 s59, s45, s46
    v_mov_b64 v[58:59], 0
    v_mov_b64 v[60:61], 0
    v_and_b32 v103, 7, v1
    v_lshlrev_b32 v105, v103, 1
    s_mov_b32 s26, 2560000
    s_mov_b32 s27, 0x00020000
    s_lshl_b32 s45, s32, 4
    v_lshlrev_b32 v67, 2, v1
    v_xor_b32 v67, s45, v67
    s_lshl_b32 s45, s32, 8
    s_add_u32 s45, s45, 83968
    v_add_u32 v67, s45, v67
    v_mul_u32_u24 v68, 272, v109
    v_lshl_add_u32 v68, v108, 1, v68
    s_lshl_b32 s45, s32, 5
    s_lshr_b32 s46, s32, 3
    s_mul_i32 s46, s46, 8448
    s_add_u32 s45, s45, s46
    s_add_u32 s45, s45, 100352
    v_add_u32 v68, s45, v68
    v_lshrrev_b32 v69, 4, v0
    v_mul_u32_u24 v69, 272, v69
    v_lshl_add_u32 v69, v109, 4, v69
    v_add_u32 v69, 100352, v69
    s_branch K1_Q
K1_TR:
    v_lshlrev_b32 v76, 4, v1
    s_waitcnt vmcnt(0)
    s_cmp_lg_u32 s32, 0
    s_cbranch_scc1 K1_G3
    v_add_co_u32 v56, vcc, 0x7F4A7C15, v56
    v_mov_b32 v54, 0x9E3779B9
    v_addc_co_u32 v57, vcc, v54, v57, vcc
    v_mov_b32 v58, 288
    v_mov_b32 v54, 1
    s_mov_b64 exec, 1
    ds_write_b128 v58, v[54:57]
    s_mov_b64 exec, -1
K1_G3:
    s_cmp_eq_u32 s3, 125
    s_cbranch_scc1 K1_ZR
    s_cmp_ge_u32 s3, 128
    s_cbranch_scc1 K1_ET
    s_lshl_b32 s55, s32, 5
    v_and_b32 v98, 3, v0
    v_lshlrev_b32 v102, 9, v108
    v_lshl_add_u32 v102, v98, 3, v102
    v_mul_u32_u24 v98, 72, v111
    v_add_u32 v102, v102, v98
    v_and_b32 v98, 4, v108
    v_lshl_add_u32 v102, v98, 5, v102
    v_add_u32 v102, 83968, v102
    v_xor_b32 v98, s55, v102
    v_xor_b32 v99, 32, v98
    v_xor_b32 v100, 64, v98
    v_xor_b32 v102, 96, v98
    s_barrier
    s_cmp_ge_u32 s32, 8
    s_cbranch_scc1 K1_N1
    ds_read_b64_tr_b16 v[2:3], v98 offset:0
    ds_read_b64_tr_b16 v[4:5], v98 offset:1024
    ds_read_b64_tr_b16 v[6:7], v98 offset:8192
    ds_read_b64_tr_b16 v[8:9], v98 offset:9216
    ds_read_b64_tr_b16 v[10:11], v98 offset:16384
    ds_read_b64_tr_b16 v[12:13], v98 offset:17408
    ds_read_b64_tr_b16 v[14:15], v98 offset:24576
    ds_read_b64_tr_b16 v[16:17], v98 offset:25600
    s_sub_u32 s50, s3, 125
    s_lshl_b32 s50, s50, 15
    s_add_u32 s50, s50, s53
    s_waitcnt lgkmcnt(0)
    buffer_store_dwordx4 v[2:5], v76, s[16:19], s50 offen offset:0 sc0 sc1
    buffer_store_dwordx4 v[6:9], v76, s[16:19], s50 offen offset:1024 sc0 sc1
    buffer_store_dwordx4 v[10:13], v76, s[16:19], s50 offen offset:2048 sc0 sc1
    buffer_store_dwordx4 v[14:17], v76, s[16:19], s50 offen offset:3072 sc0 sc1
    s_branch K1_N1
K1_ET:
    s_barrier
    s_cmp_lg_u32 s32, 0
    s_cbranch_scc1 K1_N1
    v_mov_b32 v6, 288
K1_Te:
    ds_read_b128 v[8:11], v6
    s_waitcnt lgkmcnt(0)
    v_cmp_eq_u32 vcc, 0, v8
    v_readfirstlane_b32 s70, v10
    v_readfirstlane_b32 s71, v11
    s_cbranch_vccnz K1_Te
    s_and_b32 s67, s71, 0xf000f000
    s_mul_i32 s50, s3, 2048
    s_add_u32 s50, s50, 7333888
    v_mov_b32 v2, s67
    v_mov_b32 v3, s70
    v_mov_b32 v4, s67
    v_mov_b32 v5, s70
    buffer_store_dwordx4 v[2:5], v76, s[16:19], s50 offen sc0 sc1
    buffer_store_dwordx4 v[2:5], v76, s[16:19], s50 offen offset:1024 sc0 sc1
    s_branch K1_N1
K1_ZR:
    s_cmp_lg_u32 s32, 8
    s_cbranch_scc1 K1_N0
    v_mov_b64 v[2:3], 0
    v_mov_b64 v[4:5], 0
    s_mov_b64 exec, 0xffff
    buffer_store_dwordx4 v[2:5], v76, s[16:19], 0 offen offset:3072 sc0 sc1
    s_mov_b64 exec, -1
K1_N0:
    s_barrier
K1_N1:
    s_sleep 48
    v_mov_b32 v116, 272
    v_mov_b32 v117, 1
    s_mov_b64 exec, 1
    ds_add_u32 v116, v117
    s_mov_b64 exec, -1
    s_waitcnt lgkmcnt(0)
    s_branch K1_TAIL
K1_HELP2:
    s_mov_b32 s6, 2560000
    s_mov_b32 s7, 0x00020000
    s_mov_b32 s42, 66560
    s_mov_b32 s43, 0x00020000
    v_lshrrev_b32 v2, 2, v108
    v_lshlrev_b32 v4, 1, v2
    v_xor_b32 v4, v4, v109
    v_lshlrev_b32 v4, 4, v4
    v_lshl_add_u32 v4, v2, 8, v4
    v_and_b32 v65, 0xf0, v124
    v_lshl_add_u32 v65, v108, 6, v65
    s_lshl_b32 s28, s33, 8
    s_sub_u32 s3, s32, 14
    s_cbranch_scc1 K1_H3
    v_lshlrev_b32 v5, 1, v1
    s_lshl_b32 s51, s3, 6
    v_xor_b32 v7, s51, v65
    v_xor_b32 v8, 128, v7
    v_xor_b32 v9, 128, v4
    s_lshl_b32 s50, s3, 10
    s_add_u32 s51, s50, s28
    s_add_u32 m0, s50, 73728
    buffer_load_dwordx4 v7, s[4:7], s51 offen  lds
    s_add_u32 m0, s50, 75776
    s_add_u32 s51, s51, 2048
    buffer_load_dwordx4 v8, s[4:7], s51 offen  lds
    s_add_u32 m0, s50, 77824
    s_add_u32 s51, s51, 2048
    buffer_load_dwordx4 v7, s[4:7], s51 offen  lds
    s_add_u32 m0, s50, 79872
    s_add_u32 s51, s51, 2048
    buffer_load_dwordx4 v8, s[4:7], s51 offen  lds
    s_add_u32 m0, s50, 81920
    s_add_u32 s51, s51, 2048
    buffer_load_dwordx4 v7, s[4:7], s51 offen  lds
    s_add_u32 m0, s50, 116736
    s_add_u32 s51, s50, 32768
    buffer_load_dwordx4 v4, s[40:43], s51 offen lds
    s_add_u32 m0, s50, 118784
    s_add_u32 s51, s50, 34816
    buffer_load_dwordx4 v9, s[40:43], s51 offen lds
    s_add_u32 m0, s50, 120832
    s_add_u32 s51, s50, 36864
    buffer_load_dwordx4 v4, s[40:43], s51 offen lds
    s_add_u32 m0, s50, 122880
    s_add_u32 s51, s50, 38912
    buffer_load_dwordx4 v9, s[40:43], s51 offen lds
    s_add_u32 m0, s50, 124928
    s_add_u32 s51, s50, 40960
    buffer_load_dwordx4 v4, s[40:43], s51 offen lds
    s_add_u32 m0, s50, 126976
    s_add_u32 s51, s50, 43008
    buffer_load_dwordx4 v9, s[40:43], s51 offen lds
    s_add_u32 m0, s50, 129024
    s_add_u32 s51, s50, 45056
    buffer_load_dwordx4 v4, s[40:43], s51 offen lds
    s_add_u32 m0, s50, 131072
    s_add_u32 s51, s50, 47104
    buffer_load_dwordx4 v9, s[40:43], s51 offen lds
    s_add_u32 m0, s50, 133120
    s_add_u32 s51, s50, 49152
    buffer_load_dwordx4 v4, s[40:43], s51 offen lds
    s_add_u32 m0, s50, 135168
    s_add_u32 s51, s50, 51200
    buffer_load_dwordx4 v9, s[40:43], s51 offen lds
    s_add_u32 m0, s50, 137216
    s_add_u32 s51, s50, 53248
    buffer_load_dwordx4 v4, s[40:43], s51 offen lds
    s_add_u32 m0, s50, 139264
    s_add_u32 s51, s50, 55296
    buffer_load_dwordx4 v9, s[40:43], s51 offen lds
    s_add_u32 m0, s50, 141312
    s_add_u32 s51, s50, 57344
    buffer_load_dwordx4 v4, s[40:43], s51 offen lds
    s_add_u32 m0, s50, 143360
    s_add_u32 s51, s50, 59392
    buffer_load_dwordx4 v9, s[40:43], s51 offen lds
    s_add_u32 m0, s50, 145408
    s_add_u32 s51, s50, 61440
    buffer_load_dwordx4 v4, s[40:43], s51 offen lds
    s_add_u32 m0, s50, 147456
    s_add_u32 s51, s50, 63488
    buffer_load_dwordx4 v9, s[40:43], s51 offen lds
    s_cmp_lg_u32 s3, 1
    s_cbranch_scc1 K1_H3
    s_mov_b32 s50, 65536
    buffer_load_ushort v16, v5, s[40:43], s50 offen offset:0
    buffer_load_ushort v17, v5, s[40:43], s50 offen offset:256
    buffer_load_ushort v18, v5, s[40:43], s50 offen offset:512
    buffer_load_ushort v19, v5, s[40:43], s50 offen offset:768
    buffer_load_ushort v20, v5, s[40:43], s50 offen offset:128
    buffer_load_ushort v21, v5, s[40:43], s50 offen offset:384
    buffer_load_ushort v22, v5, s[40:43], s50 offen offset:640
    buffer_load_ushort v23, v5, s[40:43], s50 offen offset:896
K1_H3:
    v_mov_b32 v2, 288
K1_Th:
    ds_read_b128 v[4:7], v2
    s_waitcnt lgkmcnt(0)
    v_cmp_eq_u32 vcc, 0, v4
    v_readfirstlane_b32 s70, v6
    v_readfirstlane_b32 s71, v7
    s_cbranch_vccnz K1_Th
    s_mov_b32 s8, s16
    s_or_b32 s9, s17, 0x1000000
    s_mov_b32 s10, 10032
    s_mov_b32 s11, 0x00020000
    s_lshl_b32 s35, s32, 12
    s_add_u32 s35, s35, 83968
    s_mov_b32 m0, s35
    s_mov_b32 s39, 0
    s_mov_b32 s42, 0x0f0f0f0f
    s_mov_b32 s43, 0xf0f0f0f0
    v_xor_b32 v79, v108, v109
    v_lshlrev_b32 v79, 4, v79
    v_add_u32 v73, 3072, v79
    v_add_u32 v75, 2048, v79
    v_add_u32 v77, 1024, v79
    v_xor_b32 v77, 128, v77
    v_xor_b32 v79, 128, v79
    s_mov_b32 s44, 328
    s_mov_b32 s63, 0x4e800000
    v_and_b32 v102, 3, v0
    v_lshlrev_b32 v103, 3, v108
    v_lshl_add_u32 v103, v102, 3, v103
    v_and_b32 v106, 8, v111
    v_mul_u32_u24 v106, 40, v106
    v_xor_b32 v103, v103, v106
    v_and_b32 v106, 4, v111
    v_mul_u32_u24 v106, 544, v106
    v_xor_b32 v103, v103, v106
    v_add_u32 v96, s35, v103
    v_xor_b32 v97, 128, v96
    v_add_u32 v103, v108, v102
    v_mov_b32 v101, 149504
    v_lshl_add_u32 v101, v103, 3, v101
    v_lshlrev_b32 v102, 4, v102
    v_lshlrev_b64 v[62:63], v102, s[60:61]
    v_lshrrev_b32 v103, 2, v1
    v_and_b32 v103, 6, v103
    v_bfe_u32 v102, v1, 1, 1
    v_or_b32 v103, v103, v102
    v_lshlrev_b32 v110, 4, v103
    v_add_u32 v110, 8192, v110
    s_and_b32 s45, s32, 3
    s_lshr_b32 s46, s32, 2
    s_lshl2_add_u32 s45, s45, 3
    s_sub_u32 s59, s45, s46
    v_mov_b64 v[58:59], 0
    v_mov_b64 v[60:61], 0
    v_and_b32 v103, 7, v1
    v_lshlrev_b32 v105, v103, 1
    s_mov_b32 s26, 2560000
    s_mov_b32 s27, 0x00020000
    s_lshl_b32 s45, s32, 4
    v_lshlrev_b32 v67, 2, v1
    v_xor_b32 v67, s45, v67
    s_lshl_b32 s45, s32, 8
    s_add_u32 s45, s45, 83968
    v_add_u32 v67, s45, v67
    v_mul_u32_u24 v68, 272, v109
    v_lshl_add_u32 v68, v108, 1, v68
    s_lshl_b32 s45, s32, 5
    s_lshr_b32 s46, s32, 3
    s_mul_i32 s46, s46, 8448
    s_add_u32 s45, s45, s46
    s_add_u32 s45, s45, 100352
    v_add_u32 v68, s45, v68
    v_lshrrev_b32 v69, 4, v0
    v_mul_u32_u24 v69, 272, v69
    v_lshl_add_u32 v69, v109, 4, v69
    v_add_u32 v69, 100352, v69
    s_and_b32 s45, s2, 7
    s_mul_i32 s45, s45, 2048
    s_add_u32 s45, s45, 7995392
    v_lshl_add_u32 v38, v1, 4, s45
    s_mov_b32 s46, 0xEA543210
    s_mov_b32 s47, 0xFBD9C876
    s_lshl_b32 s45, s32, 2
    s_lshr_b64 s[46:47], s[46:47], s45
    s_and_b32 s3, s46, 15
    s_mov_b32 s4, 0x9e37b5a7
    s_mov_b32 s5, 0x85ebca6b
    s_mov_b32 s6, 0xc2b3ae35
    s_mov_b32 s7, 0x27d5eb2f
    s_mov_b32 s20, 0x165767b1
    s_mov_b32 s21, 0xd3a3646d
    s_mov_b32 s22, 0xfd7146c5
    s_mov_b32 s23, 0xb55b4f09
    s_mov_b32 s28, 1
    s_and_b32 s64, s71, 0xffc00003
    s_lshl_b32 s65, s71, 12
    s_bfe_u32 s67, s71, 0x20014
    s_and_b32 s65, s65, 0xc00003
    s_or_b32 s65, s65, s67
    v_mov_b32 v40, s70
    v_mov_b32 v71, 0
    v_mov_b32 v30, 0
    v_mov_b32 v33, 0
    s_bfm_b64 exec, s34, 0
    v_mov_b32 v71, 28
    s_mov_b64 exec, -1
    v_mov_b32 v39, 4
    v_lshlrev_b32 v113, 2, v1
    v_and_b32 v44, 4, v111
    v_and_b32 v45, 8, v111
    v_add_u32 v44, 512, v44
    v_lshrrev_b32 v46, 3, v1
    v_add_u32 v46, 320, v46
    v_and_b32 v47, 1, v1
    v_lshlrev_b32 v48, 3, v1
    v_add_u32 v48, 31744, v48
    v_lshlrev_b32 v49, 4, v1
    v_add_u32 v49, 162624, v49
    v_mov_b64 v[92:93], 0
    v_mov_b32 v88, 1.0
    v_mov_b32 v89, 1.0
    v_mov_b64 v[94:95], 0
    v_mov_b32 v90, 1.0
    v_mov_b32 v91, 1.0
    v_mov_b32 v118, 0
    s_and_b32 s45, s32, 1
    s_lshl_b32 s45, s45, 6
    v_add_u32 v70, s45, v1
    v_mul_u32_u24 v64, 2048, v70
    v_xor_b32 v65, 64, v70
    v_mul_u32_u24 v65, 2048, v65
    v_mov_b64 v[120:121], 0
    v_mov_b64 v[122:123], 0
    s_mov_b32 s51, 131072
    s_cmp_ge_u32 s32, 12
    s_cbranch_scc1 K1_H5
    v_mov_b32 v112, 272
K2_Wy:
    ds_read_b32 v114, v112
    s_waitcnt lgkmcnt(0)
    v_cmp_gt_u32 vcc, 10, v114
    s_cbranch_vccz K2_WXy
    s_sleep 1
    s_branch K2_Wy
K2_WXy:
    buffer_load_dwordx2 v[10:11], v64, s[12:15], s29 offen sc1
    s_setprio 3
K2_TABP:
    s_mov_b32 s47, 0xf000f000
    s_waitcnt vmcnt(0)
    v_xor_b32 v2, s71, v10
    v_xor_b32 v3, s70, v11
    v_and_or_b32 v2, v2, s47, v3
    v_cmp_ne_u32 vcc, 0, v2
    s_cbranch_vccnz K2_TABW
K2_TABX:
    v_bfe_u32 v2, v10, 16, 12
    s_bitcmp1_b32 s32, 0
    v_add_u32 v3, 3, v2
    s_cselect_b32 s47, 256, 0
    v_lshrrev_b32 v3, 2, v3
    v_and_b32 v5, 0xfff, v10
    v_mov_b32 v4, v3
    s_nop 0
    v_mul_u32_u24 v7, 13312, v70
    v_add_u32_dpp v4, v4, v4 row_shr:1 row_mask:0xf bank_mask:0xf bound_ctrl:0
    v_lshl_add_u32 v5, v5, 2, v7
    v_cmp_lt_u32 vcc, 8, v3
    v_add_u32_dpp v4, v4, v4 row_shr:2 row_mask:0xf bank_mask:0xf bound_ctrl:0
    v_mov_b32 v8, 304
    v_mov_b32 v9, 1
    v_add_u32_dpp v4, v4, v4 row_shr:4 row_mask:0xf bank_mask:0xf bound_ctrl:0
    s_movk_i32 s50, 72
    s_movk_i32 s51, 84
    v_add_u32_dpp v4, v4, v4 row_shr:8 row_mask:0xf bank_mask:0xf bound_ctrl:0
    s_nop 1
    v_add_u32_dpp v4, v4, v4 row_bcast:15 row_mask:0xa bank_mask:0xf
    s_nop 1
    v_add_u32_dpp v4, v4, v4 row_bcast:31 row_mask:0xc bank_mask:0xf
    s_nop 0
    v_readlane_b32 s46, v4, 63
    v_sub_u32 v4, v4, v3
    s_cmp_gt_u32 s46, 256
    s_cbranch_scc1 K1_BA
    s_cbranch_vccnz K1_BA
    v_add_lshl_u32 v4, v4, s47, 2
    v_cmpx_lt_u32 vcc, 0, v2
    v_min_u32 v6, 4, v2
    v_add3_u32 v6, v5, v6, 0
    ds_write_b32 v4, v6 offset:30720
    v_cmpx_lt_u32 vcc, 4, v2
    v_min_u32 v6, 8, v2
    v_add3_u32 v6, v5, v6, 12
    ds_write_b32 v4, v6 offset:30724
    v_cmpx_lt_u32 vcc, 8, v2
    v_min_u32 v6, 12, v2
    v_add3_u32 v6, v5, v6, 24
    ds_write_b32 v4, v6 offset:30728
    v_cmpx_lt_u32 vcc, 12, v2
    s_cbranch_execz K1_BX
    v_min_u32 v6, 16, v2
    v_add3_u32 v6, v5, v6, 36
    ds_write_b32 v4, v6 offset:30732
    v_cmpx_lt_u32 vcc, 16, v2
    s_cbranch_execz K1_BX
    v_min_u32 v6, 20, v2
    v_add3_u32 v6, v5, v6, 48
    ds_write_b32 v4, v6 offset:30736
    v_cmpx_lt_u32 vcc, 20, v2
    s_cbranch_execz K1_BX
    v_min_u32 v6, 24, v2
    v_add3_u32 v6, v5, v6, 60
    ds_write_b32 v4, v6 offset:30740
    v_cmpx_lt_u32 vcc, 24, v2
    s_cbranch_execz K1_BX
    v_min_u32 v6, 28, v2
    v_add3_u32 v6, v5, v6, s50
    ds_write_b32 v4, v6 offset:30744
    v_cmpx_lt_u32 vcc, 28, v2
    s_cbranch_execz K1_BX
    v_min_u32 v6, 32, v2
    v_add3_u32 v6, v5, v6, s51
    ds_write_b32 v4, v6 offset:30748
K1_BX:
    s_mov_b64 exec, 1
    ds_add_u32 v8, v9
    s_mov_b64 exec, -1
    s_setprio 0
    s_branch K2_C2T
K1_H5:
    s_cmp_lt_u32 s32, 14
    s_cbranch_scc1 K1_H4
    s_waitcnt vmcnt(0)
    v_mov_b32 v8, 264
    v_mov_b32 v9, 1
    s_mov_b64 exec, 1
    ds_add_u32 v8, v9
    s_mov_b64 exec, -1
    s_cmp_lg_u32 s32, 15
    s_cbranch_scc1 K2_C2T
    s_mov_b32 s46, 0xbfb8aa3b
    v_lshlrev_b32 v16, 16, v16
    v_mul_f32 v16, s46, v16
    v_lshlrev_b32 v17, 16, v17
    v_mul_f32 v17, s46, v17
    v_lshlrev_b32 v18, 16, v18
    v_mul_f32 v18, s46, v18
    v_lshlrev_b32 v19, 16, v19
    v_mul_f32 v19, s46, v19
    v_lshlrev_b32 v20, 16, v20
    v_mul_f32 v20, s46, v20
    v_lshlrev_b32 v21, 16, v21
    v_mul_f32 v21, s46, v21
    v_lshlrev_b32 v22, 16, v22
    v_mul_f32 v22, s46, v22
    v_lshlrev_b32 v23, 16, v23
    v_mul_f32 v23, s46, v23
    v_cvt_pk_bf16_f32 v24, v16, v17
    v_cvt_pk_bf16_f32 v25, v18, v19
    v_cvt_pk_bf16_f32 v26, v20, v21
    v_cvt_pk_bf16_f32 v27, v22, v23
    ds_write_b128 v49, v[24:27]
    s_branch K2_C2T
K1_H4:
    v_add_u32 v2, 20480, v66
    v_mov_b32 v112, 268
K2_Wd:
    ds_read_b32 v114, v112
    s_waitcnt lgkmcnt(0)
    v_cmp_gt_u32 vcc, 10, v114
    s_cbranch_vccz K2_WXd
    s_sleep 1
    s_branch K2_Wd
K2_WXd:
    ds_write_b128 v2, v[120:123] offset:0
    ds_write_b128 v2, v[120:123] offset:2048
    ds_write_b128 v2, v[120:123] offset:4096
    ds_write_b128 v2, v[120:123] offset:6144
    ds_write_b128 v2, v[120:123] offset:8192
    ds_write_b128 v2, v[120:123] offset:10240
    ds_write_b128 v2, v[120:123] offset:12288
    ds_write_b128 v2, v[120:123] offset:14336
    ds_write_b128 v2, v[120:123] offset:16384
    ds_write_b128 v2, v[120:123] offset:18432
    ds_write_b128 v2, v[120:123] offset:20480
    ds_write_b128 v2, v[120:123] offset:22528
    ds_write_b128 v2, v[120:123] offset:24576
    ds_write_b128 v2, v[120:123] offset:26624
    ds_write_b128 v2, v[120:123] offset:28672
    ds_write_b128 v2, v[120:123] offset:30720
    ds_write_b128 v2, v[120:123] offset:32768
    ds_write_b128 v2, v[120:123] offset:34816
    ds_write_b128 v2, v[120:123] offset:36864
    ds_write_b128 v2, v[120:123] offset:38912
    s_branch K2_C2T
K1_Q:
    s_setprio 0
    s_cmp_ge_u32 s32, 6
    s_cbranch_scc1 K2_C0
    s_cmp_ge_u32 s32, 3
    s_cselect_b32 s55, 1, 0
    s_mul_i32 s50, s55, 3
    s_sub_u32 s28, s32, s50
    s_lshl_b32 s50, s28, 12
    v_add_u32 v103, s50, v124
    v_add_u32 v104, s50, v125
    v_add_u32 v106, s50, v126
    v_add_u32 v107, s50, v127
    s_lshl_b32 s55, s55, 7
    v_and_b32 v98, 3, v0
    v_lshlrev_b32 v102, 9, v108
    v_lshl_add_u32 v102, v98, 3, v102
    v_mul_u32_u24 v98, 72, v111
    v_add_u32 v102, v102, v98
    v_and_b32 v98, 4, v108
    v_lshl_add_u32 v102, v98, 5, v102
    v_add_u32 v102, 116736, v102
    v_xor_b32 v98, s55, v102
    v_xor_b32 v99, 32, v98
    v_xor_b32 v100, 64, v98
    v_xor_b32 v102, 96, v98
    s_mul_i32 s50, s28, 5248
    s_add_u32 s50, s50, s55
    s_add_u32 s50, s50, 149504
    v_mul_u32_u24 v76, 328, v109
    v_lshl_add_u32 v76, v108, 1, v76
    v_add_u32 v76, s50, v76
    s_mov_b32 s46, 0xbfb8aa3b
    s_mov_b32 s47, 0xbfb8aa3b
    v_mov_b32 v112, 264
K2_Wq:
    ds_read_b32 v114, v112
    s_waitcnt lgkmcnt(0)
    v_cmp_gt_u32 vcc, 2, v114
    s_cbranch_vccz K2_WXq
    s_sleep 1
    s_branch K2_Wq
K2_WXq:
    ds_read_b128 v[80:83], v103
    ds_read_b128 v[84:87], v104
    ds_read_b128 v[88:91], v106
    ds_read_b128 v[92:95], v107
    ds_read_b64_tr_b16 v[2:3], v98 offset:0
    ds_read_b64_tr_b16 v[4:5], v98 offset:1024
    ds_read_b64_tr_b16 v[6:7], v99 offset:0
    ds_read_b64_tr_b16 v[8:9], v99 offset:1024
    ds_read_b64_tr_b16 v[10:11], v100 offset:0
    ds_read_b64_tr_b16 v[12:13], v100 offset:1024
    ds_read_b64_tr_b16 v[14:15], v102 offset:0
    ds_read_b64_tr_b16 v[16:17], v102 offset:1024
    ds_read_b64_tr_b16 v[18:19], v98 offset:8192
    ds_read_b64_tr_b16 v[20:21], v98 offset:9216
    ds_read_b64_tr_b16 v[22:23], v99 offset:8192
    ds_read_b64_tr_b16 v[24:25], v99 offset:9216
    ds_read_b64_tr_b16 v[26:27], v100 offset:8192
    ds_read_b64_tr_b16 v[28:29], v100 offset:9216
    ds_read_b64_tr_b16 v[30:31], v102 offset:8192
    ds_read_b64_tr_b16 v[32:33], v102 offset:9216
    s_waitcnt lgkmcnt(8)
    v_mfma_f32_16x16x32_bf16 v[50:53], v[2:5], v[80:83], 0
    v_mfma_f32_16x16x32_bf16 v[54:57], v[6:9], v[80:83], 0
    v_mfma_f32_16x16x32_bf16 v[112:115], v[10:13], v[80:83], 0
    v_mfma_f32_16x16x32_bf16 v[120:123], v[14:17], v[80:83], 0
    ds_read_b64_tr_b16 v[34:35], v98 offset:16384
    ds_read_b64_tr_b16 v[36:37], v98 offset:17408
    ds_read_b64_tr_b16 v[38:39], v99 offset:16384
    ds_read_b64_tr_b16 v[40:41], v99 offset:17408
    ds_read_b64_tr_b16 v[42:43], v100 offset:16384
    ds_read_b64_tr_b16 v[44:45], v100 offset:17408
    ds_read_b64_tr_b16 v[46:47], v102 offset:16384
    ds_read_b64_tr_b16 v[48:49], v102 offset:17408
    s_waitcnt lgkmcnt(8)
    v_mfma_f32_16x16x32_bf16 v[50:53], v[18:21], v[84:87], v[50:53]
    v_mfma_f32_16x16x32_bf16 v[54:57], v[22:25], v[84:87], v[54:57]
    v_mfma_f32_16x16x32_bf16 v[112:115], v[26:29], v[84:87], v[112:115]
    v_mfma_f32_16x16x32_bf16 v[120:123], v[30:33], v[84:87], v[120:123]
    ds_read_b64_tr_b16 v[2:3], v98 offset:24576
    ds_read_b64_tr_b16 v[4:5], v98 offset:25600
    ds_read_b64_tr_b16 v[6:7], v99 offset:24576
    ds_read_b64_tr_b16 v[8:9], v99 offset:25600
    ds_read_b64_tr_b16 v[10:11], v100 offset:24576
    ds_read_b64_tr_b16 v[12:13], v100 offset:25600
    ds_read_b64_tr_b16 v[14:15], v102 offset:24576
    ds_read_b64_tr_b16 v[16:17], v102 offset:25600
    s_waitcnt lgkmcnt(8)
    v_mfma_f32_16x16x32_bf16 v[50:53], v[34:37], v[88:91], v[50:53]
    v_mfma_f32_16x16x32_bf16 v[54:57], v[38:41], v[88:91], v[54:57]
    v_mfma_f32_16x16x32_bf16 v[112:115], v[42:45], v[88:91], v[112:115]
    v_mfma_f32_16x16x32_bf16 v[120:123], v[46:49], v[88:91], v[120:123]
    s_waitcnt lgkmcnt(0)
    v_mfma_f32_16x16x32_bf16 v[50:53], v[2:5], v[92:95], v[50:53]
    v_mfma_f32_16x16x32_bf16 v[54:57], v[6:9], v[92:95], v[54:57]
    v_mfma_f32_16x16x32_bf16 v[112:115], v[10:13], v[92:95], v[112:115]
    v_mfma_f32_16x16x32_bf16 v[120:123], v[14:17], v[92:95], v[120:123]
    s_nop 1
    s_cmp_eq_u32 s28, 2
    s_cselect_b32 s50, 0x00ff00ff, -1
    s_nop 5
    v_pk_mul_f32 v[50:51], v[50:51], s[46:47]
    v_pk_mul_f32 v[52:53], v[52:53], s[46:47]
    v_cvt_pk_bf16_f32 v50, v50, v51
    v_cvt_pk_bf16_f32 v51, v52, v53
    v_pk_mul_f32 v[54:55], v[54:55], s[46:47]
    v_pk_mul_f32 v[56:57], v[56:57], s[46:47]
    v_cvt_pk_bf16_f32 v54, v54, v55
    v_cvt_pk_bf16_f32 v55, v56, v57
    v_pk_mul_f32 v[112:113], v[112:113], s[46:47]
    v_pk_mul_f32 v[114:115], v[114:115], s[46:47]
    v_cvt_pk_bf16_f32 v112, v112, v113
    v_cvt_pk_bf16_f32 v113, v114, v115
    v_pk_mul_f32 v[120:121], v[120:121], s[46:47]
    v_pk_mul_f32 v[122:123], v[122:123], s[46:47]
    v_cvt_pk_bf16_f32 v120, v120, v121
    v_cvt_pk_bf16_f32 v121, v122, v123
    s_mov_b32 exec_lo, s50
    s_mov_b32 exec_hi, s50
    ds_write_b64 v76, v[50:51] offset:0
    ds_write_b64 v76, v[54:55] offset:32
    ds_write_b64 v76, v[112:113] offset:64
    ds_write_b64 v76, v[120:121] offset:96
    s_mov_b64 exec, -1
K2_C0:
    s_and_b32 s45, s2, 7
    s_mul_i32 s45, s45, 2048
    s_add_u32 s45, s45, 7995392
    v_lshl_add_u32 v38, v1, 4, s45
    s_mov_b32 s46, 0xEA543210
    s_mov_b32 s47, 0xFBD9C876
    s_lshl_b32 s45, s32, 2
    s_lshr_b64 s[46:47], s[46:47], s45
    s_and_b32 s3, s46, 15
    s_mov_b32 s4, 0x9e37b5a7
    s_mov_b32 s5, 0x85ebca6b
    s_mov_b32 s6, 0xc2b3ae35
    s_mov_b32 s7, 0x27d5eb2f
    s_mov_b32 s20, 0x165767b1
    s_mov_b32 s21, 0xd3a3646d
    s_mov_b32 s22, 0xfd7146c5
    s_mov_b32 s23, 0xb55b4f09
    s_mov_b32 s28, 1
    s_and_b32 s64, s71, 0xffc00003
    s_lshl_b32 s65, s71, 12
    s_bfe_u32 s67, s71, 0x20014
    s_and_b32 s65, s65, 0xc00003
    s_or_b32 s65, s65, s67
    v_mov_b32 v40, s70
    v_mov_b32 v71, 0
    v_mov_b32 v30, 0
    v_mov_b32 v33, 0
    s_bfm_b64 exec, s34, 0
    v_mov_b32 v71, 28
    s_mov_b64 exec, -1
    v_mov_b32 v39, 4
    v_lshlrev_b32 v113, 2, v1
    v_and_b32 v44, 4, v111
    v_and_b32 v45, 8, v111
    v_add_u32 v44, 512, v44
    v_lshrrev_b32 v46, 3, v1
    v_add_u32 v46, 320, v46
    v_and_b32 v47, 1, v1
    v_lshlrev_b32 v48, 3, v1
    v_add_u32 v48, 31744, v48
    v_lshlrev_b32 v49, 4, v1
    v_add_u32 v49, 162624, v49
    v_mov_b64 v[92:93], 0
    v_mov_b32 v88, 1.0
    v_mov_b32 v89, 1.0
    v_mov_b64 v[94:95], 0
    v_mov_b32 v90, 1.0
    v_mov_b32 v91, 1.0
    v_mov_b32 v118, 0
    s_mov_b64 s[30:31], 0
    s_cmp_lt_u32 s3, 8
    s_cbranch_scc1 K2_TCH
K2_C2T:
    v_mov_b32 v112, 304
K2_Wt:
    ds_read_b64 v[114:115], v112
    s_waitcnt lgkmcnt(0)
    v_add_u32 v114, v114, v115
    v_cmp_gt_u32 vcc, 2, v114
    s_cbranch_vccz K2_WXt
    s_sleep 1
    s_branch K2_Wt
K2_WXt:
    s_sleep 8
    s_lshl_b32 s45, s3, 8
    v_lshl_add_u32 v112, v1, 2, s45
    v_mov_b32 v114, 0
    ds_read_b32 v30, v112 offset:28672
    ds_write_b32 v112, v114 offset:28672
    s_mov_b32 s45, 9437184
    s_mov_b32 s46, 11534336
    s_mov_b32 s51, 131072
    s_waitcnt lgkmcnt(1)
    v_and_b32 v32, 15, v30
    v_cmpx_ne_u32 s[30:31], 0, v30
    v_and_b32 v30, -16, v30
    s_cbranch_execz K2_LRa
    buffer_load_dwordx4 v[2:5], v30, s[16:19], s45 offen sc1
    v_lshlrev_b32 v33, 1, v30
K2_RECP:
    s_waitcnt vmcnt(0)
    v_xor_b32 v114, s65, v3
    v_xor_b32 v112, s64, v2
    v_and_b32 v114, 0xc00003, v114
    v_or_b32 v112, v114, v112
    v_and_b32 v112, 0xffc00003, v112
    v_cmp_ne_u32 vcc, 0, v112
    s_cbranch_vccnz K2_RECW
K2_RECY:
K2_CNT:
    v_and_b32 v10, 0xfc, v2
    v_and_b32 v11, 0xfc, v3
    v_and_b32 v12, 0xfc, v4
    v_and_b32 v13, 0xfc, v5
    v_cmpx_lt_i32 vcc, 0, v32
    ds_add_rtn_u32 v6, v10, v39 offset:0
    v_cmpx_lt_i32 vcc, 1, v32
    ds_add_rtn_u32 v7, v11, v39 offset:0
    v_cmpx_lt_i32 vcc, 2, v32
    ds_add_rtn_u32 v8, v12, v39 offset:0
    v_cmpx_lt_i32 vcc, 3, v32
    ds_add_rtn_u32 v9, v13, v39 offset:0
    s_mov_b64 exec, s[30:31]
    s_cmp_eq_u32 s28, 0
    s_cbranch_scc1 K2_CE0
    buffer_load_dwordx4 v[18:21], v33, s[16:19], s46 offen sc1
    buffer_load_dwordx4 v[22:25], v33, s[16:19], s46 offen offset:16 sc1
K2_CE0:
    v_mov_b64 v[42:43], v[4:5]
    v_mov_b32 v31, v3
    v_bfe_u32 v26, v2, 8, 14
    v_bfe_u32 v27, v3, 8, 14
    v_bfe_u32 v28, v4, 8, 14
    v_bfe_u32 v29, v5, 8, 14
    v_lshlrev_b32 v2, 2, v10
    v_lshlrev_b32 v3, 2, v11
    v_lshlrev_b32 v4, 2, v12
    v_lshlrev_b32 v5, 2, v13
K2_LRa:
K2_C1s:
    s_mov_b64 exec, -1
    s_waitcnt lgkmcnt(0)
    s_barrier
    s_cmp_eq_u32 s32, 9
    s_cselect_b32 s45, s62, 0
    s_cmp_eq_u32 s45, 0
    s_cbranch_scc1 K2_PFAX
    buffer_load_dwordx4 v[34:37], v38, s[16:19], 0 offen sc1
K2_PFAX:
    ds_read_b32 v114, v113 offset:0
    ds_read_b64 v[50:51], v49
    ds_read_b64 v[54:55], v49 offset:8
    v_mov_b32 v104, 2048
    s_waitcnt lgkmcnt(2)
    v_max_u32 v116, v114, v71
    s_nop 0
    v_mov_b32 v115, v116
    v_add_u32_dpp v116, v116, v116 row_shr:1 row_mask:0xf bank_mask:0xf bound_ctrl:0
    s_nop 1
    v_add_u32_dpp v116, v116, v116 row_shr:2 row_mask:0xf bank_mask:0xf bound_ctrl:0
    s_nop 1
    v_add_u32_dpp v116, v116, v116 row_shr:4 row_mask:0xf bank_mask:0xf bound_ctrl:0
    s_nop 1
    v_add_u32_dpp v116, v116, v116 row_shr:8 row_mask:0xf bank_mask:0xf bound_ctrl:0
    s_nop 1
    v_add_u32_dpp v116, v116, v116 row_bcast:15 row_mask:0xa bank_mask:0xf
    s_nop 1
    v_add_u32_dpp v116, v116, v116 row_bcast:31 row_mask:0xc bank_mask:0xf
    s_cmp_eq_u64 s[30:31], 0
    v_sub_u32 v117, v116, v115
    v_readlane_b32 s56, v116, 63
    s_cbranch_scc1 K2_C2
    ds_bpermute_b32 v14, v10, v117
    ds_bpermute_b32 v15, v11, v117
    ds_bpermute_b32 v16, v12, v117
    ds_bpermute_b32 v17, v13, v117
K2_C2:
    s_add_u32 s45, s56, 63
    s_lshr_b32 s55, s45, 6
    s_cmp_gt_u32 s56, 6144
    s_cbranch_scc1 K2_SPLIT
    s_lshl_b32 s47, s55, 5
    s_cmp_ge_u32 s3, 8
    s_cbranch_scc1 K2_L1
    s_mul_i32 s45, s55, s59
    s_add_u32 s46, s45, s55
    s_lshr_b32 s57, s45, 4
    s_lshr_b32 s46, s46, 4
    s_lshl_b32 s45, s57, 5
    s_sub_u32 s58, s46, s57
    v_cmp_ge_u32 vcc, s45, v117
    v_add3_u32 v98, v108, s45, v104
    s_add_u32 s45, s45, s47
    s_bcnt1_i32_b64 s68, vcc
    v_cmp_ge_u32 vcc, s45, v117
    v_add_u32 v104, s47, v98
    s_sub_u32 s38, 6, s58
    s_bcnt1_i32_b64 s69, vcc
    s_mov_b32 s45, s3
    s_bfm_b64 exec, s34, 0
    v_add_u32 v116, -4, v116
    v_lshrrev_b32 v117, 5, v117
    v_and_b32 v113, 1, v1
    v_add_lshl_u32 v117, v117, s45, 1
    v_lshrrev_b32 v115, 2, v116
    v_add_lshl_u32 v117, v117, v113, 2
    v_or_b32 v114, 7, v115
    s_cmp_lg_u32 s45, 7
    s_cbranch_scc1 K2_QNs
    v_lshrrev_b32 v112, 7, v116
    v_lshlrev_b32 v113, v115, 1
    v_lshlrev_b32 v112, 2, v112
    ds_or_b32 v112, v113 offset:320
K2_QNs:
    v_cmpx_le_u32 vcc, v117, v114
    s_cbranch_execz K2_QNXs
    ds_write_b32 v117, v1 offset:512
    v_add_u32 v117, 64, v117
    s_branch K2_QNs
K2_QNXs:
    s_mov_b64 exec, -1
K2_L1:
    s_cmp_eq_u64 s[30:31], 0
    s_cbranch_scc1 K2_L2
    s_sub_u32 s45, s47, 1
    s_waitcnt lgkmcnt(0)
    v_cmpx_lt_i32 vcc, 0, v32
    v_add_u32 v14, v14, v6
    ds_write_b32 v14, v26 offset:2048
    v_cmpx_lt_i32 vcc, 1, v32
    v_add_u32 v15, v15, v7
    ds_write_b32 v15, v27 offset:2048
    v_cmpx_lt_i32 vcc, 2, v32
    v_add_u32 v16, v16, v8
    ds_write_b32 v16, v28 offset:2048
    v_cmpx_lt_i32 vcc, 3, v32
    v_add_u32 v17, v17, v9
    ds_write_b32 v17, v29 offset:2048
    s_mov_b64 exec, -1
    v_sub_u32 v6, s45, v14
    v_lshlrev_b32 v14, 2, v14
    v_lshrrev_b32 v6, 26, v6
    v_bfi_b32 v6, 32, v6, v2
    v_sub_u32 v7, s45, v15
    v_lshlrev_b32 v15, 2, v15
    v_lshrrev_b32 v7, 26, v7
    v_bfi_b32 v7, 32, v7, v3
    v_sub_u32 v8, s45, v16
    v_lshlrev_b32 v16, 2, v16
    v_lshrrev_b32 v8, 26, v8
    v_bfi_b32 v8, 32, v8, v4
    v_sub_u32 v9, s45, v17
    v_lshlrev_b32 v17, 2, v17
    v_lshrrev_b32 v9, 26, v9
    v_bfi_b32 v9, 32, v9, v5
    s_cmp_eq_u32 s32, 9
    s_cselect_b32 s51, s62, 0
    s_cmp_lg_u32 s51, 0
    s_cbranch_scc1 K2_PFB
K2_PFBX:
    s_waitcnt lgkmcnt(0)
    s_barrier
    s_movk_i32 s51, 64
K2_ES:
    s_waitcnt vmcnt(0)
    v_cmpx_lt_i32 vcc, 3, v32
    v_lshlrev_b64 v[26:27], v9, s[60:61]
    ds_write_b128 v17, v[24:27] offset:8192
    s_mov_b64 exec, -1
    v_dot2_u32_u16 v10, v24, s22, v40
    v_dot2_u32_u16 v10, v25, s23, v10
    v_cmpx_lt_i32 vcc, 2, v32
    v_lshlrev_b64 v[24:25], v8, s[60:61]
    ds_write_b128 v16, v[22:25] offset:8192
    s_mov_b64 exec, -1
    v_dot2_u32_u16 v10, v22, s20, v10
    v_dot2_u32_u16 v10, v23, s21, v10
    v_cmpx_lt_i32 vcc, 1, v32
    v_lshlrev_b64 v[22:23], v7, s[60:61]
    ds_write_b128 v15, v[20:23] offset:8192
    s_mov_b64 exec, -1
    v_dot2_u32_u16 v10, v20, s6, v10
    v_dot2_u32_u16 v10, v21, s7, v10
    v_cmpx_lt_i32 vcc, 0, v32
    v_lshlrev_b64 v[20:21], v6, s[60:61]
    ds_write_b128 v14, v[18:21] offset:8192
    s_mov_b64 exec, -1
    v_dot2_u32_u16 v10, v18, s4, v10
    v_dot2_u32_u16 v10, v19, s5, v10
    v_alignbit_b32 v11, v10, v10, 20
    v_xor_b32 v12, v10, v42
    v_lshlrev_b32 v10, 22, v10
    v_bitop3_b32 v12, v43, v11, v12 bitop3:0xbe
    v_xor_b32 v10, v10, v31
    v_and_b32 v10, 0xff000000, v10
    v_or_b32 v12, v10, v12
    v_and_b32 v12, 0xffc00003, v12
    v_cmp_ne_u32 vcc, 0, v12
    s_and_b64 vcc, vcc, s[30:31]
    s_cbranch_scc1 K2_EW
K2_EX:
    s_mul_i32 s45, s55, s59
    s_add_u32 s46, s45, s55
    s_lshr_b32 s57, s45, 4
    s_lshr_b32 s46, s46, 4
    s_lshl_b32 s45, s57, 5
    s_sub_u32 s58, s46, s57
    v_cmp_ge_u32 vcc, s45, v117
    v_add3_u32 v98, v108, s45, v104
    s_add_u32 s45, s45, s47
    s_bcnt1_i32_b64 s68, vcc
    v_cmp_ge_u32 vcc, s45, v117
    v_add_u32 v104, s47, v98
    s_sub_u32 s38, 6, s58
    s_bcnt1_i32_b64 s69, vcc
    ds_read_b32 v72, v98 offset:0
    ds_read_b32 v74, v98 offset:16
    ds_read_b32 v76, v104 offset:0
    ds_read_b32 v78, v104 offset:16
    s_lshl_b32 s45, s57, 3
    v_add_u32 v100, s45, v44
    s_sub_u32 s46, s57, s38
    v_mad_u32_u24 v100, v45, s55, v100
    v_add_u32 v46, s46, v46
    v_mov_b32 v112, 0
    ds_read_b32 v103, v100 offset:0
    v_add_u32 v106, s55, v46
    ds_read_u8 v120, v46
    ds_read_u8 v121, v106
    ds_read_b32 v122, v112 offset:256
    s_lshl_b32 s45, s57, 7
    v_add_u32 v99, s45, v110
    s_lshl_b32 s45, s55, 7
    v_mad_u32_u24 v99, v47, s45, v99
    v_lshl_add_u32 v114, s68, 10, v48
    v_mov_b32 v115, v114
    v_lshl_add_u32 v116, s69, 10, v48
    v_mov_b32 v117, v116
    s_add_u32 s45, s55, s57
    s_add_u32 s45, s45, s58
    s_lshl_b32 s45, s45, 5
    s_cmp_ge_u32 s56, s45
    s_cselect_b32 s51, 0x8000, 0
    s_lshl_b32 s45, s38, 3
    s_cmp_eq_u32 s58, 0
    s_cselect_b32 s62, 16, s32
    s_cmp_ge_u32 s62, 12
    s_waitcnt lgkmcnt(8)
    s_barrier
    s_cbranch_scc1 K2_L4
    s_waitcnt lgkmcnt(4)
    buffer_load_dwordx4 v[72:73], s[8:11], 0 idxen offen offset:0 sc1 lds
    buffer_load_dwordx4 v[74:75], s[8:11], 0 idxen offen offset:1024 sc1 lds
    buffer_load_dwordx4 v[76:77], s[8:11], 0 idxen offen offset:2048 sc1 lds
    buffer_load_dwordx4 v[78:79], s[8:11], 0 idxen offen offset:3072 sc1 lds
K2_L4:
    s_waitcnt lgkmcnt(0)
    v_mad_u32_u24 v102, v103, s44, v101
    v_and_b32 v120, v105, v120
    v_and_b32 v121, v105, v121
    v_readfirstlane_b32 s50, v122
    v_cmp_ne_u32 s[40:41], 0, v120
    v_cmp_ne_u32 s[64:65], 0, v121
    ds_read_b32 v103, v100 offset:8
    v_subrev_u32 v100, s45, v100
    s_or_b32 s45, s50, s52
    s_cselect_b32 s28, 0, 1
    s_bitset1_b32 s41, 15
    s_or_b32 s65, s65, s51
    s_or_b64 s[46:47], s[40:41], s[64:65]
    s_lshr_b64 vcc, s[46:47], 1
    s_or_b64 s[36:37], s[46:47], vcc
    s_lshr_b64 vcc, s[46:47], 2
    s_or_b64 s[36:37], s[36:37], vcc
    s_sub_u32 s45, s62, 12
    s_cmp_ge_u32 s45, 4
    s_cbranch_scc1 K2_L6
    buffer_load_dwordx4 v[72:73], s[8:11], 0 idxen offen offset:0 sc1 lds
    buffer_load_dwordx4 v[74:75], s[8:11], 0 idxen offen offset:1024 sc1 lds
    buffer_load_dwordx4 v[76:77], s[8:11], 0 idxen offen offset:2048 sc1 lds
    buffer_load_dwordx4 v[78:79], s[8:11], 0 idxen offen offset:3072 sc1 lds
    s_branch K2_L6
K2_L2:
    s_cmp_eq_u32 s32, 9
    s_cselect_b32 s51, s62, 0
    s_cmp_lg_u32 s51, 0
    s_cbranch_scc1 K2_PFBn
K2_PFBXn:
    s_waitcnt lgkmcnt(0)
    s_barrier
    s_cmp_lt_u32 s3, 8
    s_cbranch_scc1 K2_L5
    s_mul_i32 s45, s55, s59
    s_add_u32 s46, s45, s55
    s_lshr_b32 s57, s45, 4
    s_lshr_b32 s46, s46, 4
    s_lshl_b32 s45, s57, 5
    s_sub_u32 s58, s46, s57
    v_cmp_ge_u32 vcc, s45, v117
    v_add3_u32 v98, v108, s45, v104
    s_add_u32 s45, s45, s47
    s_bcnt1_i32_b64 s68, vcc
    v_cmp_ge_u32 vcc, s45, v117
    v_add_u32 v104, s47, v98
    s_sub_u32 s38, 6, s58
    s_bcnt1_i32_b64 s69, vcc
K2_L5:
    ds_read_b32 v72, v98 offset:0
    ds_read_b32 v74, v98 offset:16
    ds_read_b32 v76, v104 offset:0
    ds_read_b32 v78, v104 offset:16
    s_lshl_b32 s45, s57, 3
    v_add_u32 v100, s45, v44
    s_sub_u32 s46, s57, s38
    v_mad_u32_u24 v100, v45, s55, v100
    v_add_u32 v46, s46, v46
    v_mov_b32 v112, 0
    ds_read_b32 v103, v100 offset:0
    v_add_u32 v106, s55, v46
    ds_read_u8 v120, v46
    ds_read_u8 v121, v106
    ds_read_b32 v122, v112 offset:256
    s_cmp_eq_u32 s58, 0
    s_cselect_b32 s62, 16, s32
    s_cmp_ge_u32 s62, 4
    s_cbranch_scc1 K2_L7
    s_waitcnt lgkmcnt(4)
    buffer_load_dwordx4 v[72:73], s[8:11], 0 idxen offen offset:0 sc1 lds
    buffer_load_dwordx4 v[74:75], s[8:11], 0 idxen offen offset:1024 sc1 lds
    buffer_load_dwordx4 v[76:77], s[8:11], 0 idxen offen offset:2048 sc1 lds
    buffer_load_dwordx4 v[78:79], s[8:11], 0 idxen offen offset:3072 sc1 lds
K2_L7:
    s_lshl_b32 s45, s57, 7
    v_add_u32 v99, s45, v110
    s_lshl_b32 s45, s55, 7
    v_mad_u32_u24 v99, v47, s45, v99
    v_lshl_add_u32 v114, s68, 10, v48
    v_mov_b32 v115, v114
    v_lshl_add_u32 v116, s69, 10, v48
    v_mov_b32 v117, v116
    s_add_u32 s45, s55, s57
    s_add_u32 s45, s45, s58
    s_lshl_b32 s45, s45, 5
    s_cmp_ge_u32 s56, s45
    s_cselect_b32 s51, 0x8000, 0
    s_lshl_b32 s45, s38, 3
    s_waitcnt lgkmcnt(0)
    v_mad_u32_u24 v102, v103, s44, v101
    v_and_b32 v120, v105, v120
    v_and_b32 v121, v105, v121
    v_readfirstlane_b32 s50, v122
    v_cmp_ne_u32 s[40:41], 0, v120
    v_cmp_ne_u32 s[64:65], 0, v121
    ds_read_b32 v103, v100 offset:8
    v_subrev_u32 v100, s45, v100
    s_or_b32 s45, s50, s52
    s_cselect_b32 s28, 0, 1
    s_bitset1_b32 s41, 15
    s_or_b32 s65, s65, s51
    s_or_b64 s[46:47], s[40:41], s[64:65]
    s_lshr_b64 vcc, s[46:47], 1
    s_or_b64 s[36:37], s[46:47], vcc
    s_lshr_b64 vcc, s[46:47], 2
    s_or_b64 s[36:37], s[36:37], vcc
    s_barrier
    s_sub_u32 s45, s62, 4
    s_cmp_ge_u32 s45, 12
    s_cbranch_scc1 K2_L6
    buffer_load_dwordx4 v[72:73], s[8:11], 0 idxen offen offset:0 sc1 lds
    buffer_load_dwordx4 v[74:75], s[8:11], 0 idxen offen offset:1024 sc1 lds
    buffer_load_dwordx4 v[76:77], s[8:11], 0 idxen offen offset:2048 sc1 lds
    buffer_load_dwordx4 v[78:79], s[8:11], 0 idxen offen offset:3072 sc1 lds
K2_L6:
    s_mov_b32 s62, 0
    ds_read_b32 v72, v98 offset:32
    ds_read_b32 v74, v98 offset:48
    ds_read_b32 v76, v104 offset:32
    ds_read_b32 v78, v104 offset:48
    s_lshl_b32 s45, s38, 5
    v_subrev_u32 v98, s45, v98
    v_subrev_u32 v104, s45, v104
    s_cmp_eq_u32 s58, 0
    s_cbranch_scc1 K2_REND
    s_mov_b64 exec, s[42:43]
    ds_read_b128 v[58:61], v99 offset:0
    s_mov_b64 exec, -1
    s_lshl_b32 s45, s38, 7
    v_subrev_u32 v99, s45, v99
    s_waitcnt vmcnt(0)
    ds_read_b64_tr_b16 v[52:53], v102 offset:0
    ds_read_b64_tr_b16 v[34:35], v96 offset:0
    ds_read_b64_tr_b16 v[36:37], v97 offset:512
    ds_read_b64_tr_b16 v[38:39], v96 offset:1024
    ds_read_b64_tr_b16 v[40:41], v97 offset:1536
    ds_read_b64_tr_b16 v[56:57], v102 offset:128
    ds_read_b64_tr_b16 v[42:43], v97 offset:0
    ds_read_b64_tr_b16 v[44:45], v96 offset:512
    ds_read_b64_tr_b16 v[46:47], v97 offset:1024
    ds_read_b64_tr_b16 v[48:49], v96 offset:1536
    s_setprio 3
    s_waitcnt lgkmcnt(5)
    v_mfma_f32_32x32x16_bf16 v[2:17], v[58:61], v[50:53], 0
    s_nop 7
    s_nop 1
    v_mfma_f32_4x4x4_16b_bf16 v[2:5], v[62:63], v[34:35], v[2:5]
    v_mfma_f32_4x4x4_16b_bf16 v[6:9], v[62:63], v[36:37], v[6:9]
    v_mfma_f32_4x4x4_16b_bf16 v[10:13], v[62:63], v[38:39], v[10:13]
    v_mfma_f32_4x4x4_16b_bf16 v[14:17], v[62:63], v[40:41], v[14:17]
    s_waitcnt lgkmcnt(0)
    s_cmp_lt_u32 s58, 2
    s_cbranch_scc1 K2_G1X
    buffer_load_dwordx4 v[72:73], s[8:11], 0 idxen offen offset:0 sc1 lds
    buffer_load_dwordx4 v[74:75], s[8:11], 0 idxen offen offset:1024 sc1 lds
    buffer_load_dwordx4 v[76:77], s[8:11], 0 idxen offen offset:2048 sc1 lds
    buffer_load_dwordx4 v[78:79], s[8:11], 0 idxen offen offset:3072 sc1 lds
K2_G1X:
    s_nop 7
    s_cmp_lg_u32 s66, 0
    s_cbranch_scc1 K2_GLOOP
    s_cmp_eq_u32 s58, 5
    s_cbranch_scc1 K2_POS1
    s_cmp_eq_u32 s58, 4
    s_cbranch_scc1 K2_POS2
    s_cmp_eq_u32 s58, 3
    s_cbranch_scc1 K2_POS3
    s_cmp_eq_u32 s58, 2
    s_cbranch_scc1 K2_POS4
    s_cmp_eq_u32 s58, 1
    s_cbranch_scc1 K2_POS5
K2_POS0:
    s_setprio 3
    v_mfma_f32_32x32x16_bf16 v[18:33], v[58:61], v[54:57], 0
    v_exp_f32 v80, v2
    v_exp_f32 v81, v3
    v_exp_f32 v82, v4
    v_exp_f32 v83, v5
    v_exp_f32 v84, v6
    v_exp_f32 v85, v7
    s_waitcnt lgkmcnt(0)
    v_mad_u32_u24 v102, v103, s44, v101
    s_mov_b64 exec, s[42:43]
    ds_read_b128 v[58:61], v99 offset:128
    s_mov_b64 exec, -1
    ds_read_b32 v72, v98 offset:64
    ds_read_b32 v74, v98 offset:80
    ds_read_b32 v76, v104 offset:64
    ds_read_b32 v78, v104 offset:80
    s_bitcmp1_b32 s36, 0
    s_cbranch_scc1 K2_FL0_00
    v_pk_fma_f32 v[112:113], v[2:3], v[88:89], v[92:93]
    v_pk_fma_f32 v[88:89], v[88:89], v[80:81], v[88:89]
    v_pk_fma_f32 v[92:93], v[92:93], v[80:81], v[112:113]
    v_pk_fma_f32 v[112:113], v[4:5], v[88:89], v[92:93]
    v_pk_fma_f32 v[88:89], v[88:89], v[82:83], v[88:89]
    v_pk_fma_f32 v[92:93], v[92:93], v[82:83], v[112:113]
    v_pk_fma_f32 v[112:113], v[6:7], v[88:89], v[92:93]
    v_pk_fma_f32 v[88:89], v[88:89], v[84:85], v[88:89]
    v_pk_fma_f32 v[92:93], v[92:93], v[84:85], v[112:113]
K2_RT0_00:
    v_mfma_f32_4x4x4_16b_bf16 v[18:21], v[62:63], v[42:43], v[18:21]
    v_mfma_f32_4x4x4_16b_bf16 v[22:25], v[62:63], v[44:45], v[22:25]
    v_exp_f32 v80, v8
    v_exp_f32 v81, v9
    v_exp_f32 v82, v10
    v_exp_f32 v83, v11
    v_exp_f32 v84, v12
    v_exp_f32 v85, v13
    s_bitcmp1_b32 s36, 3
    s_cbranch_scc1 K2_FL0_03
    v_pk_fma_f32 v[112:113], v[8:9], v[88:89], v[92:93]
    v_pk_fma_f32 v[88:89], v[88:89], v[80:81], v[88:89]
    v_pk_fma_f32 v[92:93], v[92:93], v[80:81], v[112:113]
    v_pk_fma_f32 v[112:113], v[10:11], v[88:89], v[92:93]
    v_pk_fma_f32 v[88:89], v[88:89], v[82:83], v[88:89]
    v_pk_fma_f32 v[92:93], v[92:93], v[82:83], v[112:113]
    v_pk_fma_f32 v[112:113], v[12:13], v[88:89], v[92:93]
    v_pk_fma_f32 v[88:89], v[88:89], v[84:85], v[88:89]
    v_pk_fma_f32 v[92:93], v[92:93], v[84:85], v[112:113]
K2_RT0_03:
    v_mfma_f32_4x4x4_16b_bf16 v[26:29], v[62:63], v[46:47], v[26:29]
    v_mfma_f32_4x4x4_16b_bf16 v[30:33], v[62:63], v[48:49], v[30:33]
    v_exp_f32 v80, v14
    v_exp_f32 v81, v15
    v_exp_f32 v82, v16
    v_exp_f32 v83, v17
    s_waitcnt vmcnt(0)
    ds_read_b64_tr_b16 v[52:53], v102 offset:0
    ds_read_b64_tr_b16 v[34:35], v96 offset:0
    ds_read_b64_tr_b16 v[36:37], v97 offset:512
    ds_read_b64_tr_b16 v[38:39], v96 offset:1024
    ds_read_b64_tr_b16 v[40:41], v97 offset:1536
    ds_read_b64_tr_b16 v[56:57], v102 offset:128
    ds_read_b64_tr_b16 v[42:43], v97 offset:0
    ds_read_b64_tr_b16 v[44:45], v96 offset:512
    ds_read_b64_tr_b16 v[46:47], v97 offset:1024
    ds_read_b64_tr_b16 v[48:49], v96 offset:1536
    s_bitcmp1_b32 s36, 6
    s_cbranch_scc1 K2_FL0_06
    v_pk_fma_f32 v[112:113], v[14:15], v[88:89], v[92:93]
    v_pk_fma_f32 v[88:89], v[88:89], v[80:81], v[88:89]
    v_pk_fma_f32 v[92:93], v[92:93], v[80:81], v[112:113]
    v_pk_fma_f32 v[112:113], v[16:17], v[88:89], v[92:93]
    v_pk_fma_f32 v[88:89], v[88:89], v[82:83], v[88:89]
    v_pk_fma_f32 v[92:93], v[92:93], v[82:83], v[112:113]
K2_RT0_06:
    s_waitcnt lgkmcnt(0)
    v_mfma_f32_32x32x16_bf16 v[2:17], v[58:61], v[50:53], 0
    v_exp_f32 v80, v18
    v_exp_f32 v81, v19
    v_exp_f32 v82, v20
    v_exp_f32 v83, v21
    v_exp_f32 v84, v22
    v_exp_f32 v85, v23
    buffer_load_dwordx4 v[72:73], s[8:11], 0 idxen offen offset:0 sc1 lds
    buffer_load_dwordx4 v[74:75], s[8:11], 0 idxen offen offset:1024 sc1 lds
    s_bitcmp1_b32 s36, 0
    s_cbranch_scc1 K2_FL0_10
    v_pk_fma_f32 v[112:113], v[18:19], v[90:91], v[94:95]
    v_pk_fma_f32 v[90:91], v[90:91], v[80:81], v[90:91]
    v_pk_fma_f32 v[94:95], v[94:95], v[80:81], v[112:113]
    v_pk_fma_f32 v[112:113], v[20:21], v[90:91], v[94:95]
    v_pk_fma_f32 v[90:91], v[90:91], v[82:83], v[90:91]
    v_pk_fma_f32 v[94:95], v[94:95], v[82:83], v[112:113]
    v_pk_fma_f32 v[112:113], v[22:23], v[90:91], v[94:95]
    v_pk_fma_f32 v[90:91], v[90:91], v[84:85], v[90:91]
    v_pk_fma_f32 v[94:95], v[94:95], v[84:85], v[112:113]
K2_RT0_10:
    v_mfma_f32_4x4x4_16b_bf16 v[2:5], v[62:63], v[34:35], v[2:5]
    v_mfma_f32_4x4x4_16b_bf16 v[6:9], v[62:63], v[36:37], v[6:9]
    v_exp_f32 v80, v24
    v_exp_f32 v81, v25
    v_exp_f32 v82, v26
    v_exp_f32 v83, v27
    v_exp_f32 v84, v28
    v_exp_f32 v85, v29
    buffer_load_dwordx4 v[76:77], s[8:11], 0 idxen offen offset:2048 sc1 lds
    buffer_load_dwordx4 v[78:79], s[8:11], 0 idxen offen offset:3072 sc1 lds
    s_bitcmp1_b32 s36, 3
    s_cbranch_scc1 K2_FL0_13
    v_pk_fma_f32 v[112:113], v[24:25], v[90:91], v[94:95]
    v_pk_fma_f32 v[90:91], v[90:91], v[80:81], v[90:91]
    v_pk_fma_f32 v[94:95], v[94:95], v[80:81], v[112:113]
    v_pk_fma_f32 v[112:113], v[26:27], v[90:91], v[94:95]
    v_pk_fma_f32 v[90:91], v[90:91], v[82:83], v[90:91]
    v_pk_fma_f32 v[94:95], v[94:95], v[82:83], v[112:113]
    v_pk_fma_f32 v[112:113], v[28:29], v[90:91], v[94:95]
    v_pk_fma_f32 v[90:91], v[90:91], v[84:85], v[90:91]
    v_pk_fma_f32 v[94:95], v[94:95], v[84:85], v[112:113]
K2_RT0_13:
    v_mfma_f32_4x4x4_16b_bf16 v[10:13], v[62:63], v[38:39], v[10:13]
    v_mfma_f32_4x4x4_16b_bf16 v[14:17], v[62:63], v[40:41], v[14:17]
    v_exp_f32 v80, v30
    v_exp_f32 v81, v31
    v_exp_f32 v82, v32
    v_exp_f32 v83, v33
    ds_read_b32 v103, v100 offset:16
    s_bitcmp1_b32 s36, 6
    s_cbranch_scc1 K2_FL0_16
    v_pk_fma_f32 v[112:113], v[30:31], v[90:91], v[94:95]
    v_pk_fma_f32 v[90:91], v[90:91], v[80:81], v[90:91]
    v_pk_fma_f32 v[94:95], v[94:95], v[80:81], v[112:113]
    v_pk_fma_f32 v[112:113], v[32:33], v[90:91], v[94:95]
    v_pk_fma_f32 v[90:91], v[90:91], v[82:83], v[90:91]
    v_pk_fma_f32 v[94:95], v[94:95], v[82:83], v[112:113]
K2_RT0_16:
K2_POS1:
    s_cbranch_execz K2_TCX
    s_setprio 3
    v_mfma_f32_32x32x16_bf16 v[18:33], v[58:61], v[54:57], 0
    v_exp_f32 v80, v2
    v_exp_f32 v81, v3
    v_exp_f32 v82, v4
    v_exp_f32 v83, v5
    v_exp_f32 v84, v6
    v_exp_f32 v85, v7
    s_waitcnt lgkmcnt(0)
    v_mad_u32_u24 v102, v103, s44, v101
    s_mov_b64 exec, s[42:43]
    ds_read_b128 v[58:61], v99 offset:256
    s_mov_b64 exec, -1
    ds_read_b32 v72, v98 offset:96
    ds_read_b32 v74, v98 offset:112
    ds_read_b32 v76, v104 offset:96
    ds_read_b32 v78, v104 offset:112
    s_bitcmp1_b32 s36, 8
    s_cbranch_scc1 K2_FL1_00
    v_pk_fma_f32 v[112:113], v[2:3], v[88:89], v[92:93]
    v_pk_fma_f32 v[88:89], v[88:89], v[80:81], v[88:89]
    v_pk_fma_f32 v[92:93], v[92:93], v[80:81], v[112:113]
    v_pk_fma_f32 v[112:113], v[4:5], v[88:89], v[92:93]
    v_pk_fma_f32 v[88:89], v[88:89], v[82:83], v[88:89]
    v_pk_fma_f32 v[92:93], v[92:93], v[82:83], v[112:113]
    v_pk_fma_f32 v[112:113], v[6:7], v[88:89], v[92:93]
    v_pk_fma_f32 v[88:89], v[88:89], v[84:85], v[88:89]
    v_pk_fma_f32 v[92:93], v[92:93], v[84:85], v[112:113]
K2_RT1_00:
    v_mfma_f32_4x4x4_16b_bf16 v[18:21], v[62:63], v[42:43], v[18:21]
    v_mfma_f32_4x4x4_16b_bf16 v[22:25], v[62:63], v[44:45], v[22:25]
    v_exp_f32 v80, v8
    v_exp_f32 v81, v9
    v_exp_f32 v82, v10
    v_exp_f32 v83, v11
    v_exp_f32 v84, v12
    v_exp_f32 v85, v13
    s_bitcmp1_b32 s36, 11
    s_cbranch_scc1 K2_FL1_03
    v_pk_fma_f32 v[112:113], v[8:9], v[88:89], v[92:93]
    v_pk_fma_f32 v[88:89], v[88:89], v[80:81], v[88:89]
    v_pk_fma_f32 v[92:93], v[92:93], v[80:81], v[112:113]
    v_pk_fma_f32 v[112:113], v[10:11], v[88:89], v[92:93]
    v_pk_fma_f32 v[88:89], v[88:89], v[82:83], v[88:89]
    v_pk_fma_f32 v[92:93], v[92:93], v[82:83], v[112:113]
    v_pk_fma_f32 v[112:113], v[12:13], v[88:89], v[92:93]
    v_pk_fma_f32 v[88:89], v[88:89], v[84:85], v[88:89]
    v_pk_fma_f32 v[92:93], v[92:93], v[84:85], v[112:113]
K2_RT1_03:
    v_mfma_f32_4x4x4_16b_bf16 v[26:29], v[62:63], v[46:47], v[26:29]
    v_mfma_f32_4x4x4_16b_bf16 v[30:33], v[62:63], v[48:49], v[30:33]
    v_exp_f32 v80, v14
    v_exp_f32 v81, v15
    v_exp_f32 v82, v16
    v_exp_f32 v83, v17
    s_waitcnt vmcnt(0)
    ds_read_b64_tr_b16 v[52:53], v102 offset:0
    ds_read_b64_tr_b16 v[34:35], v96 offset:0
    ds_read_b64_tr_b16 v[36:37], v97 offset:512
    ds_read_b64_tr_b16 v[38:39], v96 offset:1024
    ds_read_b64_tr_b16 v[40:41], v97 offset:1536
    ds_read_b64_tr_b16 v[56:57], v102 offset:128
    ds_read_b64_tr_b16 v[42:43], v97 offset:0
    ds_read_b64_tr_b16 v[44:45], v96 offset:512
    ds_read_b64_tr_b16 v[46:47], v97 offset:1024
    ds_read_b64_tr_b16 v[48:49], v96 offset:1536
    s_bitcmp1_b32 s36, 14
    s_cbranch_scc1 K2_FL1_06
    v_pk_fma_f32 v[112:113], v[14:15], v[88:89], v[92:93]
    v_pk_fma_f32 v[88:89], v[88:89], v[80:81], v[88:89]
    v_pk_fma_f32 v[92:93], v[92:93], v[80:81], v[112:113]
    v_pk_fma_f32 v[112:113], v[16:17], v[88:89], v[92:93]
    v_pk_fma_f32 v[88:89], v[88:89], v[82:83], v[88:89]
    v_pk_fma_f32 v[92:93], v[92:93], v[82:83], v[112:113]
K2_RT1_06:
    s_waitcnt lgkmcnt(0)
    v_mfma_f32_32x32x16_bf16 v[2:17], v[58:61], v[50:53], 0
    v_exp_f32 v80, v18
    v_exp_f32 v81, v19
    v_exp_f32 v82, v20
    v_exp_f32 v83, v21
    v_exp_f32 v84, v22
    v_exp_f32 v85, v23
    buffer_load_dwordx4 v[72:73], s[8:11], 0 idxen offen offset:0 sc1 lds
    buffer_load_dwordx4 v[74:75], s[8:11], 0 idxen offen offset:1024 sc1 lds
    s_bitcmp1_b32 s36, 8
    s_cbranch_scc1 K2_FL1_10
    v_pk_fma_f32 v[112:113], v[18:19], v[90:91], v[94:95]
    v_pk_fma_f32 v[90:91], v[90:91], v[80:81], v[90:91]
    v_pk_fma_f32 v[94:95], v[94:95], v[80:81], v[112:113]
    v_pk_fma_f32 v[112:113], v[20:21], v[90:91], v[94:95]
    v_pk_fma_f32 v[90:91], v[90:91], v[82:83], v[90:91]
    v_pk_fma_f32 v[94:95], v[94:95], v[82:83], v[112:113]
    v_pk_fma_f32 v[112:113], v[22:23], v[90:91], v[94:95]
    v_pk_fma_f32 v[90:91], v[90:91], v[84:85], v[90:91]
    v_pk_fma_f32 v[94:95], v[94:95], v[84:85], v[112:113]
K2_RT1_10:
    v_mfma_f32_4x4x4_16b_bf16 v[2:5], v[62:63], v[34:35], v[2:5]
    v_mfma_f32_4x4x4_16b_bf16 v[6:9], v[62:63], v[36:37], v[6:9]
    v_exp_f32 v80, v24
    v_exp_f32 v81, v25
    v_exp_f32 v82, v26
    v_exp_f32 v83, v27
    v_exp_f32 v84, v28
    v_exp_f32 v85, v29
    buffer_load_dwordx4 v[76:77], s[8:11], 0 idxen offen offset:2048 sc1 lds
    buffer_load_dwordx4 v[78:79], s[8:11], 0 idxen offen offset:3072 sc1 lds
    s_bitcmp1_b32 s36, 11
    s_cbranch_scc1 K2_FL1_13
    v_pk_fma_f32 v[112:113], v[24:25], v[90:91], v[94:95]
    v_pk_fma_f32 v[90:91], v[90:91], v[80:81], v[90:91]
    v_pk_fma_f32 v[94:95], v[94:95], v[80:81], v[112:113]
    v_pk_fma_f32 v[112:113], v[26:27], v[90:91], v[94:95]
    v_pk_fma_f32 v[90:91], v[90:91], v[82:83], v[90:91]
    v_pk_fma_f32 v[94:95], v[94:95], v[82:83], v[112:113]
    v_pk_fma_f32 v[112:113], v[28:29], v[90:91], v[94:95]
    v_pk_fma_f32 v[90:91], v[90:91], v[84:85], v[90:91]
    v_pk_fma_f32 v[94:95], v[94:95], v[84:85], v[112:113]
K2_RT1_13:
    v_mfma_f32_4x4x4_16b_bf16 v[10:13], v[62:63], v[38:39], v[10:13]
    v_mfma_f32_4x4x4_16b_bf16 v[14:17], v[62:63], v[40:41], v[14:17]
    v_exp_f32 v80, v30
    v_exp_f32 v81, v31
    v_exp_f32 v82, v32
    v_exp_f32 v83, v33
    ds_read_b32 v103, v100 offset:24
    s_bitcmp1_b32 s36, 14
    s_cbranch_scc1 K2_FL1_16
    v_pk_fma_f32 v[112:113], v[30:31], v[90:91], v[94:95]
    v_pk_fma_f32 v[90:91], v[90:91], v[80:81], v[90:91]
    v_pk_fma_f32 v[94:95], v[94:95], v[80:81], v[112:113]
    v_pk_fma_f32 v[112:113], v[32:33], v[90:91], v[94:95]
    v_pk_fma_f32 v[90:91], v[90:91], v[82:83], v[90:91]
    v_pk_fma_f32 v[94:95], v[94:95], v[82:83], v[112:113]
K2_RT1_16:
K2_POS2:
    s_setprio 3
    v_mfma_f32_32x32x16_bf16 v[18:33], v[58:61], v[54:57], 0
    v_exp_f32 v80, v2
    v_exp_f32 v81, v3
    v_exp_f32 v82, v4
    v_exp_f32 v83, v5
    v_exp_f32 v84, v6
    v_exp_f32 v85, v7
    s_waitcnt lgkmcnt(0)
    v_mad_u32_u24 v102, v103, s44, v101
    s_mov_b64 exec, s[42:43]
    ds_read_b128 v[58:61], v99 offset:384
    s_mov_b64 exec, -1
    ds_read_b32 v72, v98 offset:128
    ds_read_b32 v74, v98 offset:144
    ds_read_b32 v76, v104 offset:128
    ds_read_b32 v78, v104 offset:144
    s_bitcmp1_b32 s36, 16
    s_cbranch_scc1 K2_FL2_00
    v_pk_fma_f32 v[112:113], v[2:3], v[88:89], v[92:93]
    v_pk_fma_f32 v[88:89], v[88:89], v[80:81], v[88:89]
    v_pk_fma_f32 v[92:93], v[92:93], v[80:81], v[112:113]
    v_pk_fma_f32 v[112:113], v[4:5], v[88:89], v[92:93]
    v_pk_fma_f32 v[88:89], v[88:89], v[82:83], v[88:89]
    v_pk_fma_f32 v[92:93], v[92:93], v[82:83], v[112:113]
    v_pk_fma_f32 v[112:113], v[6:7], v[88:89], v[92:93]
    v_pk_fma_f32 v[88:89], v[88:89], v[84:85], v[88:89]
    v_pk_fma_f32 v[92:93], v[92:93], v[84:85], v[112:113]
K2_RT2_00:
    v_mfma_f32_4x4x4_16b_bf16 v[18:21], v[62:63], v[42:43], v[18:21]
    v_mfma_f32_4x4x4_16b_bf16 v[22:25], v[62:63], v[44:45], v[22:25]
    v_exp_f32 v80, v8
    v_exp_f32 v81, v9
    v_exp_f32 v82, v10
    v_exp_f32 v83, v11
    v_exp_f32 v84, v12
    v_exp_f32 v85, v13
    s_bitcmp1_b32 s36, 19
    s_cbranch_scc1 K2_FL2_03
    v_pk_fma_f32 v[112:113], v[8:9], v[88:89], v[92:93]
    v_pk_fma_f32 v[88:89], v[88:89], v[80:81], v[88:89]
    v_pk_fma_f32 v[92:93], v[92:93], v[80:81], v[112:113]
    v_pk_fma_f32 v[112:113], v[10:11], v[88:89], v[92:93]
    v_pk_fma_f32 v[88:89], v[88:89], v[82:83], v[88:89]
    v_pk_fma_f32 v[92:93], v[92:93], v[82:83], v[112:113]
    v_pk_fma_f32 v[112:113], v[12:13], v[88:89], v[92:93]
    v_pk_fma_f32 v[88:89], v[88:89], v[84:85], v[88:89]
    v_pk_fma_f32 v[92:93], v[92:93], v[84:85], v[112:113]
K2_RT2_03:
    v_mfma_f32_4x4x4_16b_bf16 v[26:29], v[62:63], v[46:47], v[26:29]
    v_mfma_f32_4x4x4_16b_bf16 v[30:33], v[62:63], v[48:49], v[30:33]
    v_exp_f32 v80, v14
    v_exp_f32 v81, v15
    v_exp_f32 v82, v16
    v_exp_f32 v83, v17
    s_waitcnt vmcnt(0)
    ds_read_b64_tr_b16 v[52:53], v102 offset:0
    ds_read_b64_tr_b16 v[34:35], v96 offset:0
    ds_read_b64_tr_b16 v[36:37], v97 offset:512
    ds_read_b64_tr_b16 v[38:39], v96 offset:1024
    ds_read_b64_tr_b16 v[40:41], v97 offset:1536
    ds_read_b64_tr_b16 v[56:57], v102 offset:128
    ds_read_b64_tr_b16 v[42:43], v97 offset:0
    ds_read_b64_tr_b16 v[44:45], v96 offset:512
    ds_read_b64_tr_b16 v[46:47], v97 offset:1024
    ds_read_b64_tr_b16 v[48:49], v96 offset:1536
    s_bitcmp1_b32 s36, 22
    s_cbranch_scc1 K2_FL2_06
    v_pk_fma_f32 v[112:113], v[14:15], v[88:89], v[92:93]
    v_pk_fma_f32 v[88:89], v[88:89], v[80:81], v[88:89]
    v_pk_fma_f32 v[92:93], v[92:93], v[80:81], v[112:113]
    v_pk_fma_f32 v[112:113], v[16:17], v[88:89], v[92:93]
    v_pk_fma_f32 v[88:89], v[88:89], v[82:83], v[88:89]
    v_pk_fma_f32 v[92:93], v[92:93], v[82:83], v[112:113]
K2_RT2_06:
    s_waitcnt lgkmcnt(0)
    v_mfma_f32_32x32x16_bf16 v[2:17], v[58:61], v[50:53], 0
    v_exp_f32 v80, v18
    v_exp_f32 v81, v19
    v_exp_f32 v82, v20
    v_exp_f32 v83, v21
    v_exp_f32 v84, v22
    v_exp_f32 v85, v23
    buffer_load_dwordx4 v[72:73], s[8:11], 0 idxen offen offset:0 sc1 lds
    buffer_load_dwordx4 v[74:75], s[8:11], 0 idxen offen offset:1024 sc1 lds
    s_bitcmp1_b32 s36, 16
    s_cbranch_scc1 K2_FL2_10
    v_pk_fma_f32 v[112:113], v[18:19], v[90:91], v[94:95]
    v_pk_fma_f32 v[90:91], v[90:91], v[80:81], v[90:91]
    v_pk_fma_f32 v[94:95], v[94:95], v[80:81], v[112:113]
    v_pk_fma_f32 v[112:113], v[20:21], v[90:91], v[94:95]
    v_pk_fma_f32 v[90:91], v[90:91], v[82:83], v[90:91]
    v_pk_fma_f32 v[94:95], v[94:95], v[82:83], v[112:113]
    v_pk_fma_f32 v[112:113], v[22:23], v[90:91], v[94:95]
    v_pk_fma_f32 v[90:91], v[90:91], v[84:85], v[90:91]
    v_pk_fma_f32 v[94:95], v[94:95], v[84:85], v[112:113]
K2_RT2_10:
    v_mfma_f32_4x4x4_16b_bf16 v[2:5], v[62:63], v[34:35], v[2:5]
    v_mfma_f32_4x4x4_16b_bf16 v[6:9], v[62:63], v[36:37], v[6:9]
    v_exp_f32 v80, v24
    v_exp_f32 v81, v25
    v_exp_f32 v82, v26
    v_exp_f32 v83, v27
    v_exp_f32 v84, v28
    v_exp_f32 v85, v29
    buffer_load_dwordx4 v[76:77], s[8:11], 0 idxen offen offset:2048 sc1 lds
    buffer_load_dwordx4 v[78:79], s[8:11], 0 idxen offen offset:3072 sc1 lds
    s_bitcmp1_b32 s36, 19
    s_cbranch_scc1 K2_FL2_13
    v_pk_fma_f32 v[112:113], v[24:25], v[90:91], v[94:95]
    v_pk_fma_f32 v[90:91], v[90:91], v[80:81], v[90:91]
    v_pk_fma_f32 v[94:95], v[94:95], v[80:81], v[112:113]
    v_pk_fma_f32 v[112:113], v[26:27], v[90:91], v[94:95]
    v_pk_fma_f32 v[90:91], v[90:91], v[82:83], v[90:91]
    v_pk_fma_f32 v[94:95], v[94:95], v[82:83], v[112:113]
    v_pk_fma_f32 v[112:113], v[28:29], v[90:91], v[94:95]
    v_pk_fma_f32 v[90:91], v[90:91], v[84:85], v[90:91]
    v_pk_fma_f32 v[94:95], v[94:95], v[84:85], v[112:113]
K2_RT2_13:
    v_mfma_f32_4x4x4_16b_bf16 v[10:13], v[62:63], v[38:39], v[10:13]
    v_mfma_f32_4x4x4_16b_bf16 v[14:17], v[62:63], v[40:41], v[14:17]
    v_exp_f32 v80, v30
    v_exp_f32 v81, v31
    v_exp_f32 v82, v32
    v_exp_f32 v83, v33
    ds_read_b32 v103, v100 offset:32
    s_bitcmp1_b32 s36, 22
    s_cbranch_scc1 K2_FL2_16
    v_pk_fma_f32 v[112:113], v[30:31], v[90:91], v[94:95]
    v_pk_fma_f32 v[90:91], v[90:91], v[80:81], v[90:91]
    v_pk_fma_f32 v[94:95], v[94:95], v[80:81], v[112:113]
    v_pk_fma_f32 v[112:113], v[32:33], v[90:91], v[94:95]
    v_pk_fma_f32 v[90:91], v[90:91], v[82:83], v[90:91]
    v_pk_fma_f32 v[94:95], v[94:95], v[82:83], v[112:113]
K2_RT2_16:
K2_POS3:
    s_setprio 3
    v_mfma_f32_32x32x16_bf16 v[18:33], v[58:61], v[54:57], 0
    v_exp_f32 v80, v2
    v_exp_f32 v81, v3
    v_exp_f32 v82, v4
    v_exp_f32 v83, v5
    v_exp_f32 v84, v6
    v_exp_f32 v85, v7
    s_waitcnt lgkmcnt(0)
    v_mad_u32_u24 v102, v103, s44, v101
    s_mov_b64 exec, s[42:43]
    ds_read_b128 v[58:61], v99 offset:512
    s_mov_b64 exec, -1
    ds_read_b32 v72, v98 offset:160
    ds_read_b32 v74, v98 offset:176
    ds_read_b32 v76, v104 offset:160
    ds_read_b32 v78, v104 offset:176
    s_bitcmp1_b32 s36, 24
    s_cbranch_scc1 K2_FL3_00
    v_pk_fma_f32 v[112:113], v[2:3], v[88:89], v[92:93]
    v_pk_fma_f32 v[88:89], v[88:89], v[80:81], v[88:89]
    v_pk_fma_f32 v[92:93], v[92:93], v[80:81], v[112:113]
    v_pk_fma_f32 v[112:113], v[4:5], v[88:89], v[92:93]
    v_pk_fma_f32 v[88:89], v[88:89], v[82:83], v[88:89]
    v_pk_fma_f32 v[92:93], v[92:93], v[82:83], v[112:113]
    v_pk_fma_f32 v[112:113], v[6:7], v[88:89], v[92:93]
    v_pk_fma_f32 v[88:89], v[88:89], v[84:85], v[88:89]
    v_pk_fma_f32 v[92:93], v[92:93], v[84:85], v[112:113]
K2_RT3_00:
    v_mfma_f32_4x4x4_16b_bf16 v[18:21], v[62:63], v[42:43], v[18:21]
    v_mfma_f32_4x4x4_16b_bf16 v[22:25], v[62:63], v[44:45], v[22:25]
    v_exp_f32 v80, v8
    v_exp_f32 v81, v9
    v_exp_f32 v82, v10
    v_exp_f32 v83, v11
    v_exp_f32 v84, v12
    v_exp_f32 v85, v13
    s_bitcmp1_b32 s36, 27
    s_cbranch_scc1 K2_FL3_03
    v_pk_fma_f32 v[112:113], v[8:9], v[88:89], v[92:93]
    v_pk_fma_f32 v[88:89], v[88:89], v[80:81], v[88:89]
    v_pk_fma_f32 v[92:93], v[92:93], v[80:81], v[112:113]
    v_pk_fma_f32 v[112:113], v[10:11], v[88:89], v[92:93]
    v_pk_fma_f32 v[88:89], v[88:89], v[82:83], v[88:89]
    v_pk_fma_f32 v[92:93], v[92:93], v[82:83], v[112:113]
    v_pk_fma_f32 v[112:113], v[12:13], v[88:89], v[92:93]
    v_pk_fma_f32 v[88:89], v[88:89], v[84:85], v[88:89]
    v_pk_fma_f32 v[92:93], v[92:93], v[84:85], v[112:113]
K2_RT3_03:
    v_mfma_f32_4x4x4_16b_bf16 v[26:29], v[62:63], v[46:47], v[26:29]
    v_mfma_f32_4x4x4_16b_bf16 v[30:33], v[62:63], v[48:49], v[30:33]
    v_exp_f32 v80, v14
    v_exp_f32 v81, v15
    v_exp_f32 v82, v16
    v_exp_f32 v83, v17
    s_waitcnt vmcnt(0)
    ds_read_b64_tr_b16 v[52:53], v102 offset:0
    ds_read_b64_tr_b16 v[34:35], v96 offset:0
    ds_read_b64_tr_b16 v[36:37], v97 offset:512
    ds_read_b64_tr_b16 v[38:39], v96 offset:1024
    ds_read_b64_tr_b16 v[40:41], v97 offset:1536
    ds_read_b64_tr_b16 v[56:57], v102 offset:128
    ds_read_b64_tr_b16 v[42:43], v97 offset:0
    ds_read_b64_tr_b16 v[44:45], v96 offset:512
    ds_read_b64_tr_b16 v[46:47], v97 offset:1024
    ds_read_b64_tr_b16 v[48:49], v96 offset:1536
    s_bitcmp1_b32 s36, 30
    s_cbranch_scc1 K2_FL3_06
    v_pk_fma_f32 v[112:113], v[14:15], v[88:89], v[92:93]
    v_pk_fma_f32 v[88:89], v[88:89], v[80:81], v[88:89]
    v_pk_fma_f32 v[92:93], v[92:93], v[80:81], v[112:113]
    v_pk_fma_f32 v[112:113], v[16:17], v[88:89], v[92:93]
    v_pk_fma_f32 v[88:89], v[88:89], v[82:83], v[88:89]
    v_pk_fma_f32 v[92:93], v[92:93], v[82:83], v[112:113]
K2_RT3_06:
    s_setprio 2
    s_waitcnt lgkmcnt(0)
    v_mfma_f32_32x32x16_bf16 v[2:17], v[58:61], v[50:53], 0
    v_exp_f32 v80, v18
    v_exp_f32 v81, v19
    v_exp_f32 v82, v20
    v_exp_f32 v83, v21
    v_exp_f32 v84, v22
    v_exp_f32 v85, v23
    buffer_load_dwordx4 v[72:73], s[8:11], 0 idxen offen offset:0 sc1 lds
    buffer_load_dwordx4 v[74:75], s[8:11], 0 idxen offen offset:1024 sc1 lds
    s_bitcmp1_b32 s36, 24
    s_cbranch_scc1 K2_FL3_10
    v_pk_fma_f32 v[112:113], v[18:19], v[90:91], v[94:95]
    v_pk_fma_f32 v[90:91], v[90:91], v[80:81], v[90:91]
    v_pk_fma_f32 v[94:95], v[94:95], v[80:81], v[112:113]
    v_pk_fma_f32 v[112:113], v[20:21], v[90:91], v[94:95]
    v_pk_fma_f32 v[90:91], v[90:91], v[82:83], v[90:91]
    v_pk_fma_f32 v[94:95], v[94:95], v[82:83], v[112:113]
    v_pk_fma_f32 v[112:113], v[22:23], v[90:91], v[94:95]
    v_pk_fma_f32 v[90:91], v[90:91], v[84:85], v[90:91]
    v_pk_fma_f32 v[94:95], v[94:95], v[84:85], v[112:113]
K2_RT3_10:
    v_mfma_f32_4x4x4_16b_bf16 v[2:5], v[62:63], v[34:35], v[2:5]
    v_mfma_f32_4x4x4_16b_bf16 v[6:9], v[62:63], v[36:37], v[6:9]
    v_exp_f32 v80, v24
    v_exp_f32 v81, v25
    v_exp_f32 v82, v26
    v_exp_f32 v83, v27
    v_exp_f32 v84, v28
    v_exp_f32 v85, v29
    buffer_load_dwordx4 v[76:77], s[8:11], 0 idxen offen offset:2048 sc1 lds
    buffer_load_dwordx4 v[78:79], s[8:11], 0 idxen offen offset:3072 sc1 lds
    s_bitcmp1_b32 s36, 27
    s_cbranch_scc1 K2_FL3_13
    v_pk_fma_f32 v[112:113], v[24:25], v[90:91], v[94:95]
    v_pk_fma_f32 v[90:91], v[90:91], v[80:81], v[90:91]
    v_pk_fma_f32 v[94:95], v[94:95], v[80:81], v[112:113]
    v_pk_fma_f32 v[112:113], v[26:27], v[90:91], v[94:95]
    v_pk_fma_f32 v[90:91], v[90:91], v[82:83], v[90:91]
    v_pk_fma_f32 v[94:95], v[94:95], v[82:83], v[112:113]
    v_pk_fma_f32 v[112:113], v[28:29], v[90:91], v[94:95]
    v_pk_fma_f32 v[90:91], v[90:91], v[84:85], v[90:91]
    v_pk_fma_f32 v[94:95], v[94:95], v[84:85], v[112:113]
K2_RT3_13:
    v_mfma_f32_4x4x4_16b_bf16 v[10:13], v[62:63], v[38:39], v[10:13]
    v_mfma_f32_4x4x4_16b_bf16 v[14:17], v[62:63], v[40:41], v[14:17]
    v_exp_f32 v80, v30
    v_exp_f32 v81, v31
    v_exp_f32 v82, v32
    v_exp_f32 v83, v33
    ds_read_b32 v103, v100 offset:40
    s_bitcmp1_b32 s36, 30
    s_cbranch_scc1 K2_FL3_16
    v_pk_fma_f32 v[112:113], v[30:31], v[90:91], v[94:95]
    v_pk_fma_f32 v[90:91], v[90:91], v[80:81], v[90:91]
    v_pk_fma_f32 v[94:95], v[94:95], v[80:81], v[112:113]
    v_pk_fma_f32 v[112:113], v[32:33], v[90:91], v[94:95]
    v_pk_fma_f32 v[90:91], v[90:91], v[82:83], v[90:91]
    v_pk_fma_f32 v[94:95], v[94:95], v[82:83], v[112:113]
K2_RT3_16:
K2_POS4:
    s_setprio 2
    v_mfma_f32_32x32x16_bf16 v[18:33], v[58:61], v[54:57], 0
    v_exp_f32 v80, v2
    v_exp_f32 v81, v3
    v_exp_f32 v82, v4
    v_exp_f32 v83, v5
    v_exp_f32 v84, v6
    v_exp_f32 v85, v7
    s_waitcnt lgkmcnt(0)
    v_mad_u32_u24 v102, v103, s44, v101
    s_mov_b64 exec, s[42:43]
    ds_read_b128 v[58:61], v99 offset:640
    s_mov_b64 exec, -1
    s_bitcmp1_b32 s37, 0
    s_cbranch_scc1 K2_FL4_00
    v_pk_fma_f32 v[112:113], v[2:3], v[88:89], v[92:93]
    v_pk_fma_f32 v[88:89], v[88:89], v[80:81], v[88:89]
    v_pk_fma_f32 v[92:93], v[92:93], v[80:81], v[112:113]
    v_pk_fma_f32 v[112:113], v[4:5], v[88:89], v[92:93]
    v_pk_fma_f32 v[88:89], v[88:89], v[82:83], v[88:89]
    v_pk_fma_f32 v[92:93], v[92:93], v[82:83], v[112:113]
    v_pk_fma_f32 v[112:113], v[6:7], v[88:89], v[92:93]
    v_pk_fma_f32 v[88:89], v[88:89], v[84:85], v[88:89]
    v_pk_fma_f32 v[92:93], v[92:93], v[84:85], v[112:113]
K2_RT4_00:
    v_mfma_f32_4x4x4_16b_bf16 v[18:21], v[62:63], v[42:43], v[18:21]
    v_mfma_f32_4x4x4_16b_bf16 v[22:25], v[62:63], v[44:45], v[22:25]
    v_exp_f32 v80, v8
    v_exp_f32 v81, v9
    v_exp_f32 v82, v10
    v_exp_f32 v83, v11
    v_exp_f32 v84, v12
    v_exp_f32 v85, v13
    s_bitcmp1_b32 s37, 3
    s_cbranch_scc1 K2_FL4_03
    v_pk_fma_f32 v[112:113], v[8:9], v[88:89], v[92:93]
    v_pk_fma_f32 v[88:89], v[88:89], v[80:81], v[88:89]
    v_pk_fma_f32 v[92:93], v[92:93], v[80:81], v[112:113]
    v_pk_fma_f32 v[112:113], v[10:11], v[88:89], v[92:93]
    v_pk_fma_f32 v[88:89], v[88:89], v[82:83], v[88:89]
    v_pk_fma_f32 v[92:93], v[92:93], v[82:83], v[112:113]
    v_pk_fma_f32 v[112:113], v[12:13], v[88:89], v[92:93]
    v_pk_fma_f32 v[88:89], v[88:89], v[84:85], v[88:89]
    v_pk_fma_f32 v[92:93], v[92:93], v[84:85], v[112:113]
K2_RT4_03:
    v_mfma_f32_4x4x4_16b_bf16 v[26:29], v[62:63], v[46:47], v[26:29]
    v_mfma_f32_4x4x4_16b_bf16 v[30:33], v[62:63], v[48:49], v[30:33]
    v_exp_f32 v80, v14
    v_exp_f32 v81, v15
    v_exp_f32 v82, v16
    v_exp_f32 v83, v17
    s_waitcnt vmcnt(0)
    ds_read_b64_tr_b16 v[52:53], v102 offset:0
    ds_read_b64_tr_b16 v[34:35], v96 offset:0
    ds_read_b64_tr_b16 v[36:37], v97 offset:512
    ds_read_b64_tr_b16 v[38:39], v96 offset:1024
    ds_read_b64_tr_b16 v[40:41], v97 offset:1536
    ds_read_b64_tr_b16 v[56:57], v102 offset:128
    ds_read_b64_tr_b16 v[42:43], v97 offset:0
    ds_read_b64_tr_b16 v[44:45], v96 offset:512
    ds_read_b64_tr_b16 v[46:47], v97 offset:1024
    ds_read_b64_tr_b16 v[48:49], v96 offset:1536
    s_bitcmp1_b32 s37, 6
    s_cbranch_scc1 K2_FL4_06
    v_pk_fma_f32 v[112:113], v[14:15], v[88:89], v[92:93]
    v_pk_fma_f32 v[88:89], v[88:89], v[80:81], v[88:89]
    v_pk_fma_f32 v[92:93], v[92:93], v[80:81], v[112:113]
    v_pk_fma_f32 v[112:113], v[16:17], v[88:89], v[92:93]
    v_pk_fma_f32 v[88:89], v[88:89], v[82:83], v[88:89]
    v_pk_fma_f32 v[92:93], v[92:93], v[82:83], v[112:113]
K2_RT4_06:
    s_setprio 1
    s_waitcnt lgkmcnt(0)
    v_mfma_f32_32x32x16_bf16 v[2:17], v[58:61], v[50:53], 0
    v_exp_f32 v80, v18
    v_exp_f32 v81, v19
    v_exp_f32 v82, v20
    v_exp_f32 v83, v21
    v_exp_f32 v84, v22
    v_exp_f32 v85, v23
    s_bitcmp1_b32 s37, 0
    s_cbranch_scc1 K2_FL4_10
    v_pk_fma_f32 v[112:113], v[18:19], v[90:91], v[94:95]
    v_pk_fma_f32 v[90:91], v[90:91], v[80:81], v[90:91]
    v_pk_fma_f32 v[94:95], v[94:95], v[80:81], v[112:113]
    v_pk_fma_f32 v[112:113], v[20:21], v[90:91], v[94:95]
    v_pk_fma_f32 v[90:91], v[90:91], v[82:83], v[90:91]
    v_pk_fma_f32 v[94:95], v[94:95], v[82:83], v[112:113]
    v_pk_fma_f32 v[112:113], v[22:23], v[90:91], v[94:95]
    v_pk_fma_f32 v[90:91], v[90:91], v[84:85], v[90:91]
    v_pk_fma_f32 v[94:95], v[94:95], v[84:85], v[112:113]
K2_RT4_10:
    v_mfma_f32_4x4x4_16b_bf16 v[2:5], v[62:63], v[34:35], v[2:5]
    v_mfma_f32_4x4x4_16b_bf16 v[6:9], v[62:63], v[36:37], v[6:9]
    v_exp_f32 v80, v24
    v_exp_f32 v81, v25
    v_exp_f32 v82, v26
    v_exp_f32 v83, v27
    v_exp_f32 v84, v28
    v_exp_f32 v85, v29
    s_bitcmp1_b32 s37, 3
    s_cbranch_scc1 K2_FL4_13
    v_pk_fma_f32 v[112:113], v[24:25], v[90:91], v[94:95]
    v_pk_fma_f32 v[90:91], v[90:91], v[80:81], v[90:91]
    v_pk_fma_f32 v[94:95], v[94:95], v[80:81], v[112:113]
    v_pk_fma_f32 v[112:113], v[26:27], v[90:91], v[94:95]
    v_pk_fma_f32 v[90:91], v[90:91], v[82:83], v[90:91]
    v_pk_fma_f32 v[94:95], v[94:95], v[82:83], v[112:113]
    v_pk_fma_f32 v[112:113], v[28:29], v[90:91], v[94:95]
    v_pk_fma_f32 v[90:91], v[90:91], v[84:85], v[90:91]
    v_pk_fma_f32 v[94:95], v[94:95], v[84:85], v[112:113]
K2_RT4_13:
    v_mfma_f32_4x4x4_16b_bf16 v[10:13], v[62:63], v[38:39], v[10:13]
    v_mfma_f32_4x4x4_16b_bf16 v[14:17], v[62:63], v[40:41], v[14:17]
    v_exp_f32 v80, v30
    v_exp_f32 v81, v31
    v_exp_f32 v82, v32
    v_exp_f32 v83, v33
    s_bitcmp1_b32 s37, 6
    s_cbranch_scc1 K2_FL4_16
    v_pk_fma_f32 v[112:113], v[30:31], v[90:91], v[94:95]
    v_pk_fma_f32 v[90:91], v[90:91], v[80:81], v[90:91]
    v_pk_fma_f32 v[94:95], v[94:95], v[80:81], v[112:113]
    v_pk_fma_f32 v[112:113], v[32:33], v[90:91], v[94:95]
    v_pk_fma_f32 v[90:91], v[90:91], v[82:83], v[90:91]
    v_pk_fma_f32 v[94:95], v[94:95], v[82:83], v[112:113]
K2_RT4_16:
K2_POS5:
    s_setprio 1
    v_mfma_f32_32x32x16_bf16 v[18:33], v[58:61], v[54:57], 0
    v_exp_f32 v80, v2
    v_exp_f32 v81, v3
    v_exp_f32 v82, v4
    v_exp_f32 v83, v5
    v_exp_f32 v84, v6
    v_exp_f32 v85, v7
    s_bitcmp1_b32 s37, 8
    s_cbranch_scc1 K2_FL5_00
    v_pk_fma_f32 v[112:113], v[2:3], v[88:89], v[92:93]
    v_pk_fma_f32 v[88:89], v[88:89], v[80:81], v[88:89]
    v_pk_fma_f32 v[92:93], v[92:93], v[80:81], v[112:113]
    v_pk_fma_f32 v[112:113], v[4:5], v[88:89], v[92:93]
    v_pk_fma_f32 v[88:89], v[88:89], v[82:83], v[88:89]
    v_pk_fma_f32 v[92:93], v[92:93], v[82:83], v[112:113]
    v_pk_fma_f32 v[112:113], v[6:7], v[88:89], v[92:93]
    v_pk_fma_f32 v[88:89], v[88:89], v[84:85], v[88:89]
    v_pk_fma_f32 v[92:93], v[92:93], v[84:85], v[112:113]
K2_RT5_00:
    v_mfma_f32_4x4x4_16b_bf16 v[18:21], v[62:63], v[42:43], v[18:21]
    v_mfma_f32_4x4x4_16b_bf16 v[22:25], v[62:63], v[44:45], v[22:25]
    v_exp_f32 v80, v8
    v_exp_f32 v81, v9
    v_exp_f32 v82, v10
    v_exp_f32 v83, v11
    v_exp_f32 v84, v12
    v_exp_f32 v85, v13
    s_bitcmp1_b32 s37, 11
    s_cbranch_scc1 K2_FL5_03
    v_pk_fma_f32 v[112:113], v[8:9], v[88:89], v[92:93]
    v_pk_fma_f32 v[88:89], v[88:89], v[80:81], v[88:89]
    v_pk_fma_f32 v[92:93], v[92:93], v[80:81], v[112:113]
    v_pk_fma_f32 v[112:113], v[10:11], v[88:89], v[92:93]
    v_pk_fma_f32 v[88:89], v[88:89], v[82:83], v[88:89]
    v_pk_fma_f32 v[92:93], v[92:93], v[82:83], v[112:113]
    v_pk_fma_f32 v[112:113], v[12:13], v[88:89], v[92:93]
    v_pk_fma_f32 v[88:89], v[88:89], v[84:85], v[88:89]
    v_pk_fma_f32 v[92:93], v[92:93], v[84:85], v[112:113]
K2_RT5_03:
    v_mfma_f32_4x4x4_16b_bf16 v[26:29], v[62:63], v[46:47], v[26:29]
    v_mfma_f32_4x4x4_16b_bf16 v[30:33], v[62:63], v[48:49], v[30:33]
    v_exp_f32 v80, v14
    v_exp_f32 v81, v15
    v_exp_f32 v82, v16
    v_exp_f32 v83, v17
    s_cmp_eq_u32 s28, 0
    s_cbranch_scc1 K2_NOE
    v_lshlrev_b32 v112, 4, v1
    s_add_u32 s45, s53, 32768
    s_add_u32 s46, s45, 32768
    buffer_load_dwordx4 v[34:37], v112, s[16:19], s45 offen offset:0 sc1
    buffer_load_dwordx4 v[38:41], v112, s[16:19], s45 offen offset:1024 sc1
    buffer_load_dwordx4 v[42:45], v112, s[16:19], s45 offen offset:2048 sc1
    buffer_load_dwordx4 v[46:49], v112, s[16:19], s45 offen offset:3072 sc1
    buffer_load_dwordx4 v[50:53], v112, s[16:19], s46 offen offset:0 sc1
    buffer_load_dwordx4 v[54:57], v112, s[16:19], s46 offen offset:1024 sc1
    buffer_load_dwordx4 v[58:61], v112, s[16:19], s46 offen offset:2048 sc1
    buffer_load_dwordx4 v[62:65], v112, s[16:19], s46 offen offset:3072 sc1
    s_mov_b32 s39, 1
K2_NOE:
    v_pk_fma_f32 v[112:113], v[14:15], v[88:89], v[92:93]
    v_pk_fma_f32 v[88:89], v[88:89], v[80:81], v[88:89]
    v_pk_fma_f32 v[92:93], v[92:93], v[80:81], v[112:113]
    s_bitcmp1_b32 s41, 14
    s_cbranch_scc0 K2_NF5_060
    v_rcp_f32 v106, v88
    v_fma_f32 v118, |v92|, s63, v118
    v_mov_b32 v88, 1.0
    v_mul_f32 v106, v92, v106
    v_mov_b32 v92, 0
    v_cvt_f64_f32 v[106:107], v106
    ds_add_f64 v114, v[106:107] offset:0
    v_add_u32 v114, 1024, v114
K2_NF5_060:
    s_bitcmp1_b32 s65, 14
    s_cbranch_scc0 K2_NF5_061
    v_rcp_f32 v106, v89
    v_fma_f32 v118, |v93|, s63, v118
    v_mov_b32 v89, 1.0
    v_mul_f32 v106, v93, v106
    v_mov_b32 v93, 0
    v_cvt_f64_f32 v[106:107], v106
    ds_add_f64 v116, v[106:107] offset:0
    v_add_u32 v116, 1024, v116
K2_NF5_061:
    v_pk_fma_f32 v[112:113], v[16:17], v[88:89], v[92:93]
    v_pk_fma_f32 v[88:89], v[88:89], v[82:83], v[88:89]
    v_pk_fma_f32 v[92:93], v[92:93], v[82:83], v[112:113]
    s_bitcmp1_b32 s41, 15
    s_cbranch_scc0 K2_NF5_070
    v_rcp_f32 v106, v88
    v_fma_f32 v118, |v92|, s63, v118
    v_mul_f32 v106, v92, v106
    v_cvt_f64_f32 v[106:107], v106
    ds_add_f64 v114, v[106:107] offset:0
K2_NF5_070:
    s_bitcmp1_b32 s65, 15
    s_cbranch_scc0 K2_NF5_071
    v_rcp_f32 v106, v89
    v_fma_f32 v118, |v93|, s63, v118
    v_mul_f32 v106, v93, v106
    v_cvt_f64_f32 v[106:107], v106
    ds_add_f64 v116, v[106:107] offset:0
K2_NF5_071:
    s_setprio 0
    v_exp_f32 v80, v18
    v_exp_f32 v81, v19
    v_exp_f32 v82, v20
    v_exp_f32 v83, v21
    v_exp_f32 v84, v22
    v_exp_f32 v85, v23
    s_bitcmp1_b32 s37, 8
    s_cbranch_scc1 K2_FL5_10
    v_pk_fma_f32 v[112:113], v[18:19], v[90:91], v[94:95]
    v_pk_fma_f32 v[90:91], v[90:91], v[80:81], v[90:91]
    v_pk_fma_f32 v[94:95], v[94:95], v[80:81], v[112:113]
    v_pk_fma_f32 v[112:113], v[20:21], v[90:91], v[94:95]
    v_pk_fma_f32 v[90:91], v[90:91], v[82:83], v[90:91]
    v_pk_fma_f32 v[94:95], v[94:95], v[82:83], v[112:113]
    v_pk_fma_f32 v[112:113], v[22:23], v[90:91], v[94:95]
    v_pk_fma_f32 v[90:91], v[90:91], v[84:85], v[90:91]
    v_pk_fma_f32 v[94:95], v[94:95], v[84:85], v[112:113]
K2_RT5_10:
    v_exp_f32 v80, v24
    v_exp_f32 v81, v25
    v_exp_f32 v82, v26
    v_exp_f32 v83, v27
    v_exp_f32 v84, v28
    v_exp_f32 v85, v29
    s_bitcmp1_b32 s37, 11
    s_cbranch_scc1 K2_FL5_13
    v_pk_fma_f32 v[112:113], v[24:25], v[90:91], v[94:95]
    v_pk_fma_f32 v[90:91], v[90:91], v[80:81], v[90:91]
    v_pk_fma_f32 v[94:95], v[94:95], v[80:81], v[112:113]
    v_pk_fma_f32 v[112:113], v[26:27], v[90:91], v[94:95]
    v_pk_fma_f32 v[90:91], v[90:91], v[82:83], v[90:91]
    v_pk_fma_f32 v[94:95], v[94:95], v[82:83], v[112:113]
    v_pk_fma_f32 v[112:113], v[28:29], v[90:91], v[94:95]
    v_pk_fma_f32 v[90:91], v[90:91], v[84:85], v[90:91]
    v_pk_fma_f32 v[94:95], v[94:95], v[84:85], v[112:113]
K2_RT5_13:
    v_exp_f32 v80, v30
    v_exp_f32 v81, v31
    v_exp_f32 v82, v32
    v_exp_f32 v83, v33
    v_pk_fma_f32 v[112:113], v[30:31], v[90:91], v[94:95]
    v_pk_fma_f32 v[90:91], v[90:91], v[80:81], v[90:91]
    v_pk_fma_f32 v[94:95], v[94:95], v[80:81], v[112:113]
    s_bitcmp1_b32 s41, 14
    s_cbranch_scc0 K2_NF5_160
    v_rcp_f32 v106, v90
    v_fma_f32 v118, |v94|, s63, v118
    v_mov_b32 v90, 1.0
    v_mul_f32 v106, v94, v106
    v_mov_b32 v94, 0
    v_cvt_f64_f32 v[106:107], v106
    ds_add_f64 v115, v[106:107] offset:512
    v_add_u32 v115, 1024, v115
K2_NF5_160:
    s_bitcmp1_b32 s65, 14
    s_cbranch_scc0 K2_NF5_161
    v_rcp_f32 v106, v91
    v_fma_f32 v118, |v95|, s63, v118
    v_mov_b32 v91, 1.0
    v_mul_f32 v106, v95, v106
    v_mov_b32 v95, 0
    v_cvt_f64_f32 v[106:107], v106
    ds_add_f64 v117, v[106:107] offset:512
    v_add_u32 v117, 1024, v117
K2_NF5_161:
    v_pk_fma_f32 v[112:113], v[32:33], v[90:91], v[94:95]
    v_pk_fma_f32 v[90:91], v[90:91], v[82:83], v[90:91]
    v_pk_fma_f32 v[94:95], v[94:95], v[82:83], v[112:113]
    s_bitcmp1_b32 s41, 15
    s_cbranch_scc0 K2_NF5_170
    v_rcp_f32 v106, v90
    v_fma_f32 v118, |v94|, s63, v118
    v_mul_f32 v106, v94, v106
    v_cvt_f64_f32 v[106:107], v106
    ds_add_f64 v115, v[106:107] offset:512
K2_NF5_170:
    s_bitcmp1_b32 s65, 15
    s_cbranch_scc0 K2_NF5_171
    v_rcp_f32 v106, v91
    v_fma_f32 v118, |v95|, s63, v118
    v_mul_f32 v106, v95, v106
    v_cvt_f64_f32 v[106:107], v106
    ds_add_f64 v117, v[106:107] offset:512
K2_NF5_171:
K2_REND:
    v_cmp_ngt_f32 vcc, 0x7f800000, v118
    s_cbranch_vccnz K2_BADM
K2_BADMX:
    s_cmp_eq_u32 s28, 0
    s_cbranch_scc1 K2_MORE
K2_FIN:
    s_cmp_lg_u32 s54, 0
    s_cbranch_scc1 K2_BAD
K2_BADX:
    s_cmp_lg_u32 s39, 0
    s_cbranch_scc1 K2_F0
    v_lshlrev_b32 v112, 4, v1
    s_add_u32 s45, s53, 32768
    s_add_u32 s46, s45, 32768
    buffer_load_dwordx4 v[34:37], v112, s[16:19], s45 offen offset:0 sc1
    buffer_load_dwordx4 v[38:41], v112, s[16:19], s45 offen offset:1024 sc1
    buffer_load_dwordx4 v[42:45], v112, s[16:19], s45 offen offset:2048 sc1
    buffer_load_dwordx4 v[46:49], v112, s[16:19], s45 offen offset:3072 sc1
    buffer_load_dwordx4 v[50:53], v112, s[16:19], s46 offen offset:0 sc1
    buffer_load_dwordx4 v[54:57], v112, s[16:19], s46 offen offset:1024 sc1
    buffer_load_dwordx4 v[58:61], v112, s[16:19], s46 offen offset:2048 sc1
    buffer_load_dwordx4 v[62:65], v112, s[16:19], s46 offen offset:3072 sc1
K2_F0:
    s_lshl4_add_u32 s51, s2, s32
    s_cmp_eq_u32 s51, 4080
    s_cbranch_scc1 K2_EPO
K2_EPOX:
    s_mov_b32 s46, 0xbf317218
    s_mov_b32 s47, 0xbf317218
    v_mov_b32 v117, 0
    s_cmp_ge_u32 s32, 8
    s_cbranch_scc1 K2_F1
    ds_read_b128 v[2:5], v124 offset:0
    ds_read_b128 v[6:9], v124 offset:4096
    ds_read_b128 v[10:13], v125 offset:0
    ds_read_b128 v[14:17], v125 offset:4096
    ds_read_b128 v[18:21], v126 offset:0
    ds_read_b128 v[22:25], v126 offset:4096
    ds_read_b128 v[26:29], v127 offset:0
    ds_read_b128 v[30:33], v127 offset:4096
    v_add_u32 v112, 65536, v66
    s_waitcnt vmcnt(7) lgkmcnt(6)
    v_mfma_f32_16x16x32_bf16 v[84:87], v[34:37], v[2:5], 0
    v_mfma_f32_16x16x32_bf16 v[88:91], v[34:37], v[6:9], 0
    s_waitcnt vmcnt(6) lgkmcnt(4)
    v_mfma_f32_16x16x32_bf16 v[84:87], v[38:41], v[10:13], v[84:87]
    v_mfma_f32_16x16x32_bf16 v[88:91], v[38:41], v[14:17], v[88:91]
    s_waitcnt vmcnt(5) lgkmcnt(2)
    v_mfma_f32_16x16x32_bf16 v[84:87], v[42:45], v[18:21], v[84:87]
    v_mfma_f32_16x16x32_bf16 v[88:91], v[42:45], v[22:25], v[88:91]
    s_waitcnt vmcnt(4) lgkmcnt(0)
    v_mfma_f32_16x16x32_bf16 v[84:87], v[46:49], v[26:29], v[84:87]
    v_mfma_f32_16x16x32_bf16 v[88:91], v[46:49], v[30:33], v[88:91]
K2_F1:
    s_waitcnt lgkmcnt(0)
    s_barrier
    ds_read_b32 v117, v117 offset:260
    ds_read_b128 v[96:99], v66 offset:32768
    ds_read_b128 v[100:103], v66 offset:49152
    s_cbranch_scc1 K2_F2
    ds_read_b128 v[104:107], v112
    s_waitcnt lgkmcnt(1)
    v_cmp_ne_u32 vcc, 0, v117
    v_cvt_f32_f64 v96, v[96:97]
    v_cvt_f32_f64 v97, v[98:99]
    v_pk_mul_f32 v[96:97], v[96:97], s[46:47]
    v_cvt_pk_bf16_f32 v96, v96, v97
    ds_write_b32 v67, v96 offset:0
    v_cvt_f32_f64 v100, v[100:101]
    v_cvt_f32_f64 v101, v[102:103]
    v_pk_mul_f32 v[100:101], v[100:101], s[46:47]
    v_cvt_pk_bf16_f32 v100, v100, v101
    ds_write_b32 v67, v100 offset:4096
    s_waitcnt lgkmcnt(2)
    v_cvt_f32_f64 v104, v[104:105]
    v_cvt_f32_f64 v105, v[106:107]
    v_pk_mul_f32 v[104:105], v[104:105], s[46:47]
    v_cvt_pk_bf16_f32 v104, v104, v105
    ds_write_b32 v67, v104 offset:8192
    s_cbranch_vccnz K2_REDO
    s_mov_b32 s46, 0xbfb8aa3b
    s_mov_b32 s47, 0xbfb8aa3b
    s_cmp_eq_u32 s51, 4080
    s_waitcnt vmcnt(1) lgkmcnt(0)
    s_cbranch_scc1 K2_E2
    s_waitcnt vmcnt(0)
K2_E2:
    s_barrier
    ds_read_b128 v[2:5], v124 offset:10240
    ds_read_b128 v[6:9], v125 offset:10240
    ds_read_b128 v[10:13], v126 offset:10240
    ds_read_b128 v[14:17], v127 offset:10240
    ds_read_b128 v[18:21], v124 offset:14336
    ds_read_b128 v[22:25], v125 offset:14336
    ds_read_b128 v[26:29], v126 offset:14336
    ds_read_b128 v[30:33], v127 offset:14336
    s_waitcnt lgkmcnt(4)
    v_mfma_f32_16x16x32_bf16 v[84:87], v[50:53], v[2:5], v[84:87]
    v_mfma_f32_16x16x32_bf16 v[84:87], v[54:57], v[6:9], v[84:87]
    v_mfma_f32_16x16x32_bf16 v[84:87], v[58:61], v[10:13], v[84:87]
    v_mfma_f32_16x16x32_bf16 v[84:87], v[62:65], v[14:17], v[84:87]
    s_waitcnt lgkmcnt(0)
    v_mfma_f32_16x16x32_bf16 v[88:91], v[50:53], v[18:21], v[88:91]
    v_mfma_f32_16x16x32_bf16 v[88:91], v[54:57], v[22:25], v[88:91]
    v_mfma_f32_16x16x32_bf16 v[88:91], v[58:61], v[26:29], v[88:91]
    v_mfma_f32_16x16x32_bf16 v[88:91], v[62:65], v[30:33], v[88:91]
    s_nop 3
    v_pk_mul_f32 v[2:3], v[84:85], s[46:47]
    v_pk_mul_f32 v[4:5], v[86:87], s[46:47]
    v_exp_f32 v2, v2
    v_exp_f32 v3, v3
    v_exp_f32 v4, v4
    v_exp_f32 v5, v5
    s_nop 0
    v_pk_add_f32 v[2:3], v[2:3], 1.0 op_sel_hi:[1,0]
    v_pk_add_f32 v[4:5], v[4:5], 1.0 op_sel_hi:[1,0]
    v_rcp_f32 v2, v2
    v_rcp_f32 v3, v3
    v_rcp_f32 v4, v4
    v_rcp_f32 v5, v5
    v_pk_mul_f32 v[18:19], v[88:89], s[46:47]
    v_pk_mul_f32 v[20:21], v[90:91], s[46:47]
    v_exp_f32 v18, v18
    v_exp_f32 v19, v19
    v_exp_f32 v20, v20
    v_exp_f32 v21, v21
    v_pk_mul_f32 v[2:3], v[2:3], v[84:85]
    v_pk_mul_f32 v[4:5], v[4:5], v[86:87]
    v_cvt_pk_bf16_f32 v2, v2, v3
    v_cvt_pk_bf16_f32 v3, v4, v5
    ds_write_b64 v68, v[2:3] offset:0
    v_pk_add_f32 v[18:19], v[18:19], 1.0 op_sel_hi:[1,0]
    v_pk_add_f32 v[20:21], v[20:21], 1.0 op_sel_hi:[1,0]
    v_rcp_f32 v18, v18
    v_rcp_f32 v19, v19
    v_rcp_f32 v20, v20
    v_rcp_f32 v21, v21
    s_nop 0
    v_pk_mul_f32 v[18:19], v[18:19], v[88:89]
    v_pk_mul_f32 v[20:21], v[20:21], v[90:91]
    v_cvt_pk_bf16_f32 v18, v18, v19
    v_cvt_pk_bf16_f32 v19, v20, v21
    ds_write_b64 v68, v[18:19] offset:4352
    s_branch K2_F3
K2_F2:
    ds_read_b128 v[18:21], v124 offset:8192
    ds_read_b128 v[22:25], v125 offset:8192
    ds_read_b128 v[26:29], v126 offset:8192
    ds_read_b128 v[30:33], v127 offset:8192
    s_waitcnt lgkmcnt(4)
    v_cmp_ne_u32 vcc, 0, v117
    v_cvt_f32_f64 v96, v[96:97]
    v_cvt_f32_f64 v97, v[98:99]
    v_pk_mul_f32 v[96:97], v[96:97], s[46:47]
    v_cvt_pk_bf16_f32 v96, v96, v97
    ds_write_b32 v67, v96 offset:0
    v_cvt_f32_f64 v100, v[100:101]
    v_cvt_f32_f64 v101, v[102:103]
    v_pk_mul_f32 v[100:101], v[100:101], s[46:47]
    v_cvt_pk_bf16_f32 v100, v100, v101
    ds_write_b32 v67, v100 offset:4096
    s_waitcnt vmcnt(4) lgkmcnt(2)
    v_mfma_f32_16x16x32_bf16 v[84:87], v[34:37], v[18:21], 0
    v_mfma_f32_16x16x32_bf16 v[84:87], v[38:41], v[22:25], v[84:87]
    v_mfma_f32_16x16x32_bf16 v[84:87], v[42:45], v[26:29], v[84:87]
    v_mfma_f32_16x16x32_bf16 v[84:87], v[46:49], v[30:33], v[84:87]
    s_cbranch_vccnz K2_REDO
    s_mov_b32 s46, 0xbfb8aa3b
    s_mov_b32 s47, 0xbfb8aa3b
    s_waitcnt vmcnt(0) lgkmcnt(0)
    s_barrier
    ds_read_b128 v[2:5], v124 offset:18432
    ds_read_b128 v[6:9], v125 offset:18432
    ds_read_b128 v[10:13], v126 offset:18432
    ds_read_b128 v[14:17], v127 offset:18432
    s_waitcnt lgkmcnt(0)
    v_mfma_f32_16x16x32_bf16 v[84:87], v[50:53], v[2:5], v[84:87]
    v_mfma_f32_16x16x32_bf16 v[84:87], v[54:57], v[6:9], v[84:87]
    v_mfma_f32_16x16x32_bf16 v[84:87], v[58:61], v[10:13], v[84:87]
    v_mfma_f32_16x16x32_bf16 v[84:87], v[62:65], v[14:17], v[84:87]
    s_nop 7
    v_pk_mul_f32 v[2:3], v[84:85], s[46:47]
    v_pk_mul_f32 v[4:5], v[86:87], s[46:47]
    v_exp_f32 v2, v2
    v_exp_f32 v3, v3
    v_exp_f32 v4, v4
    v_exp_f32 v5, v5
    s_nop 0
    v_pk_add_f32 v[2:3], v[2:3], 1.0 op_sel_hi:[1,0]
    v_pk_add_f32 v[4:5], v[4:5], 1.0 op_sel_hi:[1,0]
    v_rcp_f32 v2, v2
    v_rcp_f32 v3, v3
    v_rcp_f32 v4, v4
    v_rcp_f32 v5, v5
    s_nop 0
    v_pk_mul_f32 v[2:3], v[2:3], v[84:85]
    v_pk_mul_f32 v[4:5], v[4:5], v[86:87]
    v_cvt_pk_bf16_f32 v2, v2, v3
    v_cvt_pk_bf16_f32 v3, v4, v5
    ds_write_b64 v68, v[2:3] offset:0
K2_F3:
    s_lshl_b32 s45, s34, 4
    v_cmp_gt_u32 vcc, s45, v0
    s_lshl_b32 s45, s33, 8
    s_waitcnt lgkmcnt(0)
    s_barrier
    s_mov_b64 exec, vcc
    s_cbranch_execz K2_XW
    ds_read_b128 v[2:5], v69
    s_waitcnt lgkmcnt(0)
    buffer_store_dwordx4 v[2:5], v66, s[24:27], s45 offen sc0 sc1
K2_XW:
K2_END:
    s_endpgm
K2_TABW:
    s_sub_u32 s51, s51, 1
    s_cbranch_scc1 K2_TABT
    s_sleep 2
    s_mov_b64 exec, vcc
    buffer_load_dwordx2 v[10:11], v64, s[12:15], s29 offen sc1
    s_mov_b64 exec, -1
    s_branch K2_TABP
K2_TABT:
    v_cndmask_b32 v10, v10, 0, vcc
    s_branch K2_TABX
K1_BA:
    v_mov_b32 v4, 252
    v_mov_b32 v5, 0x1000000
    s_mov_b64 exec, 1
    ds_add_u32 v4, v5
    s_branch K1_BX
K2_RECW:
    s_sub_u32 s51, s51, 1
    s_cbranch_scc1 K2_RECT
    s_sleep 2
    s_mov_b64 exec, vcc
    buffer_load_dwordx4 v[2:5], v30, s[16:19], s45 offen sc1
    v_lshlrev_b32 v33, 1, v30
    s_mov_b64 exec, s[30:31]
    s_branch K2_RECP
K2_RECT:
    v_cndmask_b32 v32, v32, 0, vcc
    s_branch K2_RECY
K2_EW:
    s_cmp_eq_u32 s28, 0
    s_cbranch_scc1 K2_EX
    s_sub_u32 s51, s51, 1
    s_cbranch_scc1 K2_ET
    s_sleep 2
    s_cmp_eq_u32 s28, 0
    s_cbranch_scc1 K2_CEw
    s_mov_b32 s46, 11534336
    s_mov_b64 exec, s[30:31]
    buffer_load_dwordx4 v[18:21], v33, s[16:19], s46 offen sc1
    buffer_load_dwordx4 v[22:25], v33, s[16:19], s46 offen offset:16 sc1
    s_mov_b64 exec, -1
K2_CEw:
    s_branch K2_ES
K2_ET:
    s_mov_b32 s54, 1
    s_branch K2_EX
K2_PFB:
    s_mov_b32 s51, 131072
K2_PFP:
    s_waitcnt vmcnt(0)
    v_cmp_ne_u64 vcc, s[70:71], v[34:35]
    v_cmp_ne_u64 s[40:41], s[70:71], v[36:37]
    s_or_b64 vcc, vcc, s[40:41]
    s_cbranch_scc0 K2_PFBX
    s_sub_u32 s51, s51, 1
    s_cbranch_scc1 K2_PFBX
    s_sleep 2
    s_mov_b64 exec, vcc
    buffer_load_dwordx4 v[34:37], v38, s[16:19], 0 offen sc1
    s_mov_b64 exec, -1
    s_branch K2_PFP
K2_PFBn:
    s_mov_b32 s51, 131072
K2_PFPn:
    s_waitcnt vmcnt(0)
    v_cmp_ne_u64 vcc, s[70:71], v[34:35]
    v_cmp_ne_u64 s[40:41], s[70:71], v[36:37]
    s_or_b64 vcc, vcc, s[40:41]
    s_cbranch_scc0 K2_PFBXn
    s_sub_u32 s51, s51, 1
    s_cbranch_scc1 K2_PFBXn
    s_sleep 2
    s_mov_b64 exec, vcc
    buffer_load_dwordx4 v[34:37], v38, s[16:19], 0 offen sc1
    s_mov_b64 exec, -1
    s_branch K2_PFPn
K2_EPO:
    v_mov_b32 v114, s70
    v_mov_b32 v115, s71
    s_mov_b64 exec, 1
    buffer_store_dwordx2 v[114:115], off, s[16:19], 0 sc0 sc1
    s_mov_b64 exec, -1
    s_branch K2_EPOX
K2_TCH:
    s_mov_b64 exec, 0
    s_cmp_eq_u32 s3, 0
    s_cbranch_scc1 K2_POS1
K2_TCX:
    s_mov_b64 exec, -1
    s_branch K2_C1s
K2_FL0_00:
    v_pk_fma_f32 v[112:113], v[2:3], v[88:89], v[92:93]
    v_pk_fma_f32 v[88:89], v[88:89], v[80:81], v[88:89]
    v_pk_fma_f32 v[92:93], v[92:93], v[80:81], v[112:113]
    s_bitcmp1_b32 s40, 0
    s_cbranch_scc0 K2_NF0_000
    v_rcp_f32 v106, v88
    v_fma_f32 v118, |v92|, s63, v118
    v_mov_b32 v88, 1.0
    v_mul_f32 v106, v92, v106
    v_mov_b32 v92, 0
    v_cvt_f64_f32 v[106:107], v106
    ds_add_f64 v114, v[106:107] offset:0
    v_add_u32 v114, 1024, v114
K2_NF0_000:
    s_bitcmp1_b32 s64, 0
    s_cbranch_scc0 K2_NF0_001
    v_rcp_f32 v106, v89
    v_fma_f32 v118, |v93|, s63, v118
    v_mov_b32 v89, 1.0
    v_mul_f32 v106, v93, v106
    v_mov_b32 v93, 0
    v_cvt_f64_f32 v[106:107], v106
    ds_add_f64 v116, v[106:107] offset:0
    v_add_u32 v116, 1024, v116
K2_NF0_001:
    v_pk_fma_f32 v[112:113], v[4:5], v[88:89], v[92:93]
    v_pk_fma_f32 v[88:89], v[88:89], v[82:83], v[88:89]
    v_pk_fma_f32 v[92:93], v[92:93], v[82:83], v[112:113]
    s_bitcmp1_b32 s40, 1
    s_cbranch_scc0 K2_NF0_010
    v_rcp_f32 v106, v88
    v_fma_f32 v118, |v92|, s63, v118
    v_mov_b32 v88, 1.0
    v_mul_f32 v106, v92, v106
    v_mov_b32 v92, 0
    v_cvt_f64_f32 v[106:107], v106
    ds_add_f64 v114, v[106:107] offset:0
    v_add_u32 v114, 1024, v114
K2_NF0_010:
    s_bitcmp1_b32 s64, 1
    s_cbranch_scc0 K2_NF0_011
    v_rcp_f32 v106, v89
    v_fma_f32 v118, |v93|, s63, v118
    v_mov_b32 v89, 1.0
    v_mul_f32 v106, v93, v106
    v_mov_b32 v93, 0
    v_cvt_f64_f32 v[106:107], v106
    ds_add_f64 v116, v[106:107] offset:0
    v_add_u32 v116, 1024, v116
K2_NF0_011:
    v_pk_fma_f32 v[112:113], v[6:7], v[88:89], v[92:93]
    v_pk_fma_f32 v[88:89], v[88:89], v[84:85], v[88:89]
    v_pk_fma_f32 v[92:93], v[92:93], v[84:85], v[112:113]
    s_bitcmp1_b32 s40, 2
    s_cbranch_scc0 K2_NF0_020
    v_rcp_f32 v106, v88
    v_fma_f32 v118, |v92|, s63, v118
    v_mov_b32 v88, 1.0
    v_mul_f32 v106, v92, v106
    v_mov_b32 v92, 0
    v_cvt_f64_f32 v[106:107], v106
    ds_add_f64 v114, v[106:107] offset:0
    v_add_u32 v114, 1024, v114
K2_NF0_020:
    s_bitcmp1_b32 s64, 2
    s_cbranch_scc0 K2_NF0_021
    v_rcp_f32 v106, v89
    v_fma_f32 v118, |v93|, s63, v118
    v_mov_b32 v89, 1.0
    v_mul_f32 v106, v93, v106
    v_mov_b32 v93, 0
    v_cvt_f64_f32 v[106:107], v106
    ds_add_f64 v116, v[106:107] offset:0
    v_add_u32 v116, 1024, v116
K2_NF0_021:
    s_branch K2_RT0_00
K2_FL0_03:
    v_pk_fma_f32 v[112:113], v[8:9], v[88:89], v[92:93]
    v_pk_fma_f32 v[88:89], v[88:89], v[80:81], v[88:89]
    v_pk_fma_f32 v[92:93], v[92:93], v[80:81], v[112:113]
    s_bitcmp1_b32 s40, 3
    s_cbranch_scc0 K2_NF0_030
    v_rcp_f32 v106, v88
    v_fma_f32 v118, |v92|, s63, v118
    v_mov_b32 v88, 1.0
    v_mul_f32 v106, v92, v106
    v_mov_b32 v92, 0
    v_cvt_f64_f32 v[106:107], v106
    ds_add_f64 v114, v[106:107] offset:0
    v_add_u32 v114, 1024, v114
K2_NF0_030:
    s_bitcmp1_b32 s64, 3
    s_cbranch_scc0 K2_NF0_031
    v_rcp_f32 v106, v89
    v_fma_f32 v118, |v93|, s63, v118
    v_mov_b32 v89, 1.0
    v_mul_f32 v106, v93, v106
    v_mov_b32 v93, 0
    v_cvt_f64_f32 v[106:107], v106
    ds_add_f64 v116, v[106:107] offset:0
    v_add_u32 v116, 1024, v116
K2_NF0_031:
    v_pk_fma_f32 v[112:113], v[10:11], v[88:89], v[92:93]
    v_pk_fma_f32 v[88:89], v[88:89], v[82:83], v[88:89]
    v_pk_fma_f32 v[92:93], v[92:93], v[82:83], v[112:113]
    s_bitcmp1_b32 s40, 4
    s_cbranch_scc0 K2_NF0_040
    v_rcp_f32 v106, v88
    v_fma_f32 v118, |v92|, s63, v118
    v_mov_b32 v88, 1.0
    v_mul_f32 v106, v92, v106
    v_mov_b32 v92, 0
    v_cvt_f64_f32 v[106:107], v106
    ds_add_f64 v114, v[106:107] offset:0
    v_add_u32 v114, 1024, v114
K2_NF0_040:
    s_bitcmp1_b32 s64, 4
    s_cbranch_scc0 K2_NF0_041
    v_rcp_f32 v106, v89
    v_fma_f32 v118, |v93|, s63, v118
    v_mov_b32 v89, 1.0
    v_mul_f32 v106, v93, v106
    v_mov_b32 v93, 0
    v_cvt_f64_f32 v[106:107], v106
    ds_add_f64 v116, v[106:107] offset:0
    v_add_u32 v116, 1024, v116
K2_NF0_041:
    v_pk_fma_f32 v[112:113], v[12:13], v[88:89], v[92:93]
    v_pk_fma_f32 v[88:89], v[88:89], v[84:85], v[88:89]
    v_pk_fma_f32 v[92:93], v[92:93], v[84:85], v[112:113]
    s_bitcmp1_b32 s40, 5
    s_cbranch_scc0 K2_NF0_050
    v_rcp_f32 v106, v88
    v_fma_f32 v118, |v92|, s63, v118
    v_mov_b32 v88, 1.0
    v_mul_f32 v106, v92, v106
    v_mov_b32 v92, 0
    v_cvt_f64_f32 v[106:107], v106
    ds_add_f64 v114, v[106:107] offset:0
    v_add_u32 v114, 1024, v114
K2_NF0_050:
    s_bitcmp1_b32 s64, 5
    s_cbranch_scc0 K2_NF0_051
    v_rcp_f32 v106, v89
    v_fma_f32 v118, |v93|, s63, v118
    v_mov_b32 v89, 1.0
    v_mul_f32 v106, v93, v106
    v_mov_b32 v93, 0
    v_cvt_f64_f32 v[106:107], v106
    ds_add_f64 v116, v[106:107] offset:0
    v_add_u32 v116, 1024, v116
K2_NF0_051:
    s_branch K2_RT0_03
K2_FL0_06:
    v_pk_fma_f32 v[112:113], v[14:15], v[88:89], v[92:93]
    v_pk_fma_f32 v[88:89], v[88:89], v[80:81], v[88:89]
    v_pk_fma_f32 v[92:93], v[92:93], v[80:81], v[112:113]
    s_bitcmp1_b32 s40, 6
    s_cbranch_scc0 K2_NF0_060
    v_rcp_f32 v106, v88
    v_fma_f32 v118, |v92|, s63, v118
    v_mov_b32 v88, 1.0
    v_mul_f32 v106, v92, v106
    v_mov_b32 v92, 0
    v_cvt_f64_f32 v[106:107], v106
    ds_add_f64 v114, v[106:107] offset:0
    v_add_u32 v114, 1024, v114
K2_NF0_060:
    s_bitcmp1_b32 s64, 6
    s_cbranch_scc0 K2_NF0_061
    v_rcp_f32 v106, v89
    v_fma_f32 v118, |v93|, s63, v118
    v_mov_b32 v89, 1.0
    v_mul_f32 v106, v93, v106
    v_mov_b32 v93, 0
    v_cvt_f64_f32 v[106:107], v106
    ds_add_f64 v116, v[106:107] offset:0
    v_add_u32 v116, 1024, v116
K2_NF0_061:
    v_pk_fma_f32 v[112:113], v[16:17], v[88:89], v[92:93]
    v_pk_fma_f32 v[88:89], v[88:89], v[82:83], v[88:89]
    v_pk_fma_f32 v[92:93], v[92:93], v[82:83], v[112:113]
    s_bitcmp1_b32 s40, 7
    s_cbranch_scc0 K2_NF0_070
    v_rcp_f32 v106, v88
    v_fma_f32 v118, |v92|, s63, v118
    v_mov_b32 v88, 1.0
    v_mul_f32 v106, v92, v106
    v_mov_b32 v92, 0
    v_cvt_f64_f32 v[106:107], v106
    ds_add_f64 v114, v[106:107] offset:0
    v_add_u32 v114, 1024, v114
K2_NF0_070:
    s_bitcmp1_b32 s64, 7
    s_cbranch_scc0 K2_NF0_071
    v_rcp_f32 v106, v89
    v_fma_f32 v118, |v93|, s63, v118
    v_mov_b32 v89, 1.0
    v_mul_f32 v106, v93, v106
    v_mov_b32 v93, 0
    v_cvt_f64_f32 v[106:107], v106
    ds_add_f64 v116, v[106:107] offset:0
    v_add_u32 v116, 1024, v116
K2_NF0_071:
    s_branch K2_RT0_06
K2_FL0_10:
    v_pk_fma_f32 v[112:113], v[18:19], v[90:91], v[94:95]
    v_pk_fma_f32 v[90:91], v[90:91], v[80:81], v[90:91]
    v_pk_fma_f32 v[94:95], v[94:95], v[80:81], v[112:113]
    s_bitcmp1_b32 s40, 0
    s_cbranch_scc0 K2_NF0_100
    v_rcp_f32 v106, v90
    v_fma_f32 v118, |v94|, s63, v118
    v_mov_b32 v90, 1.0
    v_mul_f32 v106, v94, v106
    v_mov_b32 v94, 0
    v_cvt_f64_f32 v[106:107], v106
    ds_add_f64 v115, v[106:107] offset:512
    v_add_u32 v115, 1024, v115
K2_NF0_100:
    s_bitcmp1_b32 s64, 0
    s_cbranch_scc0 K2_NF0_101
    v_rcp_f32 v106, v91
    v_fma_f32 v118, |v95|, s63, v118
    v_mov_b32 v91, 1.0
    v_mul_f32 v106, v95, v106
    v_mov_b32 v95, 0
    v_cvt_f64_f32 v[106:107], v106
    ds_add_f64 v117, v[106:107] offset:512
    v_add_u32 v117, 1024, v117
K2_NF0_101:
    v_pk_fma_f32 v[112:113], v[20:21], v[90:91], v[94:95]
    v_pk_fma_f32 v[90:91], v[90:91], v[82:83], v[90:91]
    v_pk_fma_f32 v[94:95], v[94:95], v[82:83], v[112:113]
    s_bitcmp1_b32 s40, 1
    s_cbranch_scc0 K2_NF0_110
    v_rcp_f32 v106, v90
    v_fma_f32 v118, |v94|, s63, v118
    v_mov_b32 v90, 1.0
    v_mul_f32 v106, v94, v106
    v_mov_b32 v94, 0
    v_cvt_f64_f32 v[106:107], v106
    ds_add_f64 v115, v[106:107] offset:512
    v_add_u32 v115, 1024, v115
K2_NF0_110:
    s_bitcmp1_b32 s64, 1
    s_cbranch_scc0 K2_NF0_111
    v_rcp_f32 v106, v91
    v_fma_f32 v118, |v95|, s63, v118
    v_mov_b32 v91, 1.0
    v_mul_f32 v106, v95, v106
    v_mov_b32 v95, 0
    v_cvt_f64_f32 v[106:107], v106
    ds_add_f64 v117, v[106:107] offset:512
    v_add_u32 v117, 1024, v117
K2_NF0_111:
    v_pk_fma_f32 v[112:113], v[22:23], v[90:91], v[94:95]
    v_pk_fma_f32 v[90:91], v[90:91], v[84:85], v[90:91]
    v_pk_fma_f32 v[94:95], v[94:95], v[84:85], v[112:113]
    s_bitcmp1_b32 s40, 2
    s_cbranch_scc0 K2_NF0_120
    v_rcp_f32 v106, v90
    v_fma_f32 v118, |v94|, s63, v118
    v_mov_b32 v90, 1.0
    v_mul_f32 v106, v94, v106
    v_mov_b32 v94, 0
    v_cvt_f64_f32 v[106:107], v106
    ds_add_f64 v115, v[106:107] offset:512
    v_add_u32 v115, 1024, v115
K2_NF0_120:
    s_bitcmp1_b32 s64, 2
    s_cbranch_scc0 K2_NF0_121
    v_rcp_f32 v106, v91
    v_fma_f32 v118, |v95|, s63, v118
    v_mov_b32 v91, 1.0
    v_mul_f32 v106, v95, v106
    v_mov_b32 v95, 0
    v_cvt_f64_f32 v[106:107], v106
    ds_add_f64 v117, v[106:107] offset:512
    v_add_u32 v117, 1024, v117
K2_NF0_121:
    s_branch K2_RT0_10
K2_FL0_13:
    v_pk_fma_f32 v[112:113], v[24:25], v[90:91], v[94:95]
    v_pk_fma_f32 v[90:91], v[90:91], v[80:81], v[90:91]
    v_pk_fma_f32 v[94:95], v[94:95], v[80:81], v[112:113]
    s_bitcmp1_b32 s40, 3
    s_cbranch_scc0 K2_NF0_130
    v_rcp_f32 v106, v90
    v_fma_f32 v118, |v94|, s63, v118
    v_mov_b32 v90, 1.0
    v_mul_f32 v106, v94, v106
    v_mov_b32 v94, 0
    v_cvt_f64_f32 v[106:107], v106
    ds_add_f64 v115, v[106:107] offset:512
    v_add_u32 v115, 1024, v115
K2_NF0_130:
    s_bitcmp1_b32 s64, 3
    s_cbranch_scc0 K2_NF0_131
    v_rcp_f32 v106, v91
    v_fma_f32 v118, |v95|, s63, v118
    v_mov_b32 v91, 1.0
    v_mul_f32 v106, v95, v106
    v_mov_b32 v95, 0
    v_cvt_f64_f32 v[106:107], v106
    ds_add_f64 v117, v[106:107] offset:512
    v_add_u32 v117, 1024, v117
K2_NF0_131:
    v_pk_fma_f32 v[112:113], v[26:27], v[90:91], v[94:95]
    v_pk_fma_f32 v[90:91], v[90:91], v[82:83], v[90:91]
    v_pk_fma_f32 v[94:95], v[94:95], v[82:83], v[112:113]
    s_bitcmp1_b32 s40, 4
    s_cbranch_scc0 K2_NF0_140
    v_rcp_f32 v106, v90
    v_fma_f32 v118, |v94|, s63, v118
    v_mov_b32 v90, 1.0
    v_mul_f32 v106, v94, v106
    v_mov_b32 v94, 0
    v_cvt_f64_f32 v[106:107], v106
    ds_add_f64 v115, v[106:107] offset:512
    v_add_u32 v115, 1024, v115
K2_NF0_140:
    s_bitcmp1_b32 s64, 4
    s_cbranch_scc0 K2_NF0_141
    v_rcp_f32 v106, v91
    v_fma_f32 v118, |v95|, s63, v118
    v_mov_b32 v91, 1.0
    v_mul_f32 v106, v95, v106
    v_mov_b32 v95, 0
    v_cvt_f64_f32 v[106:107], v106
    ds_add_f64 v117, v[106:107] offset:512
    v_add_u32 v117, 1024, v117
K2_NF0_141:
    v_pk_fma_f32 v[112:113], v[28:29], v[90:91], v[94:95]
    v_pk_fma_f32 v[90:91], v[90:91], v[84:85], v[90:91]
    v_pk_fma_f32 v[94:95], v[94:95], v[84:85], v[112:113]
    s_bitcmp1_b32 s40, 5
    s_cbranch_scc0 K2_NF0_150
    v_rcp_f32 v106, v90
    v_fma_f32 v118, |v94|, s63, v118
    v_mov_b32 v90, 1.0
    v_mul_f32 v106, v94, v106
    v_mov_b32 v94, 0
    v_cvt_f64_f32 v[106:107], v106
    ds_add_f64 v115, v[106:107] offset:512
    v_add_u32 v115, 1024, v115
K2_NF0_150:
    s_bitcmp1_b32 s64, 5
    s_cbranch_scc0 K2_NF0_151
    v_rcp_f32 v106, v91
    v_fma_f32 v118, |v95|, s63, v118
    v_mov_b32 v91, 1.0
    v_mul_f32 v106, v95, v106
    v_mov_b32 v95, 0
    v_cvt_f64_f32 v[106:107], v106
    ds_add_f64 v117, v[106:107] offset:512
    v_add_u32 v117, 1024, v117
K2_NF0_151:
    s_branch K2_RT0_13
K2_FL0_16:
    v_pk_fma_f32 v[112:113], v[30:31], v[90:91], v[94:95]
    v_pk_fma_f32 v[90:91], v[90:91], v[80:81], v[90:91]
    v_pk_fma_f32 v[94:95], v[94:95], v[80:81], v[112:113]
    s_bitcmp1_b32 s40, 6
    s_cbranch_scc0 K2_NF0_160
    v_rcp_f32 v106, v90
    v_fma_f32 v118, |v94|, s63, v118
    v_mov_b32 v90, 1.0
    v_mul_f32 v106, v94, v106
    v_mov_b32 v94, 0
    v_cvt_f64_f32 v[106:107], v106
    ds_add_f64 v115, v[106:107] offset:512
    v_add_u32 v115, 1024, v115
K2_NF0_160:
    s_bitcmp1_b32 s64, 6
    s_cbranch_scc0 K2_NF0_161
    v_rcp_f32 v106, v91
    v_fma_f32 v118, |v95|, s63, v118
    v_mov_b32 v91, 1.0
    v_mul_f32 v106, v95, v106
    v_mov_b32 v95, 0
    v_cvt_f64_f32 v[106:107], v106
    ds_add_f64 v117, v[106:107] offset:512
    v_add_u32 v117, 1024, v117
K2_NF0_161:
    v_pk_fma_f32 v[112:113], v[32:33], v[90:91], v[94:95]
    v_pk_fma_f32 v[90:91], v[90:91], v[82:83], v[90:91]
    v_pk_fma_f32 v[94:95], v[94:95], v[82:83], v[112:113]
    s_bitcmp1_b32 s40, 7
    s_cbranch_scc0 K2_NF0_170
    v_rcp_f32 v106, v90
    v_fma_f32 v118, |v94|, s63, v118
    v_mov_b32 v90, 1.0
    v_mul_f32 v106, v94, v106
    v_mov_b32 v94, 0
    v_cvt_f64_f32 v[106:107], v106
    ds_add_f64 v115, v[106:107] offset:512
    v_add_u32 v115, 1024, v115
K2_NF0_170:
    s_bitcmp1_b32 s64, 7
    s_cbranch_scc0 K2_NF0_171
    v_rcp_f32 v106, v91
    v_fma_f32 v118, |v95|, s63, v118
    v_mov_b32 v91, 1.0
    v_mul_f32 v106, v95, v106
    v_mov_b32 v95, 0
    v_cvt_f64_f32 v[106:107], v106
    ds_add_f64 v117, v[106:107] offset:512
    v_add_u32 v117, 1024, v117
K2_NF0_171:
    s_branch K2_RT0_16
K2_FL1_00:
    v_pk_fma_f32 v[112:113], v[2:3], v[88:89], v[92:93]
    v_pk_fma_f32 v[88:89], v[88:89], v[80:81], v[88:89]
    v_pk_fma_f32 v[92:93], v[92:93], v[80:81], v[112:113]
    s_bitcmp1_b32 s40, 8
    s_cbranch_scc0 K2_NF1_000
    v_rcp_f32 v106, v88
    v_fma_f32 v118, |v92|, s63, v118
    v_mov_b32 v88, 1.0
    v_mul_f32 v106, v92, v106
    v_mov_b32 v92, 0
    v_cvt_f64_f32 v[106:107], v106
    ds_add_f64 v114, v[106:107] offset:0
    v_add_u32 v114, 1024, v114
K2_NF1_000:
    s_bitcmp1_b32 s64, 8
    s_cbranch_scc0 K2_NF1_001
    v_rcp_f32 v106, v89
    v_fma_f32 v118, |v93|, s63, v118
    v_mov_b32 v89, 1.0
    v_mul_f32 v106, v93, v106
    v_mov_b32 v93, 0
    v_cvt_f64_f32 v[106:107], v106
    ds_add_f64 v116, v[106:107] offset:0
    v_add_u32 v116, 1024, v116
K2_NF1_001:
    v_pk_fma_f32 v[112:113], v[4:5], v[88:89], v[92:93]
    v_pk_fma_f32 v[88:89], v[88:89], v[82:83], v[88:89]
    v_pk_fma_f32 v[92:93], v[92:93], v[82:83], v[112:113]
    s_bitcmp1_b32 s40, 9
    s_cbranch_scc0 K2_NF1_010
    v_rcp_f32 v106, v88
    v_fma_f32 v118, |v92|, s63, v118
    v_mov_b32 v88, 1.0
    v_mul_f32 v106, v92, v106
    v_mov_b32 v92, 0
    v_cvt_f64_f32 v[106:107], v106
    ds_add_f64 v114, v[106:107] offset:0
    v_add_u32 v114, 1024, v114
K2_NF1_010:
    s_bitcmp1_b32 s64, 9
    s_cbranch_scc0 K2_NF1_011
    v_rcp_f32 v106, v89
    v_fma_f32 v118, |v93|, s63, v118
    v_mov_b32 v89, 1.0
    v_mul_f32 v106, v93, v106
    v_mov_b32 v93, 0
    v_cvt_f64_f32 v[106:107], v106
    ds_add_f64 v116, v[106:107] offset:0
    v_add_u32 v116, 1024, v116
K2_NF1_011:
    v_pk_fma_f32 v[112:113], v[6:7], v[88:89], v[92:93]
    v_pk_fma_f32 v[88:89], v[88:89], v[84:85], v[88:89]
    v_pk_fma_f32 v[92:93], v[92:93], v[84:85], v[112:113]
    s_bitcmp1_b32 s40, 10
    s_cbranch_scc0 K2_NF1_020
    v_rcp_f32 v106, v88
    v_fma_f32 v118, |v92|, s63, v118
    v_mov_b32 v88, 1.0
    v_mul_f32 v106, v92, v106
    v_mov_b32 v92, 0
    v_cvt_f64_f32 v[106:107], v106
    ds_add_f64 v114, v[106:107] offset:0
    v_add_u32 v114, 1024, v114
K2_NF1_020:
    s_bitcmp1_b32 s64, 10
    s_cbranch_scc0 K2_NF1_021
    v_rcp_f32 v106, v89
    v_fma_f32 v118, |v93|, s63, v118
    v_mov_b32 v89, 1.0
    v_mul_f32 v106, v93, v106
    v_mov_b32 v93, 0
    v_cvt_f64_f32 v[106:107], v106
    ds_add_f64 v116, v[106:107] offset:0
    v_add_u32 v116, 1024, v116
K2_NF1_021:
    s_branch K2_RT1_00
K2_FL1_03:
    v_pk_fma_f32 v[112:113], v[8:9], v[88:89], v[92:93]
    v_pk_fma_f32 v[88:89], v[88:89], v[80:81], v[88:89]
    v_pk_fma_f32 v[92:93], v[92:93], v[80:81], v[112:113]
    s_bitcmp1_b32 s40, 11
    s_cbranch_scc0 K2_NF1_030
    v_rcp_f32 v106, v88
    v_fma_f32 v118, |v92|, s63, v118
    v_mov_b32 v88, 1.0
    v_mul_f32 v106, v92, v106
    v_mov_b32 v92, 0
    v_cvt_f64_f32 v[106:107], v106
    ds_add_f64 v114, v[106:107] offset:0
    v_add_u32 v114, 1024, v114
K2_NF1_030:
    s_bitcmp1_b32 s64, 11
    s_cbranch_scc0 K2_NF1_031
    v_rcp_f32 v106, v89
    v_fma_f32 v118, |v93|, s63, v118
    v_mov_b32 v89, 1.0
    v_mul_f32 v106, v93, v106
    v_mov_b32 v93, 0
    v_cvt_f64_f32 v[106:107], v106
    ds_add_f64 v116, v[106:107] offset:0
    v_add_u32 v116, 1024, v116
K2_NF1_031:
    v_pk_fma_f32 v[112:113], v[10:11], v[88:89], v[92:93]
    v_pk_fma_f32 v[88:89], v[88:89], v[82:83], v[88:89]
    v_pk_fma_f32 v[92:93], v[92:93], v[82:83], v[112:113]
    s_bitcmp1_b32 s40, 12
    s_cbranch_scc0 K2_NF1_040
    v_rcp_f32 v106, v88
    v_fma_f32 v118, |v92|, s63, v118
    v_mov_b32 v88, 1.0
    v_mul_f32 v106, v92, v106
    v_mov_b32 v92, 0
    v_cvt_f64_f32 v[106:107], v106
    ds_add_f64 v114, v[106:107] offset:0
    v_add_u32 v114, 1024, v114
K2_NF1_040:
    s_bitcmp1_b32 s64, 12
    s_cbranch_scc0 K2_NF1_041
    v_rcp_f32 v106, v89
    v_fma_f32 v118, |v93|, s63, v118
    v_mov_b32 v89, 1.0
    v_mul_f32 v106, v93, v106
    v_mov_b32 v93, 0
    v_cvt_f64_f32 v[106:107], v106
    ds_add_f64 v116, v[106:107] offset:0
    v_add_u32 v116, 1024, v116
K2_NF1_041:
    v_pk_fma_f32 v[112:113], v[12:13], v[88:89], v[92:93]
    v_pk_fma_f32 v[88:89], v[88:89], v[84:85], v[88:89]
    v_pk_fma_f32 v[92:93], v[92:93], v[84:85], v[112:113]
    s_bitcmp1_b32 s40, 13
    s_cbranch_scc0 K2_NF1_050
    v_rcp_f32 v106, v88
    v_fma_f32 v118, |v92|, s63, v118
    v_mov_b32 v88, 1.0
    v_mul_f32 v106, v92, v106
    v_mov_b32 v92, 0
    v_cvt_f64_f32 v[106:107], v106
    ds_add_f64 v114, v[106:107] offset:0
    v_add_u32 v114, 1024, v114
K2_NF1_050:
    s_bitcmp1_b32 s64, 13
    s_cbranch_scc0 K2_NF1_051
    v_rcp_f32 v106, v89
    v_fma_f32 v118, |v93|, s63, v118
    v_mov_b32 v89, 1.0
    v_mul_f32 v106, v93, v106
    v_mov_b32 v93, 0
    v_cvt_f64_f32 v[106:107], v106
    ds_add_f64 v116, v[106:107] offset:0
    v_add_u32 v116, 1024, v116
K2_NF1_051:
    s_branch K2_RT1_03
K2_FL1_06:
    v_pk_fma_f32 v[112:113], v[14:15], v[88:89], v[92:93]
    v_pk_fma_f32 v[88:89], v[88:89], v[80:81], v[88:89]
    v_pk_fma_f32 v[92:93], v[92:93], v[80:81], v[112:113]
    s_bitcmp1_b32 s40, 14
    s_cbranch_scc0 K2_NF1_060
    v_rcp_f32 v106, v88
    v_fma_f32 v118, |v92|, s63, v118
    v_mov_b32 v88, 1.0
    v_mul_f32 v106, v92, v106
    v_mov_b32 v92, 0
    v_cvt_f64_f32 v[106:107], v106
    ds_add_f64 v114, v[106:107] offset:0
    v_add_u32 v114, 1024, v114
K2_NF1_060:
    s_bitcmp1_b32 s64, 14
    s_cbranch_scc0 K2_NF1_061
    v_rcp_f32 v106, v89
    v_fma_f32 v118, |v93|, s63, v118
    v_mov_b32 v89, 1.0
    v_mul_f32 v106, v93, v106
    v_mov_b32 v93, 0
    v_cvt_f64_f32 v[106:107], v106
    ds_add_f64 v116, v[106:107] offset:0
    v_add_u32 v116, 1024, v116
K2_NF1_061:
    v_pk_fma_f32 v[112:113], v[16:17], v[88:89], v[92:93]
    v_pk_fma_f32 v[88:89], v[88:89], v[82:83], v[88:89]
    v_pk_fma_f32 v[92:93], v[92:93], v[82:83], v[112:113]
    s_bitcmp1_b32 s40, 15
    s_cbranch_scc0 K2_NF1_070
    v_rcp_f32 v106, v88
    v_fma_f32 v118, |v92|, s63, v118
    v_mov_b32 v88, 1.0
    v_mul_f32 v106, v92, v106
    v_mov_b32 v92, 0
    v_cvt_f64_f32 v[106:107], v106
    ds_add_f64 v114, v[106:107] offset:0
    v_add_u32 v114, 1024, v114
K2_NF1_070:
    s_bitcmp1_b32 s64, 15
    s_cbranch_scc0 K2_NF1_071
    v_rcp_f32 v106, v89
    v_fma_f32 v118, |v93|, s63, v118
    v_mov_b32 v89, 1.0
    v_mul_f32 v106, v93, v106
    v_mov_b32 v93, 0
    v_cvt_f64_f32 v[106:107], v106
    ds_add_f64 v116, v[106:107] offset:0
    v_add_u32 v116, 1024, v116
K2_NF1_071:
    s_branch K2_RT1_06
K2_FL1_10:
    v_pk_fma_f32 v[112:113], v[18:19], v[90:91], v[94:95]
    v_pk_fma_f32 v[90:91], v[90:91], v[80:81], v[90:91]
    v_pk_fma_f32 v[94:95], v[94:95], v[80:81], v[112:113]
    s_bitcmp1_b32 s40, 8
    s_cbranch_scc0 K2_NF1_100
    v_rcp_f32 v106, v90
    v_fma_f32 v118, |v94|, s63, v118
    v_mov_b32 v90, 1.0
    v_mul_f32 v106, v94, v106
    v_mov_b32 v94, 0
    v_cvt_f64_f32 v[106:107], v106
    ds_add_f64 v115, v[106:107] offset:512
    v_add_u32 v115, 1024, v115
K2_NF1_100:
    s_bitcmp1_b32 s64, 8
    s_cbranch_scc0 K2_NF1_101
    v_rcp_f32 v106, v91
    v_fma_f32 v118, |v95|, s63, v118
    v_mov_b32 v91, 1.0
    v_mul_f32 v106, v95, v106
    v_mov_b32 v95, 0
    v_cvt_f64_f32 v[106:107], v106
    ds_add_f64 v117, v[106:107] offset:512
    v_add_u32 v117, 1024, v117
K2_NF1_101:
    v_pk_fma_f32 v[112:113], v[20:21], v[90:91], v[94:95]
    v_pk_fma_f32 v[90:91], v[90:91], v[82:83], v[90:91]
    v_pk_fma_f32 v[94:95], v[94:95], v[82:83], v[112:113]
    s_bitcmp1_b32 s40, 9
    s_cbranch_scc0 K2_NF1_110
    v_rcp_f32 v106, v90
    v_fma_f32 v118, |v94|, s63, v118
    v_mov_b32 v90, 1.0
    v_mul_f32 v106, v94, v106
    v_mov_b32 v94, 0
    v_cvt_f64_f32 v[106:107], v106
    ds_add_f64 v115, v[106:107] offset:512
    v_add_u32 v115, 1024, v115
K2_NF1_110:
    s_bitcmp1_b32 s64, 9
    s_cbranch_scc0 K2_NF1_111
    v_rcp_f32 v106, v91
    v_fma_f32 v118, |v95|, s63, v118
    v_mov_b32 v91, 1.0
    v_mul_f32 v106, v95, v106
    v_mov_b32 v95, 0
    v_cvt_f64_f32 v[106:107], v106
    ds_add_f64 v117, v[106:107] offset:512
    v_add_u32 v117, 1024, v117
K2_NF1_111:
    v_pk_fma_f32 v[112:113], v[22:23], v[90:91], v[94:95]
    v_pk_fma_f32 v[90:91], v[90:91], v[84:85], v[90:91]
    v_pk_fma_f32 v[94:95], v[94:95], v[84:85], v[112:113]
    s_bitcmp1_b32 s40, 10
    s_cbranch_scc0 K2_NF1_120
    v_rcp_f32 v106, v90
    v_fma_f32 v118, |v94|, s63, v118
    v_mov_b32 v90, 1.0
    v_mul_f32 v106, v94, v106
    v_mov_b32 v94, 0
    v_cvt_f64_f32 v[106:107], v106
    ds_add_f64 v115, v[106:107] offset:512
    v_add_u32 v115, 1024, v115
K2_NF1_120:
    s_bitcmp1_b32 s64, 10
    s_cbranch_scc0 K2_NF1_121
    v_rcp_f32 v106, v91
    v_fma_f32 v118, |v95|, s63, v118
    v_mov_b32 v91, 1.0
    v_mul_f32 v106, v95, v106
    v_mov_b32 v95, 0
    v_cvt_f64_f32 v[106:107], v106
    ds_add_f64 v117, v[106:107] offset:512
    v_add_u32 v117, 1024, v117
K2_NF1_121:
    s_branch K2_RT1_10
K2_FL1_13:
    v_pk_fma_f32 v[112:113], v[24:25], v[90:91], v[94:95]
    v_pk_fma_f32 v[90:91], v[90:91], v[80:81], v[90:91]
    v_pk_fma_f32 v[94:95], v[94:95], v[80:81], v[112:113]
    s_bitcmp1_b32 s40, 11
    s_cbranch_scc0 K2_NF1_130
    v_rcp_f32 v106, v90
    v_fma_f32 v118, |v94|, s63, v118
    v_mov_b32 v90, 1.0
    v_mul_f32 v106, v94, v106
    v_mov_b32 v94, 0
    v_cvt_f64_f32 v[106:107], v106
    ds_add_f64 v115, v[106:107] offset:512
    v_add_u32 v115, 1024, v115
K2_NF1_130:
    s_bitcmp1_b32 s64, 11
    s_cbranch_scc0 K2_NF1_131
    v_rcp_f32 v106, v91
    v_fma_f32 v118, |v95|, s63, v118
    v_mov_b32 v91, 1.0
    v_mul_f32 v106, v95, v106
    v_mov_b32 v95, 0
    v_cvt_f64_f32 v[106:107], v106
    ds_add_f64 v117, v[106:107] offset:512
    v_add_u32 v117, 1024, v117
K2_NF1_131:
    v_pk_fma_f32 v[112:113], v[26:27], v[90:91], v[94:95]
    v_pk_fma_f32 v[90:91], v[90:91], v[82:83], v[90:91]
    v_pk_fma_f32 v[94:95], v[94:95], v[82:83], v[112:113]
    s_bitcmp1_b32 s40, 12
    s_cbranch_scc0 K2_NF1_140
    v_rcp_f32 v106, v90
    v_fma_f32 v118, |v94|, s63, v118
    v_mov_b32 v90, 1.0
    v_mul_f32 v106, v94, v106
    v_mov_b32 v94, 0
    v_cvt_f64_f32 v[106:107], v106
    ds_add_f64 v115, v[106:107] offset:512
    v_add_u32 v115, 1024, v115
K2_NF1_140:
    s_bitcmp1_b32 s64, 12
    s_cbranch_scc0 K2_NF1_141
    v_rcp_f32 v106, v91
    v_fma_f32 v118, |v95|, s63, v118
    v_mov_b32 v91, 1.0
    v_mul_f32 v106, v95, v106
    v_mov_b32 v95, 0
    v_cvt_f64_f32 v[106:107], v106
    ds_add_f64 v117, v[106:107] offset:512
    v_add_u32 v117, 1024, v117
K2_NF1_141:
    v_pk_fma_f32 v[112:113], v[28:29], v[90:91], v[94:95]
    v_pk_fma_f32 v[90:91], v[90:91], v[84:85], v[90:91]
    v_pk_fma_f32 v[94:95], v[94:95], v[84:85], v[112:113]
    s_bitcmp1_b32 s40, 13
    s_cbranch_scc0 K2_NF1_150
    v_rcp_f32 v106, v90
    v_fma_f32 v118, |v94|, s63, v118
    v_mov_b32 v90, 1.0
    v_mul_f32 v106, v94, v106
    v_mov_b32 v94, 0
    v_cvt_f64_f32 v[106:107], v106
    ds_add_f64 v115, v[106:107] offset:512
    v_add_u32 v115, 1024, v115
K2_NF1_150:
    s_bitcmp1_b32 s64, 13
    s_cbranch_scc0 K2_NF1_151
    v_rcp_f32 v106, v91
    v_fma_f32 v118, |v95|, s63, v118
    v_mov_b32 v91, 1.0
    v_mul_f32 v106, v95, v106
    v_mov_b32 v95, 0
    v_cvt_f64_f32 v[106:107], v106
    ds_add_f64 v117, v[106:107] offset:512
    v_add_u32 v117, 1024, v117
K2_NF1_151:
    s_branch K2_RT1_13
K2_FL1_16:
    v_pk_fma_f32 v[112:113], v[30:31], v[90:91], v[94:95]
    v_pk_fma_f32 v[90:91], v[90:91], v[80:81], v[90:91]
    v_pk_fma_f32 v[94:95], v[94:95], v[80:81], v[112:113]
    s_bitcmp1_b32 s40, 14
    s_cbranch_scc0 K2_NF1_160
    v_rcp_f32 v106, v90
    v_fma_f32 v118, |v94|, s63, v118
    v_mov_b32 v90, 1.0
    v_mul_f32 v106, v94, v106
    v_mov_b32 v94, 0
    v_cvt_f64_f32 v[106:107], v106
    ds_add_f64 v115, v[106:107] offset:512
    v_add_u32 v115, 1024, v115
K2_NF1_160:
    s_bitcmp1_b32 s64, 14
    s_cbranch_scc0 K2_NF1_161
    v_rcp_f32 v106, v91
    v_fma_f32 v118, |v95|, s63, v118
    v_mov_b32 v91, 1.0
    v_mul_f32 v106, v95, v106
    v_mov_b32 v95, 0
    v_cvt_f64_f32 v[106:107], v106
    ds_add_f64 v117, v[106:107] offset:512
    v_add_u32 v117, 1024, v117
K2_NF1_161:
    v_pk_fma_f32 v[112:113], v[32:33], v[90:91], v[94:95]
    v_pk_fma_f32 v[90:91], v[90:91], v[82:83], v[90:91]
    v_pk_fma_f32 v[94:95], v[94:95], v[82:83], v[112:113]
    s_bitcmp1_b32 s40, 15
    s_cbranch_scc0 K2_NF1_170
    v_rcp_f32 v106, v90
    v_fma_f32 v118, |v94|, s63, v118
    v_mov_b32 v90, 1.0
    v_mul_f32 v106, v94, v106
    v_mov_b32 v94, 0
    v_cvt_f64_f32 v[106:107], v106
    ds_add_f64 v115, v[106:107] offset:512
    v_add_u32 v115, 1024, v115
K2_NF1_170:
    s_bitcmp1_b32 s64, 15
    s_cbranch_scc0 K2_NF1_171
    v_rcp_f32 v106, v91
    v_fma_f32 v118, |v95|, s63, v118
    v_mov_b32 v91, 1.0
    v_mul_f32 v106, v95, v106
    v_mov_b32 v95, 0
    v_cvt_f64_f32 v[106:107], v106
    ds_add_f64 v117, v[106:107] offset:512
    v_add_u32 v117, 1024, v117
K2_NF1_171:
    s_branch K2_RT1_16
K2_FL2_00:
    v_pk_fma_f32 v[112:113], v[2:3], v[88:89], v[92:93]
    v_pk_fma_f32 v[88:89], v[88:89], v[80:81], v[88:89]
    v_pk_fma_f32 v[92:93], v[92:93], v[80:81], v[112:113]
    s_bitcmp1_b32 s40, 16
    s_cbranch_scc0 K2_NF2_000
    v_rcp_f32 v106, v88
    v_fma_f32 v118, |v92|, s63, v118
    v_mov_b32 v88, 1.0
    v_mul_f32 v106, v92, v106
    v_mov_b32 v92, 0
    v_cvt_f64_f32 v[106:107], v106
    ds_add_f64 v114, v[106:107] offset:0
    v_add_u32 v114, 1024, v114
K2_NF2_000:
    s_bitcmp1_b32 s64, 16
    s_cbranch_scc0 K2_NF2_001
    v_rcp_f32 v106, v89
    v_fma_f32 v118, |v93|, s63, v118
    v_mov_b32 v89, 1.0
    v_mul_f32 v106, v93, v106
    v_mov_b32 v93, 0
    v_cvt_f64_f32 v[106:107], v106
    ds_add_f64 v116, v[106:107] offset:0
    v_add_u32 v116, 1024, v116
K2_NF2_001:
    v_pk_fma_f32 v[112:113], v[4:5], v[88:89], v[92:93]
    v_pk_fma_f32 v[88:89], v[88:89], v[82:83], v[88:89]
    v_pk_fma_f32 v[92:93], v[92:93], v[82:83], v[112:113]
    s_bitcmp1_b32 s40, 17
    s_cbranch_scc0 K2_NF2_010
    v_rcp_f32 v106, v88
    v_fma_f32 v118, |v92|, s63, v118
    v_mov_b32 v88, 1.0
    v_mul_f32 v106, v92, v106
    v_mov_b32 v92, 0
    v_cvt_f64_f32 v[106:107], v106
    ds_add_f64 v114, v[106:107] offset:0
    v_add_u32 v114, 1024, v114
K2_NF2_010:
    s_bitcmp1_b32 s64, 17
    s_cbranch_scc0 K2_NF2_011
    v_rcp_f32 v106, v89
    v_fma_f32 v118, |v93|, s63, v118
    v_mov_b32 v89, 1.0
    v_mul_f32 v106, v93, v106
    v_mov_b32 v93, 0
    v_cvt_f64_f32 v[106:107], v106
    ds_add_f64 v116, v[106:107] offset:0
    v_add_u32 v116, 1024, v116
K2_NF2_011:
    v_pk_fma_f32 v[112:113], v[6:7], v[88:89], v[92:93]
    v_pk_fma_f32 v[88:89], v[88:89], v[84:85], v[88:89]
    v_pk_fma_f32 v[92:93], v[92:93], v[84:85], v[112:113]
    s_bitcmp1_b32 s40, 18
    s_cbranch_scc0 K2_NF2_020
    v_rcp_f32 v106, v88
    v_fma_f32 v118, |v92|, s63, v118
    v_mov_b32 v88, 1.0
    v_mul_f32 v106, v92, v106
    v_mov_b32 v92, 0
    v_cvt_f64_f32 v[106:107], v106
    ds_add_f64 v114, v[106:107] offset:0
    v_add_u32 v114, 1024, v114
K2_NF2_020:
    s_bitcmp1_b32 s64, 18
    s_cbranch_scc0 K2_NF2_021
    v_rcp_f32 v106, v89
    v_fma_f32 v118, |v93|, s63, v118
    v_mov_b32 v89, 1.0
    v_mul_f32 v106, v93, v106
    v_mov_b32 v93, 0
    v_cvt_f64_f32 v[106:107], v106
    ds_add_f64 v116, v[106:107] offset:0
    v_add_u32 v116, 1024, v116
K2_NF2_021:
    s_branch K2_RT2_00
K2_FL2_03:
    v_pk_fma_f32 v[112:113], v[8:9], v[88:89], v[92:93]
    v_pk_fma_f32 v[88:89], v[88:89], v[80:81], v[88:89]
    v_pk_fma_f32 v[92:93], v[92:93], v[80:81], v[112:113]
    s_bitcmp1_b32 s40, 19
    s_cbranch_scc0 K2_NF2_030
    v_rcp_f32 v106, v88
    v_fma_f32 v118, |v92|, s63, v118
    v_mov_b32 v88, 1.0
    v_mul_f32 v106, v92, v106
    v_mov_b32 v92, 0
    v_cvt_f64_f32 v[106:107], v106
    ds_add_f64 v114, v[106:107] offset:0
    v_add_u32 v114, 1024, v114
K2_NF2_030:
    s_bitcmp1_b32 s64, 19
    s_cbranch_scc0 K2_NF2_031
    v_rcp_f32 v106, v89
    v_fma_f32 v118, |v93|, s63, v118
    v_mov_b32 v89, 1.0
    v_mul_f32 v106, v93, v106
    v_mov_b32 v93, 0
    v_cvt_f64_f32 v[106:107], v106
    ds_add_f64 v116, v[106:107] offset:0
    v_add_u32 v116, 1024, v116
K2_NF2_031:
    v_pk_fma_f32 v[112:113], v[10:11], v[88:89], v[92:93]
    v_pk_fma_f32 v[88:89], v[88:89], v[82:83], v[88:89]
    v_pk_fma_f32 v[92:93], v[92:93], v[82:83], v[112:113]
    s_bitcmp1_b32 s40, 20
    s_cbranch_scc0 K2_NF2_040
    v_rcp_f32 v106, v88
    v_fma_f32 v118, |v92|, s63, v118
    v_mov_b32 v88, 1.0
    v_mul_f32 v106, v92, v106
    v_mov_b32 v92, 0
    v_cvt_f64_f32 v[106:107], v106
    ds_add_f64 v114, v[106:107] offset:0
    v_add_u32 v114, 1024, v114
K2_NF2_040:
    s_bitcmp1_b32 s64, 20
    s_cbranch_scc0 K2_NF2_041
    v_rcp_f32 v106, v89
    v_fma_f32 v118, |v93|, s63, v118
    v_mov_b32 v89, 1.0
    v_mul_f32 v106, v93, v106
    v_mov_b32 v93, 0
    v_cvt_f64_f32 v[106:107], v106
    ds_add_f64 v116, v[106:107] offset:0
    v_add_u32 v116, 1024, v116
K2_NF2_041:
    v_pk_fma_f32 v[112:113], v[12:13], v[88:89], v[92:93]
    v_pk_fma_f32 v[88:89], v[88:89], v[84:85], v[88:89]
    v_pk_fma_f32 v[92:93], v[92:93], v[84:85], v[112:113]
    s_bitcmp1_b32 s40, 21
    s_cbranch_scc0 K2_NF2_050
    v_rcp_f32 v106, v88
    v_fma_f32 v118, |v92|, s63, v118
    v_mov_b32 v88, 1.0
    v_mul_f32 v106, v92, v106
    v_mov_b32 v92, 0
    v_cvt_f64_f32 v[106:107], v106
    ds_add_f64 v114, v[106:107] offset:0
    v_add_u32 v114, 1024, v114
K2_NF2_050:
    s_bitcmp1_b32 s64, 21
    s_cbranch_scc0 K2_NF2_051
    v_rcp_f32 v106, v89
    v_fma_f32 v118, |v93|, s63, v118
    v_mov_b32 v89, 1.0
    v_mul_f32 v106, v93, v106
    v_mov_b32 v93, 0
    v_cvt_f64_f32 v[106:107], v106
    ds_add_f64 v116, v[106:107] offset:0
    v_add_u32 v116, 1024, v116
K2_NF2_051:
    s_branch K2_RT2_03
K2_FL2_06:
    v_pk_fma_f32 v[112:113], v[14:15], v[88:89], v[92:93]
    v_pk_fma_f32 v[88:89], v[88:89], v[80:81], v[88:89]
    v_pk_fma_f32 v[92:93], v[92:93], v[80:81], v[112:113]
    s_bitcmp1_b32 s40, 22
    s_cbranch_scc0 K2_NF2_060
    v_rcp_f32 v106, v88
    v_fma_f32 v118, |v92|, s63, v118
    v_mov_b32 v88, 1.0
    v_mul_f32 v106, v92, v106
    v_mov_b32 v92, 0
    v_cvt_f64_f32 v[106:107], v106
    ds_add_f64 v114, v[106:107] offset:0
    v_add_u32 v114, 1024, v114
K2_NF2_060:
    s_bitcmp1_b32 s64, 22
    s_cbranch_scc0 K2_NF2_061
    v_rcp_f32 v106, v89
    v_fma_f32 v118, |v93|, s63, v118
    v_mov_b32 v89, 1.0
    v_mul_f32 v106, v93, v106
    v_mov_b32 v93, 0
    v_cvt_f64_f32 v[106:107], v106
    ds_add_f64 v116, v[106:107] offset:0
    v_add_u32 v116, 1024, v116
K2_NF2_061:
    v_pk_fma_f32 v[112:113], v[16:17], v[88:89], v[92:93]
    v_pk_fma_f32 v[88:89], v[88:89], v[82:83], v[88:89]
    v_pk_fma_f32 v[92:93], v[92:93], v[82:83], v[112:113]
    s_bitcmp1_b32 s40, 23
    s_cbranch_scc0 K2_NF2_070
    v_rcp_f32 v106, v88
    v_fma_f32 v118, |v92|, s63, v118
    v_mov_b32 v88, 1.0
    v_mul_f32 v106, v92, v106
    v_mov_b32 v92, 0
    v_cvt_f64_f32 v[106:107], v106
    ds_add_f64 v114, v[106:107] offset:0
    v_add_u32 v114, 1024, v114
K2_NF2_070:
    s_bitcmp1_b32 s64, 23
    s_cbranch_scc0 K2_NF2_071
    v_rcp_f32 v106, v89
    v_fma_f32 v118, |v93|, s63, v118
    v_mov_b32 v89, 1.0
    v_mul_f32 v106, v93, v106
    v_mov_b32 v93, 0
    v_cvt_f64_f32 v[106:107], v106
    ds_add_f64 v116, v[106:107] offset:0
    v_add_u32 v116, 1024, v116
K2_NF2_071:
    s_branch K2_RT2_06
K2_FL2_10:
    v_pk_fma_f32 v[112:113], v[18:19], v[90:91], v[94:95]
    v_pk_fma_f32 v[90:91], v[90:91], v[80:81], v[90:91]
    v_pk_fma_f32 v[94:95], v[94:95], v[80:81], v[112:113]
    s_bitcmp1_b32 s40, 16
    s_cbranch_scc0 K2_NF2_100
    v_rcp_f32 v106, v90
    v_fma_f32 v118, |v94|, s63, v118
    v_mov_b32 v90, 1.0
    v_mul_f32 v106, v94, v106
    v_mov_b32 v94, 0
    v_cvt_f64_f32 v[106:107], v106
    ds_add_f64 v115, v[106:107] offset:512
    v_add_u32 v115, 1024, v115
K2_NF2_100:
    s_bitcmp1_b32 s64, 16
    s_cbranch_scc0 K2_NF2_101
    v_rcp_f32 v106, v91
    v_fma_f32 v118, |v95|, s63, v118
    v_mov_b32 v91, 1.0
    v_mul_f32 v106, v95, v106
    v_mov_b32 v95, 0
    v_cvt_f64_f32 v[106:107], v106
    ds_add_f64 v117, v[106:107] offset:512
    v_add_u32 v117, 1024, v117
K2_NF2_101:
    v_pk_fma_f32 v[112:113], v[20:21], v[90:91], v[94:95]
    v_pk_fma_f32 v[90:91], v[90:91], v[82:83], v[90:91]
    v_pk_fma_f32 v[94:95], v[94:95], v[82:83], v[112:113]
    s_bitcmp1_b32 s40, 17
    s_cbranch_scc0 K2_NF2_110
    v_rcp_f32 v106, v90
    v_fma_f32 v118, |v94|, s63, v118
    v_mov_b32 v90, 1.0
    v_mul_f32 v106, v94, v106
    v_mov_b32 v94, 0
    v_cvt_f64_f32 v[106:107], v106
    ds_add_f64 v115, v[106:107] offset:512
    v_add_u32 v115, 1024, v115
K2_NF2_110:
    s_bitcmp1_b32 s64, 17
    s_cbranch_scc0 K2_NF2_111
    v_rcp_f32 v106, v91
    v_fma_f32 v118, |v95|, s63, v118
    v_mov_b32 v91, 1.0
    v_mul_f32 v106, v95, v106
    v_mov_b32 v95, 0
    v_cvt_f64_f32 v[106:107], v106
    ds_add_f64 v117, v[106:107] offset:512
    v_add_u32 v117, 1024, v117
K2_NF2_111:
    v_pk_fma_f32 v[112:113], v[22:23], v[90:91], v[94:95]
    v_pk_fma_f32 v[90:91], v[90:91], v[84:85], v[90:91]
    v_pk_fma_f32 v[94:95], v[94:95], v[84:85], v[112:113]
    s_bitcmp1_b32 s40, 18
    s_cbranch_scc0 K2_NF2_120
    v_rcp_f32 v106, v90
    v_fma_f32 v118, |v94|, s63, v118
    v_mov_b32 v90, 1.0
    v_mul_f32 v106, v94, v106
    v_mov_b32 v94, 0
    v_cvt_f64_f32 v[106:107], v106
    ds_add_f64 v115, v[106:107] offset:512
    v_add_u32 v115, 1024, v115
K2_NF2_120:
    s_bitcmp1_b32 s64, 18
    s_cbranch_scc0 K2_NF2_121
    v_rcp_f32 v106, v91
    v_fma_f32 v118, |v95|, s63, v118
    v_mov_b32 v91, 1.0
    v_mul_f32 v106, v95, v106
    v_mov_b32 v95, 0
    v_cvt_f64_f32 v[106:107], v106
    ds_add_f64 v117, v[106:107] offset:512
    v_add_u32 v117, 1024, v117
K2_NF2_121:
    s_branch K2_RT2_10
K2_FL2_13:
    v_pk_fma_f32 v[112:113], v[24:25], v[90:91], v[94:95]
    v_pk_fma_f32 v[90:91], v[90:91], v[80:81], v[90:91]
    v_pk_fma_f32 v[94:95], v[94:95], v[80:81], v[112:113]
    s_bitcmp1_b32 s40, 19
    s_cbranch_scc0 K2_NF2_130
    v_rcp_f32 v106, v90
    v_fma_f32 v118, |v94|, s63, v118
    v_mov_b32 v90, 1.0
    v_mul_f32 v106, v94, v106
    v_mov_b32 v94, 0
    v_cvt_f64_f32 v[106:107], v106
    ds_add_f64 v115, v[106:107] offset:512
    v_add_u32 v115, 1024, v115
K2_NF2_130:
    s_bitcmp1_b32 s64, 19
    s_cbranch_scc0 K2_NF2_131
    v_rcp_f32 v106, v91
    v_fma_f32 v118, |v95|, s63, v118
    v_mov_b32 v91, 1.0
    v_mul_f32 v106, v95, v106
    v_mov_b32 v95, 0
    v_cvt_f64_f32 v[106:107], v106
    ds_add_f64 v117, v[106:107] offset:512
    v_add_u32 v117, 1024, v117
K2_NF2_131:
    v_pk_fma_f32 v[112:113], v[26:27], v[90:91], v[94:95]
    v_pk_fma_f32 v[90:91], v[90:91], v[82:83], v[90:91]
    v_pk_fma_f32 v[94:95], v[94:95], v[82:83], v[112:113]
    s_bitcmp1_b32 s40, 20
    s_cbranch_scc0 K2_NF2_140
    v_rcp_f32 v106, v90
    v_fma_f32 v118, |v94|, s63, v118
    v_mov_b32 v90, 1.0
    v_mul_f32 v106, v94, v106
    v_mov_b32 v94, 0
    v_cvt_f64_f32 v[106:107], v106
    ds_add_f64 v115, v[106:107] offset:512
    v_add_u32 v115, 1024, v115
K2_NF2_140:
    s_bitcmp1_b32 s64, 20
    s_cbranch_scc0 K2_NF2_141
    v_rcp_f32 v106, v91
    v_fma_f32 v118, |v95|, s63, v118
    v_mov_b32 v91, 1.0
    v_mul_f32 v106, v95, v106
    v_mov_b32 v95, 0
    v_cvt_f64_f32 v[106:107], v106
    ds_add_f64 v117, v[106:107] offset:512
    v_add_u32 v117, 1024, v117
K2_NF2_141:
    v_pk_fma_f32 v[112:113], v[28:29], v[90:91], v[94:95]
    v_pk_fma_f32 v[90:91], v[90:91], v[84:85], v[90:91]
    v_pk_fma_f32 v[94:95], v[94:95], v[84:85], v[112:113]
    s_bitcmp1_b32 s40, 21
    s_cbranch_scc0 K2_NF2_150
    v_rcp_f32 v106, v90
    v_fma_f32 v118, |v94|, s63, v118
    v_mov_b32 v90, 1.0
    v_mul_f32 v106, v94, v106
    v_mov_b32 v94, 0
    v_cvt_f64_f32 v[106:107], v106
    ds_add_f64 v115, v[106:107] offset:512
    v_add_u32 v115, 1024, v115
K2_NF2_150:
    s_bitcmp1_b32 s64, 21
    s_cbranch_scc0 K2_NF2_151
    v_rcp_f32 v106, v91
    v_fma_f32 v118, |v95|, s63, v118
    v_mov_b32 v91, 1.0
    v_mul_f32 v106, v95, v106
    v_mov_b32 v95, 0
    v_cvt_f64_f32 v[106:107], v106
    ds_add_f64 v117, v[106:107] offset:512
    v_add_u32 v117, 1024, v117
K2_NF2_151:
    s_branch K2_RT2_13
K2_FL2_16:
    v_pk_fma_f32 v[112:113], v[30:31], v[90:91], v[94:95]
    v_pk_fma_f32 v[90:91], v[90:91], v[80:81], v[90:91]
    v_pk_fma_f32 v[94:95], v[94:95], v[80:81], v[112:113]
    s_bitcmp1_b32 s40, 22
    s_cbranch_scc0 K2_NF2_160
    v_rcp_f32 v106, v90
    v_fma_f32 v118, |v94|, s63, v118
    v_mov_b32 v90, 1.0
    v_mul_f32 v106, v94, v106
    v_mov_b32 v94, 0
    v_cvt_f64_f32 v[106:107], v106
    ds_add_f64 v115, v[106:107] offset:512
    v_add_u32 v115, 1024, v115
K2_NF2_160:
    s_bitcmp1_b32 s64, 22
    s_cbranch_scc0 K2_NF2_161
    v_rcp_f32 v106, v91
    v_fma_f32 v118, |v95|, s63, v118
    v_mov_b32 v91, 1.0
    v_mul_f32 v106, v95, v106
    v_mov_b32 v95, 0
    v_cvt_f64_f32 v[106:107], v106
    ds_add_f64 v117, v[106:107] offset:512
    v_add_u32 v117, 1024, v117
K2_NF2_161:
    v_pk_fma_f32 v[112:113], v[32:33], v[90:91], v[94:95]
    v_pk_fma_f32 v[90:91], v[90:91], v[82:83], v[90:91]
    v_pk_fma_f32 v[94:95], v[94:95], v[82:83], v[112:113]
    s_bitcmp1_b32 s40, 23
    s_cbranch_scc0 K2_NF2_170
    v_rcp_f32 v106, v90
    v_fma_f32 v118, |v94|, s63, v118
    v_mov_b32 v90, 1.0
    v_mul_f32 v106, v94, v106
    v_mov_b32 v94, 0
    v_cvt_f64_f32 v[106:107], v106
    ds_add_f64 v115, v[106:107] offset:512
    v_add_u32 v115, 1024, v115
K2_NF2_170:
    s_bitcmp1_b32 s64, 23
    s_cbranch_scc0 K2_NF2_171
    v_rcp_f32 v106, v91
    v_fma_f32 v118, |v95|, s63, v118
    v_mov_b32 v91, 1.0
    v_mul_f32 v106, v95, v106
    v_mov_b32 v95, 0
    v_cvt_f64_f32 v[106:107], v106
    ds_add_f64 v117, v[106:107] offset:512
    v_add_u32 v117, 1024, v117
K2_NF2_171:
    s_branch K2_RT2_16
K2_FL3_00:
    v_pk_fma_f32 v[112:113], v[2:3], v[88:89], v[92:93]
    v_pk_fma_f32 v[88:89], v[88:89], v[80:81], v[88:89]
    v_pk_fma_f32 v[92:93], v[92:93], v[80:81], v[112:113]
    s_bitcmp1_b32 s40, 24
    s_cbranch_scc0 K2_NF3_000
    v_rcp_f32 v106, v88
    v_fma_f32 v118, |v92|, s63, v118
    v_mov_b32 v88, 1.0
    v_mul_f32 v106, v92, v106
    v_mov_b32 v92, 0
    v_cvt_f64_f32 v[106:107], v106
    ds_add_f64 v114, v[106:107] offset:0
    v_add_u32 v114, 1024, v114
K2_NF3_000:
    s_bitcmp1_b32 s64, 24
    s_cbranch_scc0 K2_NF3_001
    v_rcp_f32 v106, v89
    v_fma_f32 v118, |v93|, s63, v118
    v_mov_b32 v89, 1.0
    v_mul_f32 v106, v93, v106
    v_mov_b32 v93, 0
    v_cvt_f64_f32 v[106:107], v106
    ds_add_f64 v116, v[106:107] offset:0
    v_add_u32 v116, 1024, v116
K2_NF3_001:
    v_pk_fma_f32 v[112:113], v[4:5], v[88:89], v[92:93]
    v_pk_fma_f32 v[88:89], v[88:89], v[82:83], v[88:89]
    v_pk_fma_f32 v[92:93], v[92:93], v[82:83], v[112:113]
    s_bitcmp1_b32 s40, 25
    s_cbranch_scc0 K2_NF3_010
    v_rcp_f32 v106, v88
    v_fma_f32 v118, |v92|, s63, v118
    v_mov_b32 v88, 1.0
    v_mul_f32 v106, v92, v106
    v_mov_b32 v92, 0
    v_cvt_f64_f32 v[106:107], v106
    ds_add_f64 v114, v[106:107] offset:0
    v_add_u32 v114, 1024, v114
K2_NF3_010:
    s_bitcmp1_b32 s64, 25
    s_cbranch_scc0 K2_NF3_011
    v_rcp_f32 v106, v89
    v_fma_f32 v118, |v93|, s63, v118
    v_mov_b32 v89, 1.0
    v_mul_f32 v106, v93, v106
    v_mov_b32 v93, 0
    v_cvt_f64_f32 v[106:107], v106
    ds_add_f64 v116, v[106:107] offset:0
    v_add_u32 v116, 1024, v116
K2_NF3_011:
    v_pk_fma_f32 v[112:113], v[6:7], v[88:89], v[92:93]
    v_pk_fma_f32 v[88:89], v[88:89], v[84:85], v[88:89]
    v_pk_fma_f32 v[92:93], v[92:93], v[84:85], v[112:113]
    s_bitcmp1_b32 s40, 26
    s_cbranch_scc0 K2_NF3_020
    v_rcp_f32 v106, v88
    v_fma_f32 v118, |v92|, s63, v118
    v_mov_b32 v88, 1.0
    v_mul_f32 v106, v92, v106
    v_mov_b32 v92, 0
    v_cvt_f64_f32 v[106:107], v106
    ds_add_f64 v114, v[106:107] offset:0
    v_add_u32 v114, 1024, v114
K2_NF3_020:
    s_bitcmp1_b32 s64, 26
    s_cbranch_scc0 K2_NF3_021
    v_rcp_f32 v106, v89
    v_fma_f32 v118, |v93|, s63, v118
    v_mov_b32 v89, 1.0
    v_mul_f32 v106, v93, v106
    v_mov_b32 v93, 0
    v_cvt_f64_f32 v[106:107], v106
    ds_add_f64 v116, v[106:107] offset:0
    v_add_u32 v116, 1024, v116
K2_NF3_021:
    s_branch K2_RT3_00
K2_FL3_03:
    v_pk_fma_f32 v[112:113], v[8:9], v[88:89], v[92:93]
    v_pk_fma_f32 v[88:89], v[88:89], v[80:81], v[88:89]
    v_pk_fma_f32 v[92:93], v[92:93], v[80:81], v[112:113]
    s_bitcmp1_b32 s40, 27
    s_cbranch_scc0 K2_NF3_030
    v_rcp_f32 v106, v88
    v_fma_f32 v118, |v92|, s63, v118
    v_mov_b32 v88, 1.0
    v_mul_f32 v106, v92, v106
    v_mov_b32 v92, 0
    v_cvt_f64_f32 v[106:107], v106
    ds_add_f64 v114, v[106:107] offset:0
    v_add_u32 v114, 1024, v114
K2_NF3_030:
    s_bitcmp1_b32 s64, 27
    s_cbranch_scc0 K2_NF3_031
    v_rcp_f32 v106, v89
    v_fma_f32 v118, |v93|, s63, v118
    v_mov_b32 v89, 1.0
    v_mul_f32 v106, v93, v106
    v_mov_b32 v93, 0
    v_cvt_f64_f32 v[106:107], v106
    ds_add_f64 v116, v[106:107] offset:0
    v_add_u32 v116, 1024, v116
K2_NF3_031:
    v_pk_fma_f32 v[112:113], v[10:11], v[88:89], v[92:93]
    v_pk_fma_f32 v[88:89], v[88:89], v[82:83], v[88:89]
    v_pk_fma_f32 v[92:93], v[92:93], v[82:83], v[112:113]
    s_bitcmp1_b32 s40, 28
    s_cbranch_scc0 K2_NF3_040
    v_rcp_f32 v106, v88
    v_fma_f32 v118, |v92|, s63, v118
    v_mov_b32 v88, 1.0
    v_mul_f32 v106, v92, v106
    v_mov_b32 v92, 0
    v_cvt_f64_f32 v[106:107], v106
    ds_add_f64 v114, v[106:107] offset:0
    v_add_u32 v114, 1024, v114
K2_NF3_040:
    s_bitcmp1_b32 s64, 28
    s_cbranch_scc0 K2_NF3_041
    v_rcp_f32 v106, v89
    v_fma_f32 v118, |v93|, s63, v118
    v_mov_b32 v89, 1.0
    v_mul_f32 v106, v93, v106
    v_mov_b32 v93, 0
    v_cvt_f64_f32 v[106:107], v106
    ds_add_f64 v116, v[106:107] offset:0
    v_add_u32 v116, 1024, v116
K2_NF3_041:
    v_pk_fma_f32 v[112:113], v[12:13], v[88:89], v[92:93]
    v_pk_fma_f32 v[88:89], v[88:89], v[84:85], v[88:89]
    v_pk_fma_f32 v[92:93], v[92:93], v[84:85], v[112:113]
    s_bitcmp1_b32 s40, 29
    s_cbranch_scc0 K2_NF3_050
    v_rcp_f32 v106, v88
    v_fma_f32 v118, |v92|, s63, v118
    v_mov_b32 v88, 1.0
    v_mul_f32 v106, v92, v106
    v_mov_b32 v92, 0
    v_cvt_f64_f32 v[106:107], v106
    ds_add_f64 v114, v[106:107] offset:0
    v_add_u32 v114, 1024, v114
K2_NF3_050:
    s_bitcmp1_b32 s64, 29
    s_cbranch_scc0 K2_NF3_051
    v_rcp_f32 v106, v89
    v_fma_f32 v118, |v93|, s63, v118
    v_mov_b32 v89, 1.0
    v_mul_f32 v106, v93, v106
    v_mov_b32 v93, 0
    v_cvt_f64_f32 v[106:107], v106
    ds_add_f64 v116, v[106:107] offset:0
    v_add_u32 v116, 1024, v116
K2_NF3_051:
    s_branch K2_RT3_03
K2_FL3_06:
    v_pk_fma_f32 v[112:113], v[14:15], v[88:89], v[92:93]
    v_pk_fma_f32 v[88:89], v[88:89], v[80:81], v[88:89]
    v_pk_fma_f32 v[92:93], v[92:93], v[80:81], v[112:113]
    s_bitcmp1_b32 s40, 30
    s_cbranch_scc0 K2_NF3_060
    v_rcp_f32 v106, v88
    v_fma_f32 v118, |v92|, s63, v118
    v_mov_b32 v88, 1.0
    v_mul_f32 v106, v92, v106
    v_mov_b32 v92, 0
    v_cvt_f64_f32 v[106:107], v106
    ds_add_f64 v114, v[106:107] offset:0
    v_add_u32 v114, 1024, v114
K2_NF3_060:
    s_bitcmp1_b32 s64, 30
    s_cbranch_scc0 K2_NF3_061
    v_rcp_f32 v106, v89
    v_fma_f32 v118, |v93|, s63, v118
    v_mov_b32 v89, 1.0
    v_mul_f32 v106, v93, v106
    v_mov_b32 v93, 0
    v_cvt_f64_f32 v[106:107], v106
    ds_add_f64 v116, v[106:107] offset:0
    v_add_u32 v116, 1024, v116
K2_NF3_061:
    v_pk_fma_f32 v[112:113], v[16:17], v[88:89], v[92:93]
    v_pk_fma_f32 v[88:89], v[88:89], v[82:83], v[88:89]
    v_pk_fma_f32 v[92:93], v[92:93], v[82:83], v[112:113]
    s_bitcmp1_b32 s40, 31
    s_cbranch_scc0 K2_NF3_070
    v_rcp_f32 v106, v88
    v_fma_f32 v118, |v92|, s63, v118
    v_mov_b32 v88, 1.0
    v_mul_f32 v106, v92, v106
    v_mov_b32 v92, 0
    v_cvt_f64_f32 v[106:107], v106
    ds_add_f64 v114, v[106:107] offset:0
    v_add_u32 v114, 1024, v114
K2_NF3_070:
    s_bitcmp1_b32 s64, 31
    s_cbranch_scc0 K2_NF3_071
    v_rcp_f32 v106, v89
    v_fma_f32 v118, |v93|, s63, v118
    v_mov_b32 v89, 1.0
    v_mul_f32 v106, v93, v106
    v_mov_b32 v93, 0
    v_cvt_f64_f32 v[106:107], v106
    ds_add_f64 v116, v[106:107] offset:0
    v_add_u32 v116, 1024, v116
K2_NF3_071:
    s_branch K2_RT3_06
K2_FL3_10:
    v_pk_fma_f32 v[112:113], v[18:19], v[90:91], v[94:95]
    v_pk_fma_f32 v[90:91], v[90:91], v[80:81], v[90:91]
    v_pk_fma_f32 v[94:95], v[94:95], v[80:81], v[112:113]
    s_bitcmp1_b32 s40, 24
    s_cbranch_scc0 K2_NF3_100
    v_rcp_f32 v106, v90
    v_fma_f32 v118, |v94|, s63, v118
    v_mov_b32 v90, 1.0
    v_mul_f32 v106, v94, v106
    v_mov_b32 v94, 0
    v_cvt_f64_f32 v[106:107], v106
    ds_add_f64 v115, v[106:107] offset:512
    v_add_u32 v115, 1024, v115
K2_NF3_100:
    s_bitcmp1_b32 s64, 24
    s_cbranch_scc0 K2_NF3_101
    v_rcp_f32 v106, v91
    v_fma_f32 v118, |v95|, s63, v118
    v_mov_b32 v91, 1.0
    v_mul_f32 v106, v95, v106
    v_mov_b32 v95, 0
    v_cvt_f64_f32 v[106:107], v106
    ds_add_f64 v117, v[106:107] offset:512
    v_add_u32 v117, 1024, v117
K2_NF3_101:
    v_pk_fma_f32 v[112:113], v[20:21], v[90:91], v[94:95]
    v_pk_fma_f32 v[90:91], v[90:91], v[82:83], v[90:91]
    v_pk_fma_f32 v[94:95], v[94:95], v[82:83], v[112:113]
    s_bitcmp1_b32 s40, 25
    s_cbranch_scc0 K2_NF3_110
    v_rcp_f32 v106, v90
    v_fma_f32 v118, |v94|, s63, v118
    v_mov_b32 v90, 1.0
    v_mul_f32 v106, v94, v106
    v_mov_b32 v94, 0
    v_cvt_f64_f32 v[106:107], v106
    ds_add_f64 v115, v[106:107] offset:512
    v_add_u32 v115, 1024, v115
K2_NF3_110:
    s_bitcmp1_b32 s64, 25
    s_cbranch_scc0 K2_NF3_111
    v_rcp_f32 v106, v91
    v_fma_f32 v118, |v95|, s63, v118
    v_mov_b32 v91, 1.0
    v_mul_f32 v106, v95, v106
    v_mov_b32 v95, 0
    v_cvt_f64_f32 v[106:107], v106
    ds_add_f64 v117, v[106:107] offset:512
    v_add_u32 v117, 1024, v117
K2_NF3_111:
    v_pk_fma_f32 v[112:113], v[22:23], v[90:91], v[94:95]
    v_pk_fma_f32 v[90:91], v[90:91], v[84:85], v[90:91]
    v_pk_fma_f32 v[94:95], v[94:95], v[84:85], v[112:113]
    s_bitcmp1_b32 s40, 26
    s_cbranch_scc0 K2_NF3_120
    v_rcp_f32 v106, v90
    v_fma_f32 v118, |v94|, s63, v118
    v_mov_b32 v90, 1.0
    v_mul_f32 v106, v94, v106
    v_mov_b32 v94, 0
    v_cvt_f64_f32 v[106:107], v106
    ds_add_f64 v115, v[106:107] offset:512
    v_add_u32 v115, 1024, v115
K2_NF3_120:
    s_bitcmp1_b32 s64, 26
    s_cbranch_scc0 K2_NF3_121
    v_rcp_f32 v106, v91
    v_fma_f32 v118, |v95|, s63, v118
    v_mov_b32 v91, 1.0
    v_mul_f32 v106, v95, v106
    v_mov_b32 v95, 0
    v_cvt_f64_f32 v[106:107], v106
    ds_add_f64 v117, v[106:107] offset:512
    v_add_u32 v117, 1024, v117
K2_NF3_121:
    s_branch K2_RT3_10
K2_FL3_13:
    v_pk_fma_f32 v[112:113], v[24:25], v[90:91], v[94:95]
    v_pk_fma_f32 v[90:91], v[90:91], v[80:81], v[90:91]
    v_pk_fma_f32 v[94:95], v[94:95], v[80:81], v[112:113]
    s_bitcmp1_b32 s40, 27
    s_cbranch_scc0 K2_NF3_130
    v_rcp_f32 v106, v90
    v_fma_f32 v118, |v94|, s63, v118
    v_mov_b32 v90, 1.0
    v_mul_f32 v106, v94, v106
    v_mov_b32 v94, 0
    v_cvt_f64_f32 v[106:107], v106
    ds_add_f64 v115, v[106:107] offset:512
    v_add_u32 v115, 1024, v115
K2_NF3_130:
    s_bitcmp1_b32 s64, 27
    s_cbranch_scc0 K2_NF3_131
    v_rcp_f32 v106, v91
    v_fma_f32 v118, |v95|, s63, v118
    v_mov_b32 v91, 1.0
    v_mul_f32 v106, v95, v106
    v_mov_b32 v95, 0
    v_cvt_f64_f32 v[106:107], v106
    ds_add_f64 v117, v[106:107] offset:512
    v_add_u32 v117, 1024, v117
K2_NF3_131:
    v_pk_fma_f32 v[112:113], v[26:27], v[90:91], v[94:95]
    v_pk_fma_f32 v[90:91], v[90:91], v[82:83], v[90:91]
    v_pk_fma_f32 v[94:95], v[94:95], v[82:83], v[112:113]
    s_bitcmp1_b32 s40, 28
    s_cbranch_scc0 K2_NF3_140
    v_rcp_f32 v106, v90
    v_fma_f32 v118, |v94|, s63, v118
    v_mov_b32 v90, 1.0
    v_mul_f32 v106, v94, v106
    v_mov_b32 v94, 0
    v_cvt_f64_f32 v[106:107], v106
    ds_add_f64 v115, v[106:107] offset:512
    v_add_u32 v115, 1024, v115
K2_NF3_140:
    s_bitcmp1_b32 s64, 28
    s_cbranch_scc0 K2_NF3_141
    v_rcp_f32 v106, v91
    v_fma_f32 v118, |v95|, s63, v118
    v_mov_b32 v91, 1.0
    v_mul_f32 v106, v95, v106
    v_mov_b32 v95, 0
    v_cvt_f64_f32 v[106:107], v106
    ds_add_f64 v117, v[106:107] offset:512
    v_add_u32 v117, 1024, v117
K2_NF3_141:
    v_pk_fma_f32 v[112:113], v[28:29], v[90:91], v[94:95]
    v_pk_fma_f32 v[90:91], v[90:91], v[84:85], v[90:91]
    v_pk_fma_f32 v[94:95], v[94:95], v[84:85], v[112:113]
    s_bitcmp1_b32 s40, 29
    s_cbranch_scc0 K2_NF3_150
    v_rcp_f32 v106, v90
    v_fma_f32 v118, |v94|, s63, v118
    v_mov_b32 v90, 1.0
    v_mul_f32 v106, v94, v106
    v_mov_b32 v94, 0
    v_cvt_f64_f32 v[106:107], v106
    ds_add_f64 v115, v[106:107] offset:512
    v_add_u32 v115, 1024, v115
K2_NF3_150:
    s_bitcmp1_b32 s64, 29
    s_cbranch_scc0 K2_NF3_151
    v_rcp_f32 v106, v91
    v_fma_f32 v118, |v95|, s63, v118
    v_mov_b32 v91, 1.0
    v_mul_f32 v106, v95, v106
    v_mov_b32 v95, 0
    v_cvt_f64_f32 v[106:107], v106
    ds_add_f64 v117, v[106:107] offset:512
    v_add_u32 v117, 1024, v117
K2_NF3_151:
    s_branch K2_RT3_13
K2_FL3_16:
    v_pk_fma_f32 v[112:113], v[30:31], v[90:91], v[94:95]
    v_pk_fma_f32 v[90:91], v[90:91], v[80:81], v[90:91]
    v_pk_fma_f32 v[94:95], v[94:95], v[80:81], v[112:113]
    s_bitcmp1_b32 s40, 30
    s_cbranch_scc0 K2_NF3_160
    v_rcp_f32 v106, v90
    v_fma_f32 v118, |v94|, s63, v118
    v_mov_b32 v90, 1.0
    v_mul_f32 v106, v94, v106
    v_mov_b32 v94, 0
    v_cvt_f64_f32 v[106:107], v106
    ds_add_f64 v115, v[106:107] offset:512
    v_add_u32 v115, 1024, v115
K2_NF3_160:
    s_bitcmp1_b32 s64, 30
    s_cbranch_scc0 K2_NF3_161
    v_rcp_f32 v106, v91
    v_fma_f32 v118, |v95|, s63, v118
    v_mov_b32 v91, 1.0
    v_mul_f32 v106, v95, v106
    v_mov_b32 v95, 0
    v_cvt_f64_f32 v[106:107], v106
    ds_add_f64 v117, v[106:107] offset:512
    v_add_u32 v117, 1024, v117
K2_NF3_161:
    v_pk_fma_f32 v[112:113], v[32:33], v[90:91], v[94:95]
    v_pk_fma_f32 v[90:91], v[90:91], v[82:83], v[90:91]
    v_pk_fma_f32 v[94:95], v[94:95], v[82:83], v[112:113]
    s_bitcmp1_b32 s40, 31
    s_cbranch_scc0 K2_NF3_170
    v_rcp_f32 v106, v90
    v_fma_f32 v118, |v94|, s63, v118
    v_mov_b32 v90, 1.0
    v_mul_f32 v106, v94, v106
    v_mov_b32 v94, 0
    v_cvt_f64_f32 v[106:107], v106
    ds_add_f64 v115, v[106:107] offset:512
    v_add_u32 v115, 1024, v115
K2_NF3_170:
    s_bitcmp1_b32 s64, 31
    s_cbranch_scc0 K2_NF3_171
    v_rcp_f32 v106, v91
    v_fma_f32 v118, |v95|, s63, v118
    v_mov_b32 v91, 1.0
    v_mul_f32 v106, v95, v106
    v_mov_b32 v95, 0
    v_cvt_f64_f32 v[106:107], v106
    ds_add_f64 v117, v[106:107] offset:512
    v_add_u32 v117, 1024, v117
K2_NF3_171:
    s_branch K2_RT3_16
K2_FL4_00:
    v_pk_fma_f32 v[112:113], v[2:3], v[88:89], v[92:93]
    v_pk_fma_f32 v[88:89], v[88:89], v[80:81], v[88:89]
    v_pk_fma_f32 v[92:93], v[92:93], v[80:81], v[112:113]
    s_bitcmp1_b32 s41, 0
    s_cbranch_scc0 K2_NF4_000
    v_rcp_f32 v106, v88
    v_fma_f32 v118, |v92|, s63, v118
    v_mov_b32 v88, 1.0
    v_mul_f32 v106, v92, v106
    v_mov_b32 v92, 0
    v_cvt_f64_f32 v[106:107], v106
    ds_add_f64 v114, v[106:107] offset:0
    v_add_u32 v114, 1024, v114
K2_NF4_000:
    s_bitcmp1_b32 s65, 0
    s_cbranch_scc0 K2_NF4_001
    v_rcp_f32 v106, v89
    v_fma_f32 v118, |v93|, s63, v118
    v_mov_b32 v89, 1.0
    v_mul_f32 v106, v93, v106
    v_mov_b32 v93, 0
    v_cvt_f64_f32 v[106:107], v106
    ds_add_f64 v116, v[106:107] offset:0
    v_add_u32 v116, 1024, v116
K2_NF4_001:
    v_pk_fma_f32 v[112:113], v[4:5], v[88:89], v[92:93]
    v_pk_fma_f32 v[88:89], v[88:89], v[82:83], v[88:89]
    v_pk_fma_f32 v[92:93], v[92:93], v[82:83], v[112:113]
    s_bitcmp1_b32 s41, 1
    s_cbranch_scc0 K2_NF4_010
    v_rcp_f32 v106, v88
    v_fma_f32 v118, |v92|, s63, v118
    v_mov_b32 v88, 1.0
    v_mul_f32 v106, v92, v106
    v_mov_b32 v92, 0
    v_cvt_f64_f32 v[106:107], v106
    ds_add_f64 v114, v[106:107] offset:0
    v_add_u32 v114, 1024, v114
K2_NF4_010:
    s_bitcmp1_b32 s65, 1
    s_cbranch_scc0 K2_NF4_011
    v_rcp_f32 v106, v89
    v_fma_f32 v118, |v93|, s63, v118
    v_mov_b32 v89, 1.0
    v_mul_f32 v106, v93, v106
    v_mov_b32 v93, 0
    v_cvt_f64_f32 v[106:107], v106
    ds_add_f64 v116, v[106:107] offset:0
    v_add_u32 v116, 1024, v116
K2_NF4_011:
    v_pk_fma_f32 v[112:113], v[6:7], v[88:89], v[92:93]
    v_pk_fma_f32 v[88:89], v[88:89], v[84:85], v[88:89]
    v_pk_fma_f32 v[92:93], v[92:93], v[84:85], v[112:113]
    s_bitcmp1_b32 s41, 2
    s_cbranch_scc0 K2_NF4_020
    v_rcp_f32 v106, v88
    v_fma_f32 v118, |v92|, s63, v118
    v_mov_b32 v88, 1.0
    v_mul_f32 v106, v92, v106
    v_mov_b32 v92, 0
    v_cvt_f64_f32 v[106:107], v106
    ds_add_f64 v114, v[106:107] offset:0
    v_add_u32 v114, 1024, v114
K2_NF4_020:
    s_bitcmp1_b32 s65, 2
    s_cbranch_scc0 K2_NF4_021
    v_rcp_f32 v106, v89
    v_fma_f32 v118, |v93|, s63, v118
    v_mov_b32 v89, 1.0
    v_mul_f32 v106, v93, v106
    v_mov_b32 v93, 0
    v_cvt_f64_f32 v[106:107], v106
    ds_add_f64 v116, v[106:107] offset:0
    v_add_u32 v116, 1024, v116
K2_NF4_021:
    s_branch K2_RT4_00
K2_FL4_03:
    v_pk_fma_f32 v[112:113], v[8:9], v[88:89], v[92:93]
    v_pk_fma_f32 v[88:89], v[88:89], v[80:81], v[88:89]
    v_pk_fma_f32 v[92:93], v[92:93], v[80:81], v[112:113]
    s_bitcmp1_b32 s41, 3
    s_cbranch_scc0 K2_NF4_030
    v_rcp_f32 v106, v88
    v_fma_f32 v118, |v92|, s63, v118
    v_mov_b32 v88, 1.0
    v_mul_f32 v106, v92, v106
    v_mov_b32 v92, 0
    v_cvt_f64_f32 v[106:107], v106
    ds_add_f64 v114, v[106:107] offset:0
    v_add_u32 v114, 1024, v114
K2_NF4_030:
    s_bitcmp1_b32 s65, 3
    s_cbranch_scc0 K2_NF4_031
    v_rcp_f32 v106, v89
    v_fma_f32 v118, |v93|, s63, v118
    v_mov_b32 v89, 1.0
    v_mul_f32 v106, v93, v106
    v_mov_b32 v93, 0
    v_cvt_f64_f32 v[106:107], v106
    ds_add_f64 v116, v[106:107] offset:0
    v_add_u32 v116, 1024, v116
K2_NF4_031:
    v_pk_fma_f32 v[112:113], v[10:11], v[88:89], v[92:93]
    v_pk_fma_f32 v[88:89], v[88:89], v[82:83], v[88:89]
    v_pk_fma_f32 v[92:93], v[92:93], v[82:83], v[112:113]
    s_bitcmp1_b32 s41, 4
    s_cbranch_scc0 K2_NF4_040
    v_rcp_f32 v106, v88
    v_fma_f32 v118, |v92|, s63, v118
    v_mov_b32 v88, 1.0
    v_mul_f32 v106, v92, v106
    v_mov_b32 v92, 0
    v_cvt_f64_f32 v[106:107], v106
    ds_add_f64 v114, v[106:107] offset:0
    v_add_u32 v114, 1024, v114
K2_NF4_040:
    s_bitcmp1_b32 s65, 4
    s_cbranch_scc0 K2_NF4_041
    v_rcp_f32 v106, v89
    v_fma_f32 v118, |v93|, s63, v118
    v_mov_b32 v89, 1.0
    v_mul_f32 v106, v93, v106
    v_mov_b32 v93, 0
    v_cvt_f64_f32 v[106:107], v106
    ds_add_f64 v116, v[106:107] offset:0
    v_add_u32 v116, 1024, v116
K2_NF4_041:
    v_pk_fma_f32 v[112:113], v[12:13], v[88:89], v[92:93]
    v_pk_fma_f32 v[88:89], v[88:89], v[84:85], v[88:89]
    v_pk_fma_f32 v[92:93], v[92:93], v[84:85], v[112:113]
    s_bitcmp1_b32 s41, 5
    s_cbranch_scc0 K2_NF4_050
    v_rcp_f32 v106, v88
    v_fma_f32 v118, |v92|, s63, v118
    v_mov_b32 v88, 1.0
    v_mul_f32 v106, v92, v106
    v_mov_b32 v92, 0
    v_cvt_f64_f32 v[106:107], v106
    ds_add_f64 v114, v[106:107] offset:0
    v_add_u32 v114, 1024, v114
K2_NF4_050:
    s_bitcmp1_b32 s65, 5
    s_cbranch_scc0 K2_NF4_051
    v_rcp_f32 v106, v89
    v_fma_f32 v118, |v93|, s63, v118
    v_mov_b32 v89, 1.0
    v_mul_f32 v106, v93, v106
    v_mov_b32 v93, 0
    v_cvt_f64_f32 v[106:107], v106
    ds_add_f64 v116, v[106:107] offset:0
    v_add_u32 v116, 1024, v116
K2_NF4_051:
    s_branch K2_RT4_03
K2_FL4_06:
    v_pk_fma_f32 v[112:113], v[14:15], v[88:89], v[92:93]
    v_pk_fma_f32 v[88:89], v[88:89], v[80:81], v[88:89]
    v_pk_fma_f32 v[92:93], v[92:93], v[80:81], v[112:113]
    s_bitcmp1_b32 s41, 6
    s_cbranch_scc0 K2_NF4_060
    v_rcp_f32 v106, v88
    v_fma_f32 v118, |v92|, s63, v118
    v_mov_b32 v88, 1.0
    v_mul_f32 v106, v92, v106
    v_mov_b32 v92, 0
    v_cvt_f64_f32 v[106:107], v106
    ds_add_f64 v114, v[106:107] offset:0
    v_add_u32 v114, 1024, v114
K2_NF4_060:
    s_bitcmp1_b32 s65, 6
    s_cbranch_scc0 K2_NF4_061
    v_rcp_f32 v106, v89
    v_fma_f32 v118, |v93|, s63, v118
    v_mov_b32 v89, 1.0
    v_mul_f32 v106, v93, v106
    v_mov_b32 v93, 0
    v_cvt_f64_f32 v[106:107], v106
    ds_add_f64 v116, v[106:107] offset:0
    v_add_u32 v116, 1024, v116
K2_NF4_061:
    v_pk_fma_f32 v[112:113], v[16:17], v[88:89], v[92:93]
    v_pk_fma_f32 v[88:89], v[88:89], v[82:83], v[88:89]
    v_pk_fma_f32 v[92:93], v[92:93], v[82:83], v[112:113]
    s_bitcmp1_b32 s41, 7
    s_cbranch_scc0 K2_NF4_070
    v_rcp_f32 v106, v88
    v_fma_f32 v118, |v92|, s63, v118
    v_mov_b32 v88, 1.0
    v_mul_f32 v106, v92, v106
    v_mov_b32 v92, 0
    v_cvt_f64_f32 v[106:107], v106
    ds_add_f64 v114, v[106:107] offset:0
    v_add_u32 v114, 1024, v114
K2_NF4_070:
    s_bitcmp1_b32 s65, 7
    s_cbranch_scc0 K2_NF4_071
    v_rcp_f32 v106, v89
    v_fma_f32 v118, |v93|, s63, v118
    v_mov_b32 v89, 1.0
    v_mul_f32 v106, v93, v106
    v_mov_b32 v93, 0
    v_cvt_f64_f32 v[106:107], v106
    ds_add_f64 v116, v[106:107] offset:0
    v_add_u32 v116, 1024, v116
K2_NF4_071:
    s_branch K2_RT4_06
K2_FL4_10:
    v_pk_fma_f32 v[112:113], v[18:19], v[90:91], v[94:95]
    v_pk_fma_f32 v[90:91], v[90:91], v[80:81], v[90:91]
    v_pk_fma_f32 v[94:95], v[94:95], v[80:81], v[112:113]
    s_bitcmp1_b32 s41, 0
    s_cbranch_scc0 K2_NF4_100
    v_rcp_f32 v106, v90
    v_fma_f32 v118, |v94|, s63, v118
    v_mov_b32 v90, 1.0
    v_mul_f32 v106, v94, v106
    v_mov_b32 v94, 0
    v_cvt_f64_f32 v[106:107], v106
    ds_add_f64 v115, v[106:107] offset:512
    v_add_u32 v115, 1024, v115
K2_NF4_100:
    s_bitcmp1_b32 s65, 0
    s_cbranch_scc0 K2_NF4_101
    v_rcp_f32 v106, v91
    v_fma_f32 v118, |v95|, s63, v118
    v_mov_b32 v91, 1.0
    v_mul_f32 v106, v95, v106
    v_mov_b32 v95, 0
    v_cvt_f64_f32 v[106:107], v106
    ds_add_f64 v117, v[106:107] offset:512
    v_add_u32 v117, 1024, v117
K2_NF4_101:
    v_pk_fma_f32 v[112:113], v[20:21], v[90:91], v[94:95]
    v_pk_fma_f32 v[90:91], v[90:91], v[82:83], v[90:91]
    v_pk_fma_f32 v[94:95], v[94:95], v[82:83], v[112:113]
    s_bitcmp1_b32 s41, 1
    s_cbranch_scc0 K2_NF4_110
    v_rcp_f32 v106, v90
    v_fma_f32 v118, |v94|, s63, v118
    v_mov_b32 v90, 1.0
    v_mul_f32 v106, v94, v106
    v_mov_b32 v94, 0
    v_cvt_f64_f32 v[106:107], v106
    ds_add_f64 v115, v[106:107] offset:512
    v_add_u32 v115, 1024, v115
K2_NF4_110:
    s_bitcmp1_b32 s65, 1
    s_cbranch_scc0 K2_NF4_111
    v_rcp_f32 v106, v91
    v_fma_f32 v118, |v95|, s63, v118
    v_mov_b32 v91, 1.0
    v_mul_f32 v106, v95, v106
    v_mov_b32 v95, 0
    v_cvt_f64_f32 v[106:107], v106
    ds_add_f64 v117, v[106:107] offset:512
    v_add_u32 v117, 1024, v117
K2_NF4_111:
    v_pk_fma_f32 v[112:113], v[22:23], v[90:91], v[94:95]
    v_pk_fma_f32 v[90:91], v[90:91], v[84:85], v[90:91]
    v_pk_fma_f32 v[94:95], v[94:95], v[84:85], v[112:113]
    s_bitcmp1_b32 s41, 2
    s_cbranch_scc0 K2_NF4_120
    v_rcp_f32 v106, v90
    v_fma_f32 v118, |v94|, s63, v118
    v_mov_b32 v90, 1.0
    v_mul_f32 v106, v94, v106
    v_mov_b32 v94, 0
    v_cvt_f64_f32 v[106:107], v106
    ds_add_f64 v115, v[106:107] offset:512
    v_add_u32 v115, 1024, v115
K2_NF4_120:
    s_bitcmp1_b32 s65, 2
    s_cbranch_scc0 K2_NF4_121
    v_rcp_f32 v106, v91
    v_fma_f32 v118, |v95|, s63, v118
    v_mov_b32 v91, 1.0
    v_mul_f32 v106, v95, v106
    v_mov_b32 v95, 0
    v_cvt_f64_f32 v[106:107], v106
    ds_add_f64 v117, v[106:107] offset:512
    v_add_u32 v117, 1024, v117
K2_NF4_121:
    s_branch K2_RT4_10
K2_FL4_13:
    v_pk_fma_f32 v[112:113], v[24:25], v[90:91], v[94:95]
    v_pk_fma_f32 v[90:91], v[90:91], v[80:81], v[90:91]
    v_pk_fma_f32 v[94:95], v[94:95], v[80:81], v[112:113]
    s_bitcmp1_b32 s41, 3
    s_cbranch_scc0 K2_NF4_130
    v_rcp_f32 v106, v90
    v_fma_f32 v118, |v94|, s63, v118
    v_mov_b32 v90, 1.0
    v_mul_f32 v106, v94, v106
    v_mov_b32 v94, 0
    v_cvt_f64_f32 v[106:107], v106
    ds_add_f64 v115, v[106:107] offset:512
    v_add_u32 v115, 1024, v115
K2_NF4_130:
    s_bitcmp1_b32 s65, 3
    s_cbranch_scc0 K2_NF4_131
    v_rcp_f32 v106, v91
    v_fma_f32 v118, |v95|, s63, v118
    v_mov_b32 v91, 1.0
    v_mul_f32 v106, v95, v106
    v_mov_b32 v95, 0
    v_cvt_f64_f32 v[106:107], v106
    ds_add_f64 v117, v[106:107] offset:512
    v_add_u32 v117, 1024, v117
K2_NF4_131:
    v_pk_fma_f32 v[112:113], v[26:27], v[90:91], v[94:95]
    v_pk_fma_f32 v[90:91], v[90:91], v[82:83], v[90:91]
    v_pk_fma_f32 v[94:95], v[94:95], v[82:83], v[112:113]
    s_bitcmp1_b32 s41, 4
    s_cbranch_scc0 K2_NF4_140
    v_rcp_f32 v106, v90
    v_fma_f32 v118, |v94|, s63, v118
    v_mov_b32 v90, 1.0
    v_mul_f32 v106, v94, v106
    v_mov_b32 v94, 0
    v_cvt_f64_f32 v[106:107], v106
    ds_add_f64 v115, v[106:107] offset:512
    v_add_u32 v115, 1024, v115
K2_NF4_140:
    s_bitcmp1_b32 s65, 4
    s_cbranch_scc0 K2_NF4_141
    v_rcp_f32 v106, v91
    v_fma_f32 v118, |v95|, s63, v118
    v_mov_b32 v91, 1.0
    v_mul_f32 v106, v95, v106
    v_mov_b32 v95, 0
    v_cvt_f64_f32 v[106:107], v106
    ds_add_f64 v117, v[106:107] offset:512
    v_add_u32 v117, 1024, v117
K2_NF4_141:
    v_pk_fma_f32 v[112:113], v[28:29], v[90:91], v[94:95]
    v_pk_fma_f32 v[90:91], v[90:91], v[84:85], v[90:91]
    v_pk_fma_f32 v[94:95], v[94:95], v[84:85], v[112:113]
    s_bitcmp1_b32 s41, 5
    s_cbranch_scc0 K2_NF4_150
    v_rcp_f32 v106, v90
    v_fma_f32 v118, |v94|, s63, v118
    v_mov_b32 v90, 1.0
    v_mul_f32 v106, v94, v106
    v_mov_b32 v94, 0
    v_cvt_f64_f32 v[106:107], v106
    ds_add_f64 v115, v[106:107] offset:512
    v_add_u32 v115, 1024, v115
K2_NF4_150:
    s_bitcmp1_b32 s65, 5
    s_cbranch_scc0 K2_NF4_151
    v_rcp_f32 v106, v91
    v_fma_f32 v118, |v95|, s63, v118
    v_mov_b32 v91, 1.0
    v_mul_f32 v106, v95, v106
    v_mov_b32 v95, 0
    v_cvt_f64_f32 v[106:107], v106
    ds_add_f64 v117, v[106:107] offset:512
    v_add_u32 v117, 1024, v117
K2_NF4_151:
    s_branch K2_RT4_13
K2_FL4_16:
    v_pk_fma_f32 v[112:113], v[30:31], v[90:91], v[94:95]
    v_pk_fma_f32 v[90:91], v[90:91], v[80:81], v[90:91]
    v_pk_fma_f32 v[94:95], v[94:95], v[80:81], v[112:113]
    s_bitcmp1_b32 s41, 6
    s_cbranch_scc0 K2_NF4_160
    v_rcp_f32 v106, v90
    v_fma_f32 v118, |v94|, s63, v118
    v_mov_b32 v90, 1.0
    v_mul_f32 v106, v94, v106
    v_mov_b32 v94, 0
    v_cvt_f64_f32 v[106:107], v106
    ds_add_f64 v115, v[106:107] offset:512
    v_add_u32 v115, 1024, v115
K2_NF4_160:
    s_bitcmp1_b32 s65, 6
    s_cbranch_scc0 K2_NF4_161
    v_rcp_f32 v106, v91
    v_fma_f32 v118, |v95|, s63, v118
    v_mov_b32 v91, 1.0
    v_mul_f32 v106, v95, v106
    v_mov_b32 v95, 0
    v_cvt_f64_f32 v[106:107], v106
    ds_add_f64 v117, v[106:107] offset:512
    v_add_u32 v117, 1024, v117
K2_NF4_161:
    v_pk_fma_f32 v[112:113], v[32:33], v[90:91], v[94:95]
    v_pk_fma_f32 v[90:91], v[90:91], v[82:83], v[90:91]
    v_pk_fma_f32 v[94:95], v[94:95], v[82:83], v[112:113]
    s_bitcmp1_b32 s41, 7
    s_cbranch_scc0 K2_NF4_170
    v_rcp_f32 v106, v90
    v_fma_f32 v118, |v94|, s63, v118
    v_mov_b32 v90, 1.0
    v_mul_f32 v106, v94, v106
    v_mov_b32 v94, 0
    v_cvt_f64_f32 v[106:107], v106
    ds_add_f64 v115, v[106:107] offset:512
    v_add_u32 v115, 1024, v115
K2_NF4_170:
    s_bitcmp1_b32 s65, 7
    s_cbranch_scc0 K2_NF4_171
    v_rcp_f32 v106, v91
    v_fma_f32 v118, |v95|, s63, v118
    v_mov_b32 v91, 1.0
    v_mul_f32 v106, v95, v106
    v_mov_b32 v95, 0
    v_cvt_f64_f32 v[106:107], v106
    ds_add_f64 v117, v[106:107] offset:512
    v_add_u32 v117, 1024, v117
K2_NF4_171:
    s_branch K2_RT4_16
K2_FL5_00:
    v_pk_fma_f32 v[112:113], v[2:3], v[88:89], v[92:93]
    v_pk_fma_f32 v[88:89], v[88:89], v[80:81], v[88:89]
    v_pk_fma_f32 v[92:93], v[92:93], v[80:81], v[112:113]
    s_bitcmp1_b32 s41, 8
    s_cbranch_scc0 K2_NF5_000
    v_rcp_f32 v106, v88
    v_fma_f32 v118, |v92|, s63, v118
    v_mov_b32 v88, 1.0
    v_mul_f32 v106, v92, v106
    v_mov_b32 v92, 0
    v_cvt_f64_f32 v[106:107], v106
    ds_add_f64 v114, v[106:107] offset:0
    v_add_u32 v114, 1024, v114
K2_NF5_000:
    s_bitcmp1_b32 s65, 8
    s_cbranch_scc0 K2_NF5_001
    v_rcp_f32 v106, v89
    v_fma_f32 v118, |v93|, s63, v118
    v_mov_b32 v89, 1.0
    v_mul_f32 v106, v93, v106
    v_mov_b32 v93, 0
    v_cvt_f64_f32 v[106:107], v106
    ds_add_f64 v116, v[106:107] offset:0
    v_add_u32 v116, 1024, v116
K2_NF5_001:
    v_pk_fma_f32 v[112:113], v[4:5], v[88:89], v[92:93]
    v_pk_fma_f32 v[88:89], v[88:89], v[82:83], v[88:89]
    v_pk_fma_f32 v[92:93], v[92:93], v[82:83], v[112:113]
    s_bitcmp1_b32 s41, 9
    s_cbranch_scc0 K2_NF5_010
    v_rcp_f32 v106, v88
    v_fma_f32 v118, |v92|, s63, v118
    v_mov_b32 v88, 1.0
    v_mul_f32 v106, v92, v106
    v_mov_b32 v92, 0
    v_cvt_f64_f32 v[106:107], v106
    ds_add_f64 v114, v[106:107] offset:0
    v_add_u32 v114, 1024, v114
K2_NF5_010:
    s_bitcmp1_b32 s65, 9
    s_cbranch_scc0 K2_NF5_011
    v_rcp_f32 v106, v89
    v_fma_f32 v118, |v93|, s63, v118
    v_mov_b32 v89, 1.0
    v_mul_f32 v106, v93, v106
    v_mov_b32 v93, 0
    v_cvt_f64_f32 v[106:107], v106
    ds_add_f64 v116, v[106:107] offset:0
    v_add_u32 v116, 1024, v116
K2_NF5_011:
    v_pk_fma_f32 v[112:113], v[6:7], v[88:89], v[92:93]
    v_pk_fma_f32 v[88:89], v[88:89], v[84:85], v[88:89]
    v_pk_fma_f32 v[92:93], v[92:93], v[84:85], v[112:113]
    s_bitcmp1_b32 s41, 10
    s_cbranch_scc0 K2_NF5_020
    v_rcp_f32 v106, v88
    v_fma_f32 v118, |v92|, s63, v118
    v_mov_b32 v88, 1.0
    v_mul_f32 v106, v92, v106
    v_mov_b32 v92, 0
    v_cvt_f64_f32 v[106:107], v106
    ds_add_f64 v114, v[106:107] offset:0
    v_add_u32 v114, 1024, v114
K2_NF5_020:
    s_bitcmp1_b32 s65, 10
    s_cbranch_scc0 K2_NF5_021
    v_rcp_f32 v106, v89
    v_fma_f32 v118, |v93|, s63, v118
    v_mov_b32 v89, 1.0
    v_mul_f32 v106, v93, v106
    v_mov_b32 v93, 0
    v_cvt_f64_f32 v[106:107], v106
    ds_add_f64 v116, v[106:107] offset:0
    v_add_u32 v116, 1024, v116
K2_NF5_021:
    s_branch K2_RT5_00
K2_FL5_03:
    v_pk_fma_f32 v[112:113], v[8:9], v[88:89], v[92:93]
    v_pk_fma_f32 v[88:89], v[88:89], v[80:81], v[88:89]
    v_pk_fma_f32 v[92:93], v[92:93], v[80:81], v[112:113]
    s_bitcmp1_b32 s41, 11
    s_cbranch_scc0 K2_NF5_030
    v_rcp_f32 v106, v88
    v_fma_f32 v118, |v92|, s63, v118
    v_mov_b32 v88, 1.0
    v_mul_f32 v106, v92, v106
    v_mov_b32 v92, 0
    v_cvt_f64_f32 v[106:107], v106
    ds_add_f64 v114, v[106:107] offset:0
    v_add_u32 v114, 1024, v114
K2_NF5_030:
    s_bitcmp1_b32 s65, 11
    s_cbranch_scc0 K2_NF5_031
    v_rcp_f32 v106, v89
    v_fma_f32 v118, |v93|, s63, v118
    v_mov_b32 v89, 1.0
    v_mul_f32 v106, v93, v106
    v_mov_b32 v93, 0
    v_cvt_f64_f32 v[106:107], v106
    ds_add_f64 v116, v[106:107] offset:0
    v_add_u32 v116, 1024, v116
K2_NF5_031:
    v_pk_fma_f32 v[112:113], v[10:11], v[88:89], v[92:93]
    v_pk_fma_f32 v[88:89], v[88:89], v[82:83], v[88:89]
    v_pk_fma_f32 v[92:93], v[92:93], v[82:83], v[112:113]
    s_bitcmp1_b32 s41, 12
    s_cbranch_scc0 K2_NF5_040
    v_rcp_f32 v106, v88
    v_fma_f32 v118, |v92|, s63, v118
    v_mov_b32 v88, 1.0
    v_mul_f32 v106, v92, v106
    v_mov_b32 v92, 0
    v_cvt_f64_f32 v[106:107], v106
    ds_add_f64 v114, v[106:107] offset:0
    v_add_u32 v114, 1024, v114
K2_NF5_040:
    s_bitcmp1_b32 s65, 12
    s_cbranch_scc0 K2_NF5_041
    v_rcp_f32 v106, v89
    v_fma_f32 v118, |v93|, s63, v118
    v_mov_b32 v89, 1.0
    v_mul_f32 v106, v93, v106
    v_mov_b32 v93, 0
    v_cvt_f64_f32 v[106:107], v106
    ds_add_f64 v116, v[106:107] offset:0
    v_add_u32 v116, 1024, v116
K2_NF5_041:
    v_pk_fma_f32 v[112:113], v[12:13], v[88:89], v[92:93]
    v_pk_fma_f32 v[88:89], v[88:89], v[84:85], v[88:89]
    v_pk_fma_f32 v[92:93], v[92:93], v[84:85], v[112:113]
    s_bitcmp1_b32 s41, 13
    s_cbranch_scc0 K2_NF5_050
    v_rcp_f32 v106, v88
    v_fma_f32 v118, |v92|, s63, v118
    v_mov_b32 v88, 1.0
    v_mul_f32 v106, v92, v106
    v_mov_b32 v92, 0
    v_cvt_f64_f32 v[106:107], v106
    ds_add_f64 v114, v[106:107] offset:0
    v_add_u32 v114, 1024, v114
K2_NF5_050:
    s_bitcmp1_b32 s65, 13
    s_cbranch_scc0 K2_NF5_051
    v_rcp_f32 v106, v89
    v_fma_f32 v118, |v93|, s63, v118
    v_mov_b32 v89, 1.0
    v_mul_f32 v106, v93, v106
    v_mov_b32 v93, 0
    v_cvt_f64_f32 v[106:107], v106
    ds_add_f64 v116, v[106:107] offset:0
    v_add_u32 v116, 1024, v116
K2_NF5_051:
    s_branch K2_RT5_03
K2_FL5_10:
    v_pk_fma_f32 v[112:113], v[18:19], v[90:91], v[94:95]
    v_pk_fma_f32 v[90:91], v[90:91], v[80:81], v[90:91]
    v_pk_fma_f32 v[94:95], v[94:95], v[80:81], v[112:113]
    s_bitcmp1_b32 s41, 8
    s_cbranch_scc0 K2_NF5_100
    v_rcp_f32 v106, v90
    v_fma_f32 v118, |v94|, s63, v118
    v_mov_b32 v90, 1.0
    v_mul_f32 v106, v94, v106
    v_mov_b32 v94, 0
    v_cvt_f64_f32 v[106:107], v106
    ds_add_f64 v115, v[106:107] offset:512
    v_add_u32 v115, 1024, v115
K2_NF5_100:
    s_bitcmp1_b32 s65, 8
    s_cbranch_scc0 K2_NF5_101
    v_rcp_f32 v106, v91
    v_fma_f32 v118, |v95|, s63, v118
    v_mov_b32 v91, 1.0
    v_mul_f32 v106, v95, v106
    v_mov_b32 v95, 0
    v_cvt_f64_f32 v[106:107], v106
    ds_add_f64 v117, v[106:107] offset:512
    v_add_u32 v117, 1024, v117
K2_NF5_101:
    v_pk_fma_f32 v[112:113], v[20:21], v[90:91], v[94:95]
    v_pk_fma_f32 v[90:91], v[90:91], v[82:83], v[90:91]
    v_pk_fma_f32 v[94:95], v[94:95], v[82:83], v[112:113]
    s_bitcmp1_b32 s41, 9
    s_cbranch_scc0 K2_NF5_110
    v_rcp_f32 v106, v90
    v_fma_f32 v118, |v94|, s63, v118
    v_mov_b32 v90, 1.0
    v_mul_f32 v106, v94, v106
    v_mov_b32 v94, 0
    v_cvt_f64_f32 v[106:107], v106
    ds_add_f64 v115, v[106:107] offset:512
    v_add_u32 v115, 1024, v115
K2_NF5_110:
    s_bitcmp1_b32 s65, 9
    s_cbranch_scc0 K2_NF5_111
    v_rcp_f32 v106, v91
    v_fma_f32 v118, |v95|, s63, v118
    v_mov_b32 v91, 1.0
    v_mul_f32 v106, v95, v106
    v_mov_b32 v95, 0
    v_cvt_f64_f32 v[106:107], v106
    ds_add_f64 v117, v[106:107] offset:512
    v_add_u32 v117, 1024, v117
K2_NF5_111:
    v_pk_fma_f32 v[112:113], v[22:23], v[90:91], v[94:95]
    v_pk_fma_f32 v[90:91], v[90:91], v[84:85], v[90:91]
    v_pk_fma_f32 v[94:95], v[94:95], v[84:85], v[112:113]
    s_bitcmp1_b32 s41, 10
    s_cbranch_scc0 K2_NF5_120
    v_rcp_f32 v106, v90
    v_fma_f32 v118, |v94|, s63, v118
    v_mov_b32 v90, 1.0
    v_mul_f32 v106, v94, v106
    v_mov_b32 v94, 0
    v_cvt_f64_f32 v[106:107], v106
    ds_add_f64 v115, v[106:107] offset:512
    v_add_u32 v115, 1024, v115
K2_NF5_120:
    s_bitcmp1_b32 s65, 10
    s_cbranch_scc0 K2_NF5_121
    v_rcp_f32 v106, v91
    v_fma_f32 v118, |v95|, s63, v118
    v_mov_b32 v91, 1.0
    v_mul_f32 v106, v95, v106
    v_mov_b32 v95, 0
    v_cvt_f64_f32 v[106:107], v106
    ds_add_f64 v117, v[106:107] offset:512
    v_add_u32 v117, 1024, v117
K2_NF5_121:
    s_branch K2_RT5_10
K2_FL5_13:
    v_pk_fma_f32 v[112:113], v[24:25], v[90:91], v[94:95]
    v_pk_fma_f32 v[90:91], v[90:91], v[80:81], v[90:91]
    v_pk_fma_f32 v[94:95], v[94:95], v[80:81], v[112:113]
    s_bitcmp1_b32 s41, 11
    s_cbranch_scc0 K2_NF5_130
    v_rcp_f32 v106, v90
    v_fma_f32 v118, |v94|, s63, v118
    v_mov_b32 v90, 1.0
    v_mul_f32 v106, v94, v106
    v_mov_b32 v94, 0
    v_cvt_f64_f32 v[106:107], v106
    ds_add_f64 v115, v[106:107] offset:512
    v_add_u32 v115, 1024, v115
K2_NF5_130:
    s_bitcmp1_b32 s65, 11
    s_cbranch_scc0 K2_NF5_131
    v_rcp_f32 v106, v91
    v_fma_f32 v118, |v95|, s63, v118
    v_mov_b32 v91, 1.0
    v_mul_f32 v106, v95, v106
    v_mov_b32 v95, 0
    v_cvt_f64_f32 v[106:107], v106
    ds_add_f64 v117, v[106:107] offset:512
    v_add_u32 v117, 1024, v117
K2_NF5_131:
    v_pk_fma_f32 v[112:113], v[26:27], v[90:91], v[94:95]
    v_pk_fma_f32 v[90:91], v[90:91], v[82:83], v[90:91]
    v_pk_fma_f32 v[94:95], v[94:95], v[82:83], v[112:113]
    s_bitcmp1_b32 s41, 12
    s_cbranch_scc0 K2_NF5_140
    v_rcp_f32 v106, v90
    v_fma_f32 v118, |v94|, s63, v118
    v_mov_b32 v90, 1.0
    v_mul_f32 v106, v94, v106
    v_mov_b32 v94, 0
    v_cvt_f64_f32 v[106:107], v106
    ds_add_f64 v115, v[106:107] offset:512
    v_add_u32 v115, 1024, v115
K2_NF5_140:
    s_bitcmp1_b32 s65, 12
    s_cbranch_scc0 K2_NF5_141
    v_rcp_f32 v106, v91
    v_fma_f32 v118, |v95|, s63, v118
    v_mov_b32 v91, 1.0
    v_mul_f32 v106, v95, v106
    v_mov_b32 v95, 0
    v_cvt_f64_f32 v[106:107], v106
    ds_add_f64 v117, v[106:107] offset:512
    v_add_u32 v117, 1024, v117
K2_NF5_141:
    v_pk_fma_f32 v[112:113], v[28:29], v[90:91], v[94:95]
    v_pk_fma_f32 v[90:91], v[90:91], v[84:85], v[90:91]
    v_pk_fma_f32 v[94:95], v[94:95], v[84:85], v[112:113]
    s_bitcmp1_b32 s41, 13
    s_cbranch_scc0 K2_NF5_150
    v_rcp_f32 v106, v90
    v_fma_f32 v118, |v94|, s63, v118
    v_mov_b32 v90, 1.0
    v_mul_f32 v106, v94, v106
    v_mov_b32 v94, 0
    v_cvt_f64_f32 v[106:107], v106
    ds_add_f64 v115, v[106:107] offset:512
    v_add_u32 v115, 1024, v115
K2_NF5_150:
    s_bitcmp1_b32 s65, 13
    s_cbranch_scc0 K2_NF5_151
    v_rcp_f32 v106, v91
    v_fma_f32 v118, |v95|, s63, v118
    v_mov_b32 v91, 1.0
    v_mul_f32 v106, v95, v106
    v_mov_b32 v95, 0
    v_cvt_f64_f32 v[106:107], v106
    ds_add_f64 v117, v[106:107] offset:512
    v_add_u32 v117, 1024, v117
K2_NF5_151:
    s_branch K2_RT5_13
K2_GLOOP:
    s_cmp_eq_u32 s58, 5
    s_cbranch_scc1 K2_POSg1
    s_cmp_eq_u32 s58, 4
    s_cbranch_scc1 K2_POSg2
    s_cmp_eq_u32 s58, 3
    s_cbranch_scc1 K2_POSg3
    s_cmp_eq_u32 s58, 2
    s_cbranch_scc1 K2_POSg4
    s_cmp_eq_u32 s58, 1
    s_cbranch_scc1 K2_POSg5
K2_POSg0:
    s_setprio 3
    v_mfma_f32_32x32x16_bf16 v[18:33], v[58:61], v[54:57], 0
    v_exp_f32 v80, v2
    v_exp_f32 v81, v3
    v_exp_f32 v82, v4
    v_exp_f32 v83, v5
    v_exp_f32 v84, v6
    v_exp_f32 v85, v7
    s_waitcnt lgkmcnt(0)
    v_mad_u32_u24 v102, v103, s44, v101
    s_mov_b64 exec, s[42:43]
    ds_read_b128 v[58:61], v99 offset:128
    s_mov_b64 exec, -1
    ds_read_b32 v72, v98 offset:64
    ds_read_b32 v74, v98 offset:80
    ds_read_b32 v76, v104 offset:64
    ds_read_b32 v78, v104 offset:80
    s_nop 0
    v_pk_add_f32 v[80:81], v[80:81], 1.0 op_sel_hi:[1,0]
    v_rcp_f32 v80, v80
    v_rcp_f32 v81, v81
    v_pk_add_f32 v[82:83], v[82:83], 1.0 op_sel_hi:[1,0]
    v_rcp_f32 v82, v82
    v_rcp_f32 v83, v83
    v_pk_add_f32 v[84:85], v[84:85], 1.0 op_sel_hi:[1,0]
    v_rcp_f32 v84, v84
    v_rcp_f32 v85, v85
    s_nop 0
    s_bitcmp1_b32 s36, 0
    s_cbranch_scc1 K2_FLg0_00
    v_pk_fma_f32 v[92:93], v[2:3], v[80:81], v[92:93]
    v_pk_fma_f32 v[92:93], v[4:5], v[82:83], v[92:93]
    v_pk_fma_f32 v[92:93], v[6:7], v[84:85], v[92:93]
K2_RTg0_00:
    v_mfma_f32_4x4x4_16b_bf16 v[18:21], v[62:63], v[42:43], v[18:21]
    v_mfma_f32_4x4x4_16b_bf16 v[22:25], v[62:63], v[44:45], v[22:25]
    v_exp_f32 v80, v8
    v_exp_f32 v81, v9
    v_exp_f32 v82, v10
    v_exp_f32 v83, v11
    v_exp_f32 v84, v12
    v_exp_f32 v85, v13
    s_nop 0
    v_pk_add_f32 v[80:81], v[80:81], 1.0 op_sel_hi:[1,0]
    v_rcp_f32 v80, v80
    v_rcp_f32 v81, v81
    v_pk_add_f32 v[82:83], v[82:83], 1.0 op_sel_hi:[1,0]
    v_rcp_f32 v82, v82
    v_rcp_f32 v83, v83
    v_pk_add_f32 v[84:85], v[84:85], 1.0 op_sel_hi:[1,0]
    v_rcp_f32 v84, v84
    v_rcp_f32 v85, v85
    s_nop 0
    s_bitcmp1_b32 s36, 3
    s_cbranch_scc1 K2_FLg0_03
    v_pk_fma_f32 v[92:93], v[8:9], v[80:81], v[92:93]
    v_pk_fma_f32 v[92:93], v[10:11], v[82:83], v[92:93]
    v_pk_fma_f32 v[92:93], v[12:13], v[84:85], v[92:93]
K2_RTg0_03:
    v_mfma_f32_4x4x4_16b_bf16 v[26:29], v[62:63], v[46:47], v[26:29]
    v_mfma_f32_4x4x4_16b_bf16 v[30:33], v[62:63], v[48:49], v[30:33]
    v_exp_f32 v80, v14
    v_exp_f32 v81, v15
    v_exp_f32 v82, v16
    v_exp_f32 v83, v17
    s_waitcnt vmcnt(0)
    ds_read_b64_tr_b16 v[52:53], v102 offset:0
    ds_read_b64_tr_b16 v[34:35], v96 offset:0
    ds_read_b64_tr_b16 v[36:37], v97 offset:512
    ds_read_b64_tr_b16 v[38:39], v96 offset:1024
    ds_read_b64_tr_b16 v[40:41], v97 offset:1536
    ds_read_b64_tr_b16 v[56:57], v102 offset:128
    ds_read_b64_tr_b16 v[42:43], v97 offset:0
    ds_read_b64_tr_b16 v[44:45], v96 offset:512
    ds_read_b64_tr_b16 v[46:47], v97 offset:1024
    ds_read_b64_tr_b16 v[48:49], v96 offset:1536
    s_nop 0
    v_pk_add_f32 v[80:81], v[80:81], 1.0 op_sel_hi:[1,0]
    v_rcp_f32 v80, v80
    v_rcp_f32 v81, v81
    v_pk_add_f32 v[82:83], v[82:83], 1.0 op_sel_hi:[1,0]
    v_rcp_f32 v82, v82
    v_rcp_f32 v83, v83
    s_nop 0
    s_bitcmp1_b32 s36, 6
    s_cbranch_scc1 K2_FLg0_06
    v_pk_fma_f32 v[92:93], v[14:15], v[80:81], v[92:93]
    v_pk_fma_f32 v[92:93], v[16:17], v[82:83], v[92:93]
K2_RTg0_06:
    s_waitcnt lgkmcnt(0)
    v_mfma_f32_32x32x16_bf16 v[2:17], v[58:61], v[50:53], 0
    v_exp_f32 v80, v18
    v_exp_f32 v81, v19
    v_exp_f32 v82, v20
    v_exp_f32 v83, v21
    v_exp_f32 v84, v22
    v_exp_f32 v85, v23
    buffer_load_dwordx4 v[72:73], s[8:11], 0 idxen offen offset:0 sc1 lds
    buffer_load_dwordx4 v[74:75], s[8:11], 0 idxen offen offset:1024 sc1 lds
    s_nop 0
    v_pk_add_f32 v[80:81], v[80:81], 1.0 op_sel_hi:[1,0]
    v_rcp_f32 v80, v80
    v_rcp_f32 v81, v81
    v_pk_add_f32 v[82:83], v[82:83], 1.0 op_sel_hi:[1,0]
    v_rcp_f32 v82, v82
    v_rcp_f32 v83, v83
    v_pk_add_f32 v[84:85], v[84:85], 1.0 op_sel_hi:[1,0]
    v_rcp_f32 v84, v84
    v_rcp_f32 v85, v85
    s_nop 0
    s_bitcmp1_b32 s36, 0
    s_cbranch_scc1 K2_FLg0_10
    v_pk_fma_f32 v[94:95], v[18:19], v[80:81], v[94:95]
    v_pk_fma_f32 v[94:95], v[20:21], v[82:83], v[94:95]
    v_pk_fma_f32 v[94:95], v[22:23], v[84:85], v[94:95]
K2_RTg0_10:
    v_mfma_f32_4x4x4_16b_bf16 v[2:5], v[62:63], v[34:35], v[2:5]
    v_mfma_f32_4x4x4_16b_bf16 v[6:9], v[62:63], v[36:37], v[6:9]
    v_exp_f32 v80, v24
    v_exp_f32 v81, v25
    v_exp_f32 v82, v26
    v_exp_f32 v83, v27
    v_exp_f32 v84, v28
    v_exp_f32 v85, v29
    buffer_load_dwordx4 v[76:77], s[8:11], 0 idxen offen offset:2048 sc1 lds
    buffer_load_dwordx4 v[78:79], s[8:11], 0 idxen offen offset:3072 sc1 lds
    s_nop 0
    v_pk_add_f32 v[80:81], v[80:81], 1.0 op_sel_hi:[1,0]
    v_rcp_f32 v80, v80
    v_rcp_f32 v81, v81
    v_pk_add_f32 v[82:83], v[82:83], 1.0 op_sel_hi:[1,0]
    v_rcp_f32 v82, v82
    v_rcp_f32 v83, v83
    v_pk_add_f32 v[84:85], v[84:85], 1.0 op_sel_hi:[1,0]
    v_rcp_f32 v84, v84
    v_rcp_f32 v85, v85
    s_nop 0
    s_bitcmp1_b32 s36, 3
    s_cbranch_scc1 K2_FLg0_13
    v_pk_fma_f32 v[94:95], v[24:25], v[80:81], v[94:95]
    v_pk_fma_f32 v[94:95], v[26:27], v[82:83], v[94:95]
    v_pk_fma_f32 v[94:95], v[28:29], v[84:85], v[94:95]
K2_RTg0_13:
    v_mfma_f32_4x4x4_16b_bf16 v[10:13], v[62:63], v[38:39], v[10:13]
    v_mfma_f32_4x4x4_16b_bf16 v[14:17], v[62:63], v[40:41], v[14:17]
    v_exp_f32 v80, v30
    v_exp_f32 v81, v31
    v_exp_f32 v82, v32
    v_exp_f32 v83, v33
    ds_read_b32 v103, v100 offset:16
    s_nop 0
    v_pk_add_f32 v[80:81], v[80:81], 1.0 op_sel_hi:[1,0]
    v_rcp_f32 v80, v80
    v_rcp_f32 v81, v81
    v_pk_add_f32 v[82:83], v[82:83], 1.0 op_sel_hi:[1,0]
    v_rcp_f32 v82, v82
    v_rcp_f32 v83, v83
    s_nop 0
    s_bitcmp1_b32 s36, 6
    s_cbranch_scc1 K2_FLg0_16
    v_pk_fma_f32 v[94:95], v[30:31], v[80:81], v[94:95]
    v_pk_fma_f32 v[94:95], v[32:33], v[82:83], v[94:95]
K2_RTg0_16:
K2_POSg1:
    s_setprio 3
    v_mfma_f32_32x32x16_bf16 v[18:33], v[58:61], v[54:57], 0
    v_exp_f32 v80, v2
    v_exp_f32 v81, v3
    v_exp_f32 v82, v4
    v_exp_f32 v83, v5
    v_exp_f32 v84, v6
    v_exp_f32 v85, v7
    s_waitcnt lgkmcnt(0)
    v_mad_u32_u24 v102, v103, s44, v101
    s_mov_b64 exec, s[42:43]
    ds_read_b128 v[58:61], v99 offset:256
    s_mov_b64 exec, -1
    ds_read_b32 v72, v98 offset:96
    ds_read_b32 v74, v98 offset:112
    ds_read_b32 v76, v104 offset:96
    ds_read_b32 v78, v104 offset:112
    s_nop 0
    v_pk_add_f32 v[80:81], v[80:81], 1.0 op_sel_hi:[1,0]
    v_rcp_f32 v80, v80
    v_rcp_f32 v81, v81
    v_pk_add_f32 v[82:83], v[82:83], 1.0 op_sel_hi:[1,0]
    v_rcp_f32 v82, v82
    v_rcp_f32 v83, v83
    v_pk_add_f32 v[84:85], v[84:85], 1.0 op_sel_hi:[1,0]
    v_rcp_f32 v84, v84
    v_rcp_f32 v85, v85
    s_nop 0
    s_bitcmp1_b32 s36, 8
    s_cbranch_scc1 K2_FLg1_00
    v_pk_fma_f32 v[92:93], v[2:3], v[80:81], v[92:93]
    v_pk_fma_f32 v[92:93], v[4:5], v[82:83], v[92:93]
    v_pk_fma_f32 v[92:93], v[6:7], v[84:85], v[92:93]
K2_RTg1_00:
    v_mfma_f32_4x4x4_16b_bf16 v[18:21], v[62:63], v[42:43], v[18:21]
    v_mfma_f32_4x4x4_16b_bf16 v[22:25], v[62:63], v[44:45], v[22:25]
    v_exp_f32 v80, v8
    v_exp_f32 v81, v9
    v_exp_f32 v82, v10
    v_exp_f32 v83, v11
    v_exp_f32 v84, v12
    v_exp_f32 v85, v13
    s_nop 0
    v_pk_add_f32 v[80:81], v[80:81], 1.0 op_sel_hi:[1,0]
    v_rcp_f32 v80, v80
    v_rcp_f32 v81, v81
    v_pk_add_f32 v[82:83], v[82:83], 1.0 op_sel_hi:[1,0]
    v_rcp_f32 v82, v82
    v_rcp_f32 v83, v83
    v_pk_add_f32 v[84:85], v[84:85], 1.0 op_sel_hi:[1,0]
    v_rcp_f32 v84, v84
    v_rcp_f32 v85, v85
    s_nop 0
    s_bitcmp1_b32 s36, 11
    s_cbranch_scc1 K2_FLg1_03
    v_pk_fma_f32 v[92:93], v[8:9], v[80:81], v[92:93]
    v_pk_fma_f32 v[92:93], v[10:11], v[82:83], v[92:93]
    v_pk_fma_f32 v[92:93], v[12:13], v[84:85], v[92:93]
K2_RTg1_03:
    v_mfma_f32_4x4x4_16b_bf16 v[26:29], v[62:63], v[46:47], v[26:29]
    v_mfma_f32_4x4x4_16b_bf16 v[30:33], v[62:63], v[48:49], v[30:33]
    v_exp_f32 v80, v14
    v_exp_f32 v81, v15
    v_exp_f32 v82, v16
    v_exp_f32 v83, v17
    s_waitcnt vmcnt(0)
    ds_read_b64_tr_b16 v[52:53], v102 offset:0
    ds_read_b64_tr_b16 v[34:35], v96 offset:0
    ds_read_b64_tr_b16 v[36:37], v97 offset:512
    ds_read_b64_tr_b16 v[38:39], v96 offset:1024
    ds_read_b64_tr_b16 v[40:41], v97 offset:1536
    ds_read_b64_tr_b16 v[56:57], v102 offset:128
    ds_read_b64_tr_b16 v[42:43], v97 offset:0
    ds_read_b64_tr_b16 v[44:45], v96 offset:512
    ds_read_b64_tr_b16 v[46:47], v97 offset:1024
    ds_read_b64_tr_b16 v[48:49], v96 offset:1536
    s_nop 0
    v_pk_add_f32 v[80:81], v[80:81], 1.0 op_sel_hi:[1,0]
    v_rcp_f32 v80, v80
    v_rcp_f32 v81, v81
    v_pk_add_f32 v[82:83], v[82:83], 1.0 op_sel_hi:[1,0]
    v_rcp_f32 v82, v82
    v_rcp_f32 v83, v83
    s_nop 0
    s_bitcmp1_b32 s36, 14
    s_cbranch_scc1 K2_FLg1_06
    v_pk_fma_f32 v[92:93], v[14:15], v[80:81], v[92:93]
    v_pk_fma_f32 v[92:93], v[16:17], v[82:83], v[92:93]
K2_RTg1_06:
    s_waitcnt lgkmcnt(0)
    v_mfma_f32_32x32x16_bf16 v[2:17], v[58:61], v[50:53], 0
    v_exp_f32 v80, v18
    v_exp_f32 v81, v19
    v_exp_f32 v82, v20
    v_exp_f32 v83, v21
    v_exp_f32 v84, v22
    v_exp_f32 v85, v23
    buffer_load_dwordx4 v[72:73], s[8:11], 0 idxen offen offset:0 sc1 lds
    buffer_load_dwordx4 v[74:75], s[8:11], 0 idxen offen offset:1024 sc1 lds
    s_nop 0
    v_pk_add_f32 v[80:81], v[80:81], 1.0 op_sel_hi:[1,0]
    v_rcp_f32 v80, v80
    v_rcp_f32 v81, v81
    v_pk_add_f32 v[82:83], v[82:83], 1.0 op_sel_hi:[1,0]
    v_rcp_f32 v82, v82
    v_rcp_f32 v83, v83
    v_pk_add_f32 v[84:85], v[84:85], 1.0 op_sel_hi:[1,0]
    v_rcp_f32 v84, v84
    v_rcp_f32 v85, v85
    s_nop 0
    s_bitcmp1_b32 s36, 8
    s_cbranch_scc1 K2_FLg1_10
    v_pk_fma_f32 v[94:95], v[18:19], v[80:81], v[94:95]
    v_pk_fma_f32 v[94:95], v[20:21], v[82:83], v[94:95]
    v_pk_fma_f32 v[94:95], v[22:23], v[84:85], v[94:95]
K2_RTg1_10:
    v_mfma_f32_4x4x4_16b_bf16 v[2:5], v[62:63], v[34:35], v[2:5]
    v_mfma_f32_4x4x4_16b_bf16 v[6:9], v[62:63], v[36:37], v[6:9]
    v_exp_f32 v80, v24
    v_exp_f32 v81, v25
    v_exp_f32 v82, v26
    v_exp_f32 v83, v27
    v_exp_f32 v84, v28
    v_exp_f32 v85, v29
    buffer_load_dwordx4 v[76:77], s[8:11], 0 idxen offen offset:2048 sc1 lds
    buffer_load_dwordx4 v[78:79], s[8:11], 0 idxen offen offset:3072 sc1 lds
    s_nop 0
    v_pk_add_f32 v[80:81], v[80:81], 1.0 op_sel_hi:[1,0]
    v_rcp_f32 v80, v80
    v_rcp_f32 v81, v81
    v_pk_add_f32 v[82:83], v[82:83], 1.0 op_sel_hi:[1,0]
    v_rcp_f32 v82, v82
    v_rcp_f32 v83, v83
    v_pk_add_f32 v[84:85], v[84:85], 1.0 op_sel_hi:[1,0]
    v_rcp_f32 v84, v84
    v_rcp_f32 v85, v85
    s_nop 0
    s_bitcmp1_b32 s36, 11
    s_cbranch_scc1 K2_FLg1_13
    v_pk_fma_f32 v[94:95], v[24:25], v[80:81], v[94:95]
    v_pk_fma_f32 v[94:95], v[26:27], v[82:83], v[94:95]
    v_pk_fma_f32 v[94:95], v[28:29], v[84:85], v[94:95]
K2_RTg1_13:
    v_mfma_f32_4x4x4_16b_bf16 v[10:13], v[62:63], v[38:39], v[10:13]
    v_mfma_f32_4x4x4_16b_bf16 v[14:17], v[62:63], v[40:41], v[14:17]
    v_exp_f32 v80, v30
    v_exp_f32 v81, v31
    v_exp_f32 v82, v32
    v_exp_f32 v83, v33
    ds_read_b32 v103, v100 offset:24
    s_nop 0
    v_pk_add_f32 v[80:81], v[80:81], 1.0 op_sel_hi:[1,0]
    v_rcp_f32 v80, v80
    v_rcp_f32 v81, v81
    v_pk_add_f32 v[82:83], v[82:83], 1.0 op_sel_hi:[1,0]
    v_rcp_f32 v82, v82
    v_rcp_f32 v83, v83
    s_nop 0
    s_bitcmp1_b32 s36, 14
    s_cbranch_scc1 K2_FLg1_16
    v_pk_fma_f32 v[94:95], v[30:31], v[80:81], v[94:95]
    v_pk_fma_f32 v[94:95], v[32:33], v[82:83], v[94:95]
K2_RTg1_16:
K2_POSg2:
    s_setprio 3
    v_mfma_f32_32x32x16_bf16 v[18:33], v[58:61], v[54:57], 0
    v_exp_f32 v80, v2
    v_exp_f32 v81, v3
    v_exp_f32 v82, v4
    v_exp_f32 v83, v5
    v_exp_f32 v84, v6
    v_exp_f32 v85, v7
    s_waitcnt lgkmcnt(0)
    v_mad_u32_u24 v102, v103, s44, v101
    s_mov_b64 exec, s[42:43]
    ds_read_b128 v[58:61], v99 offset:384
    s_mov_b64 exec, -1
    ds_read_b32 v72, v98 offset:128
    ds_read_b32 v74, v98 offset:144
    ds_read_b32 v76, v104 offset:128
    ds_read_b32 v78, v104 offset:144
    s_nop 0
    v_pk_add_f32 v[80:81], v[80:81], 1.0 op_sel_hi:[1,0]
    v_rcp_f32 v80, v80
    v_rcp_f32 v81, v81
    v_pk_add_f32 v[82:83], v[82:83], 1.0 op_sel_hi:[1,0]
    v_rcp_f32 v82, v82
    v_rcp_f32 v83, v83
    v_pk_add_f32 v[84:85], v[84:85], 1.0 op_sel_hi:[1,0]
    v_rcp_f32 v84, v84
    v_rcp_f32 v85, v85
    s_nop 0
    s_bitcmp1_b32 s36, 16
    s_cbranch_scc1 K2_FLg2_00
    v_pk_fma_f32 v[92:93], v[2:3], v[80:81], v[92:93]
    v_pk_fma_f32 v[92:93], v[4:5], v[82:83], v[92:93]
    v_pk_fma_f32 v[92:93], v[6:7], v[84:85], v[92:93]
K2_RTg2_00:
    v_mfma_f32_4x4x4_16b_bf16 v[18:21], v[62:63], v[42:43], v[18:21]
    v_mfma_f32_4x4x4_16b_bf16 v[22:25], v[62:63], v[44:45], v[22:25]
    v_exp_f32 v80, v8
    v_exp_f32 v81, v9
    v_exp_f32 v82, v10
    v_exp_f32 v83, v11
    v_exp_f32 v84, v12
    v_exp_f32 v85, v13
    s_nop 0
    v_pk_add_f32 v[80:81], v[80:81], 1.0 op_sel_hi:[1,0]
    v_rcp_f32 v80, v80
    v_rcp_f32 v81, v81
    v_pk_add_f32 v[82:83], v[82:83], 1.0 op_sel_hi:[1,0]
    v_rcp_f32 v82, v82
    v_rcp_f32 v83, v83
    v_pk_add_f32 v[84:85], v[84:85], 1.0 op_sel_hi:[1,0]
    v_rcp_f32 v84, v84
    v_rcp_f32 v85, v85
    s_nop 0
    s_bitcmp1_b32 s36, 19
    s_cbranch_scc1 K2_FLg2_03
    v_pk_fma_f32 v[92:93], v[8:9], v[80:81], v[92:93]
    v_pk_fma_f32 v[92:93], v[10:11], v[82:83], v[92:93]
    v_pk_fma_f32 v[92:93], v[12:13], v[84:85], v[92:93]
K2_RTg2_03:
    v_mfma_f32_4x4x4_16b_bf16 v[26:29], v[62:63], v[46:47], v[26:29]
    v_mfma_f32_4x4x4_16b_bf16 v[30:33], v[62:63], v[48:49], v[30:33]
    v_exp_f32 v80, v14
    v_exp_f32 v81, v15
    v_exp_f32 v82, v16
    v_exp_f32 v83, v17
    s_waitcnt vmcnt(0)
    ds_read_b64_tr_b16 v[52:53], v102 offset:0
    ds_read_b64_tr_b16 v[34:35], v96 offset:0
    ds_read_b64_tr_b16 v[36:37], v97 offset:512
    ds_read_b64_tr_b16 v[38:39], v96 offset:1024
    ds_read_b64_tr_b16 v[40:41], v97 offset:1536
    ds_read_b64_tr_b16 v[56:57], v102 offset:128
    ds_read_b64_tr_b16 v[42:43], v97 offset:0
    ds_read_b64_tr_b16 v[44:45], v96 offset:512
    ds_read_b64_tr_b16 v[46:47], v97 offset:1024
    ds_read_b64_tr_b16 v[48:49], v96 offset:1536
    s_nop 0
    v_pk_add_f32 v[80:81], v[80:81], 1.0 op_sel_hi:[1,0]
    v_rcp_f32 v80, v80
    v_rcp_f32 v81, v81
    v_pk_add_f32 v[82:83], v[82:83], 1.0 op_sel_hi:[1,0]
    v_rcp_f32 v82, v82
    v_rcp_f32 v83, v83
    s_nop 0
    s_bitcmp1_b32 s36, 22
    s_cbranch_scc1 K2_FLg2_06
    v_pk_fma_f32 v[92:93], v[14:15], v[80:81], v[92:93]
    v_pk_fma_f32 v[92:93], v[16:17], v[82:83], v[92:93]
K2_RTg2_06:
    s_waitcnt lgkmcnt(0)
    v_mfma_f32_32x32x16_bf16 v[2:17], v[58:61], v[50:53], 0
    v_exp_f32 v80, v18
    v_exp_f32 v81, v19
    v_exp_f32 v82, v20
    v_exp_f32 v83, v21
    v_exp_f32 v84, v22
    v_exp_f32 v85, v23
    buffer_load_dwordx4 v[72:73], s[8:11], 0 idxen offen offset:0 sc1 lds
    buffer_load_dwordx4 v[74:75], s[8:11], 0 idxen offen offset:1024 sc1 lds
    s_nop 0
    v_pk_add_f32 v[80:81], v[80:81], 1.0 op_sel_hi:[1,0]
    v_rcp_f32 v80, v80
    v_rcp_f32 v81, v81
    v_pk_add_f32 v[82:83], v[82:83], 1.0 op_sel_hi:[1,0]
    v_rcp_f32 v82, v82
    v_rcp_f32 v83, v83
    v_pk_add_f32 v[84:85], v[84:85], 1.0 op_sel_hi:[1,0]
    v_rcp_f32 v84, v84
    v_rcp_f32 v85, v85
    s_nop 0
    s_bitcmp1_b32 s36, 16
    s_cbranch_scc1 K2_FLg2_10
    v_pk_fma_f32 v[94:95], v[18:19], v[80:81], v[94:95]
    v_pk_fma_f32 v[94:95], v[20:21], v[82:83], v[94:95]
    v_pk_fma_f32 v[94:95], v[22:23], v[84:85], v[94:95]
K2_RTg2_10:
    v_mfma_f32_4x4x4_16b_bf16 v[2:5], v[62:63], v[34:35], v[2:5]
    v_mfma_f32_4x4x4_16b_bf16 v[6:9], v[62:63], v[36:37], v[6:9]
    v_exp_f32 v80, v24
    v_exp_f32 v81, v25
    v_exp_f32 v82, v26
    v_exp_f32 v83, v27
    v_exp_f32 v84, v28
    v_exp_f32 v85, v29
    buffer_load_dwordx4 v[76:77], s[8:11], 0 idxen offen offset:2048 sc1 lds
    buffer_load_dwordx4 v[78:79], s[8:11], 0 idxen offen offset:3072 sc1 lds
    s_nop 0
    v_pk_add_f32 v[80:81], v[80:81], 1.0 op_sel_hi:[1,0]
    v_rcp_f32 v80, v80
    v_rcp_f32 v81, v81
    v_pk_add_f32 v[82:83], v[82:83], 1.0 op_sel_hi:[1,0]
    v_rcp_f32 v82, v82
    v_rcp_f32 v83, v83
    v_pk_add_f32 v[84:85], v[84:85], 1.0 op_sel_hi:[1,0]
    v_rcp_f32 v84, v84
    v_rcp_f32 v85, v85
    s_nop 0
    s_bitcmp1_b32 s36, 19
    s_cbranch_scc1 K2_FLg2_13
    v_pk_fma_f32 v[94:95], v[24:25], v[80:81], v[94:95]
    v_pk_fma_f32 v[94:95], v[26:27], v[82:83], v[94:95]
    v_pk_fma_f32 v[94:95], v[28:29], v[84:85], v[94:95]
K2_RTg2_13:
    v_mfma_f32_4x4x4_16b_bf16 v[10:13], v[62:63], v[38:39], v[10:13]
    v_mfma_f32_4x4x4_16b_bf16 v[14:17], v[62:63], v[40:41], v[14:17]
    v_exp_f32 v80, v30
    v_exp_f32 v81, v31
    v_exp_f32 v82, v32
    v_exp_f32 v83, v33
    ds_read_b32 v103, v100 offset:32
    s_nop 0
    v_pk_add_f32 v[80:81], v[80:81], 1.0 op_sel_hi:[1,0]
    v_rcp_f32 v80, v80
    v_rcp_f32 v81, v81
    v_pk_add_f32 v[82:83], v[82:83], 1.0 op_sel_hi:[1,0]
    v_rcp_f32 v82, v82
    v_rcp_f32 v83, v83
    s_nop 0
    s_bitcmp1_b32 s36, 22
    s_cbranch_scc1 K2_FLg2_16
    v_pk_fma_f32 v[94:95], v[30:31], v[80:81], v[94:95]
    v_pk_fma_f32 v[94:95], v[32:33], v[82:83], v[94:95]
K2_RTg2_16:
K2_POSg3:
    s_setprio 3
    v_mfma_f32_32x32x16_bf16 v[18:33], v[58:61], v[54:57], 0
    v_exp_f32 v80, v2
    v_exp_f32 v81, v3
    v_exp_f32 v82, v4
    v_exp_f32 v83, v5
    v_exp_f32 v84, v6
    v_exp_f32 v85, v7
    s_waitcnt lgkmcnt(0)
    v_mad_u32_u24 v102, v103, s44, v101
    s_mov_b64 exec, s[42:43]
    ds_read_b128 v[58:61], v99 offset:512
    s_mov_b64 exec, -1
    ds_read_b32 v72, v98 offset:160
    ds_read_b32 v74, v98 offset:176
    ds_read_b32 v76, v104 offset:160
    ds_read_b32 v78, v104 offset:176
    s_nop 0
    v_pk_add_f32 v[80:81], v[80:81], 1.0 op_sel_hi:[1,0]
    v_rcp_f32 v80, v80
    v_rcp_f32 v81, v81
    v_pk_add_f32 v[82:83], v[82:83], 1.0 op_sel_hi:[1,0]
    v_rcp_f32 v82, v82
    v_rcp_f32 v83, v83
    v_pk_add_f32 v[84:85], v[84:85], 1.0 op_sel_hi:[1,0]
    v_rcp_f32 v84, v84
    v_rcp_f32 v85, v85
    s_nop 0
    s_bitcmp1_b32 s36, 24
    s_cbranch_scc1 K2_FLg3_00
    v_pk_fma_f32 v[92:93], v[2:3], v[80:81], v[92:93]
    v_pk_fma_f32 v[92:93], v[4:5], v[82:83], v[92:93]
    v_pk_fma_f32 v[92:93], v[6:7], v[84:85], v[92:93]
K2_RTg3_00:
    v_mfma_f32_4x4x4_16b_bf16 v[18:21], v[62:63], v[42:43], v[18:21]
    v_mfma_f32_4x4x4_16b_bf16 v[22:25], v[62:63], v[44:45], v[22:25]
    v_exp_f32 v80, v8
    v_exp_f32 v81, v9
    v_exp_f32 v82, v10
    v_exp_f32 v83, v11
    v_exp_f32 v84, v12
    v_exp_f32 v85, v13
    s_nop 0
    v_pk_add_f32 v[80:81], v[80:81], 1.0 op_sel_hi:[1,0]
    v_rcp_f32 v80, v80
    v_rcp_f32 v81, v81
    v_pk_add_f32 v[82:83], v[82:83], 1.0 op_sel_hi:[1,0]
    v_rcp_f32 v82, v82
    v_rcp_f32 v83, v83
    v_pk_add_f32 v[84:85], v[84:85], 1.0 op_sel_hi:[1,0]
    v_rcp_f32 v84, v84
    v_rcp_f32 v85, v85
    s_nop 0
    s_bitcmp1_b32 s36, 27
    s_cbranch_scc1 K2_FLg3_03
    v_pk_fma_f32 v[92:93], v[8:9], v[80:81], v[92:93]
    v_pk_fma_f32 v[92:93], v[10:11], v[82:83], v[92:93]
    v_pk_fma_f32 v[92:93], v[12:13], v[84:85], v[92:93]
K2_RTg3_03:
    v_mfma_f32_4x4x4_16b_bf16 v[26:29], v[62:63], v[46:47], v[26:29]
    v_mfma_f32_4x4x4_16b_bf16 v[30:33], v[62:63], v[48:49], v[30:33]
    v_exp_f32 v80, v14
    v_exp_f32 v81, v15
    v_exp_f32 v82, v16
    v_exp_f32 v83, v17
    s_waitcnt vmcnt(0)
    ds_read_b64_tr_b16 v[52:53], v102 offset:0
    ds_read_b64_tr_b16 v[34:35], v96 offset:0
    ds_read_b64_tr_b16 v[36:37], v97 offset:512
    ds_read_b64_tr_b16 v[38:39], v96 offset:1024
    ds_read_b64_tr_b16 v[40:41], v97 offset:1536
    ds_read_b64_tr_b16 v[56:57], v102 offset:128
    ds_read_b64_tr_b16 v[42:43], v97 offset:0
    ds_read_b64_tr_b16 v[44:45], v96 offset:512
    ds_read_b64_tr_b16 v[46:47], v97 offset:1024
    ds_read_b64_tr_b16 v[48:49], v96 offset:1536
    s_nop 0
    v_pk_add_f32 v[80:81], v[80:81], 1.0 op_sel_hi:[1,0]
    v_rcp_f32 v80, v80
    v_rcp_f32 v81, v81
    v_pk_add_f32 v[82:83], v[82:83], 1.0 op_sel_hi:[1,0]
    v_rcp_f32 v82, v82
    v_rcp_f32 v83, v83
    s_nop 0
    s_bitcmp1_b32 s36, 30
    s_cbranch_scc1 K2_FLg3_06
    v_pk_fma_f32 v[92:93], v[14:15], v[80:81], v[92:93]
    v_pk_fma_f32 v[92:93], v[16:17], v[82:83], v[92:93]
K2_RTg3_06:
    s_setprio 2
    s_waitcnt lgkmcnt(0)
    v_mfma_f32_32x32x16_bf16 v[2:17], v[58:61], v[50:53], 0
    v_exp_f32 v80, v18
    v_exp_f32 v81, v19
    v_exp_f32 v82, v20
    v_exp_f32 v83, v21
    v_exp_f32 v84, v22
    v_exp_f32 v85, v23
    buffer_load_dwordx4 v[72:73], s[8:11], 0 idxen offen offset:0 sc1 lds
    buffer_load_dwordx4 v[74:75], s[8:11], 0 idxen offen offset:1024 sc1 lds
    s_nop 0
    v_pk_add_f32 v[80:81], v[80:81], 1.0 op_sel_hi:[1,0]
    v_rcp_f32 v80, v80
    v_rcp_f32 v81, v81
    v_pk_add_f32 v[82:83], v[82:83], 1.0 op_sel_hi:[1,0]
    v_rcp_f32 v82, v82
    v_rcp_f32 v83, v83
    v_pk_add_f32 v[84:85], v[84:85], 1.0 op_sel_hi:[1,0]
    v_rcp_f32 v84, v84
    v_rcp_f32 v85, v85
    s_nop 0
    s_bitcmp1_b32 s36, 24
    s_cbranch_scc1 K2_FLg3_10
    v_pk_fma_f32 v[94:95], v[18:19], v[80:81], v[94:95]
    v_pk_fma_f32 v[94:95], v[20:21], v[82:83], v[94:95]
    v_pk_fma_f32 v[94:95], v[22:23], v[84:85], v[94:95]
K2_RTg3_10:
    v_mfma_f32_4x4x4_16b_bf16 v[2:5], v[62:63], v[34:35], v[2:5]
    v_mfma_f32_4x4x4_16b_bf16 v[6:9], v[62:63], v[36:37], v[6:9]
    v_exp_f32 v80, v24
    v_exp_f32 v81, v25
    v_exp_f32 v82, v26
    v_exp_f32 v83, v27
    v_exp_f32 v84, v28
    v_exp_f32 v85, v29
    buffer_load_dwordx4 v[76:77], s[8:11], 0 idxen offen offset:2048 sc1 lds
    buffer_load_dwordx4 v[78:79], s[8:11], 0 idxen offen offset:3072 sc1 lds
    s_nop 0
    v_pk_add_f32 v[80:81], v[80:81], 1.0 op_sel_hi:[1,0]
    v_rcp_f32 v80, v80
    v_rcp_f32 v81, v81
    v_pk_add_f32 v[82:83], v[82:83], 1.0 op_sel_hi:[1,0]
    v_rcp_f32 v82, v82
    v_rcp_f32 v83, v83
    v_pk_add_f32 v[84:85], v[84:85], 1.0 op_sel_hi:[1,0]
    v_rcp_f32 v84, v84
    v_rcp_f32 v85, v85
    s_nop 0
    s_bitcmp1_b32 s36, 27
    s_cbranch_scc1 K2_FLg3_13
    v_pk_fma_f32 v[94:95], v[24:25], v[80:81], v[94:95]
    v_pk_fma_f32 v[94:95], v[26:27], v[82:83], v[94:95]
    v_pk_fma_f32 v[94:95], v[28:29], v[84:85], v[94:95]
K2_RTg3_13:
    v_mfma_f32_4x4x4_16b_bf16 v[10:13], v[62:63], v[38:39], v[10:13]
    v_mfma_f32_4x4x4_16b_bf16 v[14:17], v[62:63], v[40:41], v[14:17]
    v_exp_f32 v80, v30
    v_exp_f32 v81, v31
    v_exp_f32 v82, v32
    v_exp_f32 v83, v33
    ds_read_b32 v103, v100 offset:40
    s_nop 0
    v_pk_add_f32 v[80:81], v[80:81], 1.0 op_sel_hi:[1,0]
    v_rcp_f32 v80, v80
    v_rcp_f32 v81, v81
    v_pk_add_f32 v[82:83], v[82:83], 1.0 op_sel_hi:[1,0]
    v_rcp_f32 v82, v82
    v_rcp_f32 v83, v83
    s_nop 0
    s_bitcmp1_b32 s36, 30
    s_cbranch_scc1 K2_FLg3_16
    v_pk_fma_f32 v[94:95], v[30:31], v[80:81], v[94:95]
    v_pk_fma_f32 v[94:95], v[32:33], v[82:83], v[94:95]
K2_RTg3_16:
K2_POSg4:
    s_setprio 2
    v_mfma_f32_32x32x16_bf16 v[18:33], v[58:61], v[54:57], 0
    v_exp_f32 v80, v2
    v_exp_f32 v81, v3
    v_exp_f32 v82, v4
    v_exp_f32 v83, v5
    v_exp_f32 v84, v6
    v_exp_f32 v85, v7
    s_waitcnt lgkmcnt(0)
    v_mad_u32_u24 v102, v103, s44, v101
    s_mov_b64 exec, s[42:43]
    ds_read_b128 v[58:61], v99 offset:640
    s_mov_b64 exec, -1
    s_nop 0
    v_pk_add_f32 v[80:81], v[80:81], 1.0 op_sel_hi:[1,0]
    v_rcp_f32 v80, v80
    v_rcp_f32 v81, v81
    v_pk_add_f32 v[82:83], v[82:83], 1.0 op_sel_hi:[1,0]
    v_rcp_f32 v82, v82
    v_rcp_f32 v83, v83
    v_pk_add_f32 v[84:85], v[84:85], 1.0 op_sel_hi:[1,0]
    v_rcp_f32 v84, v84
    v_rcp_f32 v85, v85
    s_nop 0
    s_bitcmp1_b32 s37, 0
    s_cbranch_scc1 K2_FLg4_00
    v_pk_fma_f32 v[92:93], v[2:3], v[80:81], v[92:93]
    v_pk_fma_f32 v[92:93], v[4:5], v[82:83], v[92:93]
    v_pk_fma_f32 v[92:93], v[6:7], v[84:85], v[92:93]
K2_RTg4_00:
    v_mfma_f32_4x4x4_16b_bf16 v[18:21], v[62:63], v[42:43], v[18:21]
    v_mfma_f32_4x4x4_16b_bf16 v[22:25], v[62:63], v[44:45], v[22:25]
    v_exp_f32 v80, v8
    v_exp_f32 v81, v9
    v_exp_f32 v82, v10
    v_exp_f32 v83, v11
    v_exp_f32 v84, v12
    v_exp_f32 v85, v13
    s_nop 0
    v_pk_add_f32 v[80:81], v[80:81], 1.0 op_sel_hi:[1,0]
    v_rcp_f32 v80, v80
    v_rcp_f32 v81, v81
    v_pk_add_f32 v[82:83], v[82:83], 1.0 op_sel_hi:[1,0]
    v_rcp_f32 v82, v82
    v_rcp_f32 v83, v83
    v_pk_add_f32 v[84:85], v[84:85], 1.0 op_sel_hi:[1,0]
    v_rcp_f32 v84, v84
    v_rcp_f32 v85, v85
    s_nop 0
    s_bitcmp1_b32 s37, 3
    s_cbranch_scc1 K2_FLg4_03
    v_pk_fma_f32 v[92:93], v[8:9], v[80:81], v[92:93]
    v_pk_fma_f32 v[92:93], v[10:11], v[82:83], v[92:93]
    v_pk_fma_f32 v[92:93], v[12:13], v[84:85], v[92:93]
K2_RTg4_03:
    v_mfma_f32_4x4x4_16b_bf16 v[26:29], v[62:63], v[46:47], v[26:29]
    v_mfma_f32_4x4x4_16b_bf16 v[30:33], v[62:63], v[48:49], v[30:33]
    v_exp_f32 v80, v14
    v_exp_f32 v81, v15
    v_exp_f32 v82, v16
    v_exp_f32 v83, v17
    s_waitcnt vmcnt(0)
    ds_read_b64_tr_b16 v[52:53], v102 offset:0
    ds_read_b64_tr_b16 v[34:35], v96 offset:0
    ds_read_b64_tr_b16 v[36:37], v97 offset:512
    ds_read_b64_tr_b16 v[38:39], v96 offset:1024
    ds_read_b64_tr_b16 v[40:41], v97 offset:1536
    ds_read_b64_tr_b16 v[56:57], v102 offset:128
    ds_read_b64_tr_b16 v[42:43], v97 offset:0
    ds_read_b64_tr_b16 v[44:45], v96 offset:512
    ds_read_b64_tr_b16 v[46:47], v97 offset:1024
    ds_read_b64_tr_b16 v[48:49], v96 offset:1536
    s_nop 0
    v_pk_add_f32 v[80:81], v[80:81], 1.0 op_sel_hi:[1,0]
    v_rcp_f32 v80, v80
    v_rcp_f32 v81, v81
    v_pk_add_f32 v[82:83], v[82:83], 1.0 op_sel_hi:[1,0]
    v_rcp_f32 v82, v82
    v_rcp_f32 v83, v83
    s_nop 0
    s_bitcmp1_b32 s37, 6
    s_cbranch_scc1 K2_FLg4_06
    v_pk_fma_f32 v[92:93], v[14:15], v[80:81], v[92:93]
    v_pk_fma_f32 v[92:93], v[16:17], v[82:83], v[92:93]
K2_RTg4_06:
    s_setprio 1
    s_waitcnt lgkmcnt(0)
    v_mfma_f32_32x32x16_bf16 v[2:17], v[58:61], v[50:53], 0
    v_exp_f32 v80, v18
    v_exp_f32 v81, v19
    v_exp_f32 v82, v20
    v_exp_f32 v83, v21
    v_exp_f32 v84, v22
    v_exp_f32 v85, v23
    s_nop 0
    v_pk_add_f32 v[80:81], v[80:81], 1.0 op_sel_hi:[1,0]
    v_rcp_f32 v80, v80
    v_rcp_f32 v81, v81
    v_pk_add_f32 v[82:83], v[82:83], 1.0 op_sel_hi:[1,0]
    v_rcp_f32 v82, v82
    v_rcp_f32 v83, v83
    v_pk_add_f32 v[84:85], v[84:85], 1.0 op_sel_hi:[1,0]
    v_rcp_f32 v84, v84
    v_rcp_f32 v85, v85
    s_nop 0
    s_bitcmp1_b32 s37, 0
    s_cbranch_scc1 K2_FLg4_10
    v_pk_fma_f32 v[94:95], v[18:19], v[80:81], v[94:95]
    v_pk_fma_f32 v[94:95], v[20:21], v[82:83], v[94:95]
    v_pk_fma_f32 v[94:95], v[22:23], v[84:85], v[94:95]
K2_RTg4_10:
    v_mfma_f32_4x4x4_16b_bf16 v[2:5], v[62:63], v[34:35], v[2:5]
    v_mfma_f32_4x4x4_16b_bf16 v[6:9], v[62:63], v[36:37], v[6:9]
    v_exp_f32 v80, v24
    v_exp_f32 v81, v25
    v_exp_f32 v82, v26
    v_exp_f32 v83, v27
    v_exp_f32 v84, v28
    v_exp_f32 v85, v29
    s_nop 0
    v_pk_add_f32 v[80:81], v[80:81], 1.0 op_sel_hi:[1,0]
    v_rcp_f32 v80, v80
    v_rcp_f32 v81, v81
    v_pk_add_f32 v[82:83], v[82:83], 1.0 op_sel_hi:[1,0]
    v_rcp_f32 v82, v82
    v_rcp_f32 v83, v83
    v_pk_add_f32 v[84:85], v[84:85], 1.0 op_sel_hi:[1,0]
    v_rcp_f32 v84, v84
    v_rcp_f32 v85, v85
    s_nop 0
    s_bitcmp1_b32 s37, 3
    s_cbranch_scc1 K2_FLg4_13
    v_pk_fma_f32 v[94:95], v[24:25], v[80:81], v[94:95]
    v_pk_fma_f32 v[94:95], v[26:27], v[82:83], v[94:95]
    v_pk_fma_f32 v[94:95], v[28:29], v[84:85], v[94:95]
K2_RTg4_13:
    v_mfma_f32_4x4x4_16b_bf16 v[10:13], v[62:63], v[38:39], v[10:13]
    v_mfma_f32_4x4x4_16b_bf16 v[14:17], v[62:63], v[40:41], v[14:17]
    v_exp_f32 v80, v30
    v_exp_f32 v81, v31
    v_exp_f32 v82, v32
    v_exp_f32 v83, v33
    s_nop 0
    v_pk_add_f32 v[80:81], v[80:81], 1.0 op_sel_hi:[1,0]
    v_rcp_f32 v80, v80
    v_rcp_f32 v81, v81
    v_pk_add_f32 v[82:83], v[82:83], 1.0 op_sel_hi:[1,0]
    v_rcp_f32 v82, v82
    v_rcp_f32 v83, v83
    s_nop 0
    s_bitcmp1_b32 s37, 6
    s_cbranch_scc1 K2_FLg4_16
    v_pk_fma_f32 v[94:95], v[30:31], v[80:81], v[94:95]
    v_pk_fma_f32 v[94:95], v[32:33], v[82:83], v[94:95]
K2_RTg4_16:
K2_POSg5:
    s_setprio 1
    v_mfma_f32_32x32x16_bf16 v[18:33], v[58:61], v[54:57], 0
    v_exp_f32 v80, v2
    v_exp_f32 v81, v3
    v_exp_f32 v82, v4
    v_exp_f32 v83, v5
    v_exp_f32 v84, v6
    v_exp_f32 v85, v7
    s_nop 0
    v_pk_add_f32 v[80:81], v[80:81], 1.0 op_sel_hi:[1,0]
    v_rcp_f32 v80, v80
    v_rcp_f32 v81, v81
    v_pk_add_f32 v[82:83], v[82:83], 1.0 op_sel_hi:[1,0]
    v_rcp_f32 v82, v82
    v_rcp_f32 v83, v83
    v_pk_add_f32 v[84:85], v[84:85], 1.0 op_sel_hi:[1,0]
    v_rcp_f32 v84, v84
    v_rcp_f32 v85, v85
    s_nop 0
    s_bitcmp1_b32 s37, 8
    s_cbranch_scc1 K2_FLg5_00
    v_pk_fma_f32 v[92:93], v[2:3], v[80:81], v[92:93]
    v_pk_fma_f32 v[92:93], v[4:5], v[82:83], v[92:93]
    v_pk_fma_f32 v[92:93], v[6:7], v[84:85], v[92:93]
K2_RTg5_00:
    v_mfma_f32_4x4x4_16b_bf16 v[18:21], v[62:63], v[42:43], v[18:21]
    v_mfma_f32_4x4x4_16b_bf16 v[22:25], v[62:63], v[44:45], v[22:25]
    v_exp_f32 v80, v8
    v_exp_f32 v81, v9
    v_exp_f32 v82, v10
    v_exp_f32 v83, v11
    v_exp_f32 v84, v12
    v_exp_f32 v85, v13
    s_nop 0
    v_pk_add_f32 v[80:81], v[80:81], 1.0 op_sel_hi:[1,0]
    v_rcp_f32 v80, v80
    v_rcp_f32 v81, v81
    v_pk_add_f32 v[82:83], v[82:83], 1.0 op_sel_hi:[1,0]
    v_rcp_f32 v82, v82
    v_rcp_f32 v83, v83
    v_pk_add_f32 v[84:85], v[84:85], 1.0 op_sel_hi:[1,0]
    v_rcp_f32 v84, v84
    v_rcp_f32 v85, v85
    s_nop 0
    s_bitcmp1_b32 s37, 11
    s_cbranch_scc1 K2_FLg5_03
    v_pk_fma_f32 v[92:93], v[8:9], v[80:81], v[92:93]
    v_pk_fma_f32 v[92:93], v[10:11], v[82:83], v[92:93]
    v_pk_fma_f32 v[92:93], v[12:13], v[84:85], v[92:93]
K2_RTg5_03:
    v_mfma_f32_4x4x4_16b_bf16 v[26:29], v[62:63], v[46:47], v[26:29]
    v_mfma_f32_4x4x4_16b_bf16 v[30:33], v[62:63], v[48:49], v[30:33]
    v_exp_f32 v80, v14
    v_exp_f32 v81, v15
    v_exp_f32 v82, v16
    v_exp_f32 v83, v17
    s_cmp_eq_u32 s28, 0
    s_cbranch_scc1 K2_NOEg
    v_lshlrev_b32 v112, 4, v1
    s_add_u32 s45, s53, 32768
    s_add_u32 s46, s45, 32768
    buffer_load_dwordx4 v[34:37], v112, s[16:19], s45 offen offset:0 sc1
    buffer_load_dwordx4 v[38:41], v112, s[16:19], s45 offen offset:1024 sc1
    buffer_load_dwordx4 v[42:45], v112, s[16:19], s45 offen offset:2048 sc1
    buffer_load_dwordx4 v[46:49], v112, s[16:19], s45 offen offset:3072 sc1
    buffer_load_dwordx4 v[50:53], v112, s[16:19], s46 offen offset:0 sc1
    buffer_load_dwordx4 v[54:57], v112, s[16:19], s46 offen offset:1024 sc1
    buffer_load_dwordx4 v[58:61], v112, s[16:19], s46 offen offset:2048 sc1
    buffer_load_dwordx4 v[62:65], v112, s[16:19], s46 offen offset:3072 sc1
    s_mov_b32 s39, 1
K2_NOEg:
    s_nop 0
    v_pk_add_f32 v[80:81], v[80:81], 1.0 op_sel_hi:[1,0]
    v_rcp_f32 v80, v80
    v_rcp_f32 v81, v81
    v_pk_add_f32 v[82:83], v[82:83], 1.0 op_sel_hi:[1,0]
    v_rcp_f32 v82, v82
    v_rcp_f32 v83, v83
    s_nop 0
    v_pk_fma_f32 v[92:93], v[14:15], v[80:81], v[92:93]
    s_bitcmp1_b32 s41, 14
    s_cbranch_scc0 K2_NFg5_060
    v_cvt_f64_f32 v[106:107], v92
    v_mov_b32 v92, 0
    ds_add_f64 v114, v[106:107] offset:0
    v_add_u32 v114, 1024, v114
K2_NFg5_060:
    s_bitcmp1_b32 s65, 14
    s_cbranch_scc0 K2_NFg5_061
    v_cvt_f64_f32 v[106:107], v93
    v_mov_b32 v93, 0
    ds_add_f64 v116, v[106:107] offset:0
    v_add_u32 v116, 1024, v116
K2_NFg5_061:
    v_pk_fma_f32 v[92:93], v[16:17], v[82:83], v[92:93]
    s_bitcmp1_b32 s41, 15
    s_cbranch_scc0 K2_NFg5_070
    v_cvt_f64_f32 v[106:107], v92
    v_mov_b32 v92, 0
    ds_add_f64 v114, v[106:107] offset:0
K2_NFg5_070:
    s_bitcmp1_b32 s65, 15
    s_cbranch_scc0 K2_NFg5_071
    v_cvt_f64_f32 v[106:107], v93
    v_mov_b32 v93, 0
    ds_add_f64 v116, v[106:107] offset:0
K2_NFg5_071:
    s_setprio 0
    v_exp_f32 v80, v18
    v_exp_f32 v81, v19
    v_exp_f32 v82, v20
    v_exp_f32 v83, v21
    v_exp_f32 v84, v22
    v_exp_f32 v85, v23
    s_nop 0
    v_pk_add_f32 v[80:81], v[80:81], 1.0 op_sel_hi:[1,0]
    v_rcp_f32 v80, v80
    v_rcp_f32 v81, v81
    v_pk_add_f32 v[82:83], v[82:83], 1.0 op_sel_hi:[1,0]
    v_rcp_f32 v82, v82
    v_rcp_f32 v83, v83
    v_pk_add_f32 v[84:85], v[84:85], 1.0 op_sel_hi:[1,0]
    v_rcp_f32 v84, v84
    v_rcp_f32 v85, v85
    s_nop 0
    s_bitcmp1_b32 s37, 8
    s_cbranch_scc1 K2_FLg5_10
    v_pk_fma_f32 v[94:95], v[18:19], v[80:81], v[94:95]
    v_pk_fma_f32 v[94:95], v[20:21], v[82:83], v[94:95]
    v_pk_fma_f32 v[94:95], v[22:23], v[84:85], v[94:95]
K2_RTg5_10:
    v_exp_f32 v80, v24
    v_exp_f32 v81, v25
    v_exp_f32 v82, v26
    v_exp_f32 v83, v27
    v_exp_f32 v84, v28
    v_exp_f32 v85, v29
    s_nop 0
    v_pk_add_f32 v[80:81], v[80:81], 1.0 op_sel_hi:[1,0]
    v_rcp_f32 v80, v80
    v_rcp_f32 v81, v81
    v_pk_add_f32 v[82:83], v[82:83], 1.0 op_sel_hi:[1,0]
    v_rcp_f32 v82, v82
    v_rcp_f32 v83, v83
    v_pk_add_f32 v[84:85], v[84:85], 1.0 op_sel_hi:[1,0]
    v_rcp_f32 v84, v84
    v_rcp_f32 v85, v85
    s_nop 0
    s_bitcmp1_b32 s37, 11
    s_cbranch_scc1 K2_FLg5_13
    v_pk_fma_f32 v[94:95], v[24:25], v[80:81], v[94:95]
    v_pk_fma_f32 v[94:95], v[26:27], v[82:83], v[94:95]
    v_pk_fma_f32 v[94:95], v[28:29], v[84:85], v[94:95]
K2_RTg5_13:
    v_exp_f32 v80, v30
    v_exp_f32 v81, v31
    v_exp_f32 v82, v32
    v_exp_f32 v83, v33
    s_nop 0
    v_pk_add_f32 v[80:81], v[80:81], 1.0 op_sel_hi:[1,0]
    v_rcp_f32 v80, v80
    v_rcp_f32 v81, v81
    v_pk_add_f32 v[82:83], v[82:83], 1.0 op_sel_hi:[1,0]
    v_rcp_f32 v82, v82
    v_rcp_f32 v83, v83
    s_nop 0
    v_pk_fma_f32 v[94:95], v[30:31], v[80:81], v[94:95]
    s_bitcmp1_b32 s41, 14
    s_cbranch_scc0 K2_NFg5_160
    v_cvt_f64_f32 v[106:107], v94
    v_mov_b32 v94, 0
    ds_add_f64 v115, v[106:107] offset:512
    v_add_u32 v115, 1024, v115
K2_NFg5_160:
    s_bitcmp1_b32 s65, 14
    s_cbranch_scc0 K2_NFg5_161
    v_cvt_f64_f32 v[106:107], v95
    v_mov_b32 v95, 0
    ds_add_f64 v117, v[106:107] offset:512
    v_add_u32 v117, 1024, v117
K2_NFg5_161:
    v_pk_fma_f32 v[94:95], v[32:33], v[82:83], v[94:95]
    s_bitcmp1_b32 s41, 15
    s_cbranch_scc0 K2_NFg5_170
    v_cvt_f64_f32 v[106:107], v94
    v_mov_b32 v94, 0
    ds_add_f64 v115, v[106:107] offset:512
K2_NFg5_170:
    s_bitcmp1_b32 s65, 15
    s_cbranch_scc0 K2_NFg5_171
    v_cvt_f64_f32 v[106:107], v95
    v_mov_b32 v95, 0
    ds_add_f64 v117, v[106:107] offset:512
K2_NFg5_171:
    s_branch K2_REND
K2_FLg0_00:
    v_pk_fma_f32 v[92:93], v[2:3], v[80:81], v[92:93]
    s_bitcmp1_b32 s40, 0
    s_cbranch_scc0 K2_NFg0_000
    v_cvt_f64_f32 v[106:107], v92
    v_mov_b32 v92, 0
    ds_add_f64 v114, v[106:107] offset:0
    v_add_u32 v114, 1024, v114
K2_NFg0_000:
    s_bitcmp1_b32 s64, 0
    s_cbranch_scc0 K2_NFg0_001
    v_cvt_f64_f32 v[106:107], v93
    v_mov_b32 v93, 0
    ds_add_f64 v116, v[106:107] offset:0
    v_add_u32 v116, 1024, v116
K2_NFg0_001:
    v_pk_fma_f32 v[92:93], v[4:5], v[82:83], v[92:93]
    s_bitcmp1_b32 s40, 1
    s_cbranch_scc0 K2_NFg0_010
    v_cvt_f64_f32 v[106:107], v92
    v_mov_b32 v92, 0
    ds_add_f64 v114, v[106:107] offset:0
    v_add_u32 v114, 1024, v114
K2_NFg0_010:
    s_bitcmp1_b32 s64, 1
    s_cbranch_scc0 K2_NFg0_011
    v_cvt_f64_f32 v[106:107], v93
    v_mov_b32 v93, 0
    ds_add_f64 v116, v[106:107] offset:0
    v_add_u32 v116, 1024, v116
K2_NFg0_011:
    v_pk_fma_f32 v[92:93], v[6:7], v[84:85], v[92:93]
    s_bitcmp1_b32 s40, 2
    s_cbranch_scc0 K2_NFg0_020
    v_cvt_f64_f32 v[106:107], v92
    v_mov_b32 v92, 0
    ds_add_f64 v114, v[106:107] offset:0
    v_add_u32 v114, 1024, v114
K2_NFg0_020:
    s_bitcmp1_b32 s64, 2
    s_cbranch_scc0 K2_NFg0_021
    v_cvt_f64_f32 v[106:107], v93
    v_mov_b32 v93, 0
    ds_add_f64 v116, v[106:107] offset:0
    v_add_u32 v116, 1024, v116
K2_NFg0_021:
    s_branch K2_RTg0_00
K2_FLg0_03:
    v_pk_fma_f32 v[92:93], v[8:9], v[80:81], v[92:93]
    s_bitcmp1_b32 s40, 3
    s_cbranch_scc0 K2_NFg0_030
    v_cvt_f64_f32 v[106:107], v92
    v_mov_b32 v92, 0
    ds_add_f64 v114, v[106:107] offset:0
    v_add_u32 v114, 1024, v114
K2_NFg0_030:
    s_bitcmp1_b32 s64, 3
    s_cbranch_scc0 K2_NFg0_031
    v_cvt_f64_f32 v[106:107], v93
    v_mov_b32 v93, 0
    ds_add_f64 v116, v[106:107] offset:0
    v_add_u32 v116, 1024, v116
K2_NFg0_031:
    v_pk_fma_f32 v[92:93], v[10:11], v[82:83], v[92:93]
    s_bitcmp1_b32 s40, 4
    s_cbranch_scc0 K2_NFg0_040
    v_cvt_f64_f32 v[106:107], v92
    v_mov_b32 v92, 0
    ds_add_f64 v114, v[106:107] offset:0
    v_add_u32 v114, 1024, v114
K2_NFg0_040:
    s_bitcmp1_b32 s64, 4
    s_cbranch_scc0 K2_NFg0_041
    v_cvt_f64_f32 v[106:107], v93
    v_mov_b32 v93, 0
    ds_add_f64 v116, v[106:107] offset:0
    v_add_u32 v116, 1024, v116
K2_NFg0_041:
    v_pk_fma_f32 v[92:93], v[12:13], v[84:85], v[92:93]
    s_bitcmp1_b32 s40, 5
    s_cbranch_scc0 K2_NFg0_050
    v_cvt_f64_f32 v[106:107], v92
    v_mov_b32 v92, 0
    ds_add_f64 v114, v[106:107] offset:0
    v_add_u32 v114, 1024, v114
K2_NFg0_050:
    s_bitcmp1_b32 s64, 5
    s_cbranch_scc0 K2_NFg0_051
    v_cvt_f64_f32 v[106:107], v93
    v_mov_b32 v93, 0
    ds_add_f64 v116, v[106:107] offset:0
    v_add_u32 v116, 1024, v116
K2_NFg0_051:
    s_branch K2_RTg0_03
K2_FLg0_06:
    v_pk_fma_f32 v[92:93], v[14:15], v[80:81], v[92:93]
    s_bitcmp1_b32 s40, 6
    s_cbranch_scc0 K2_NFg0_060
    v_cvt_f64_f32 v[106:107], v92
    v_mov_b32 v92, 0
    ds_add_f64 v114, v[106:107] offset:0
    v_add_u32 v114, 1024, v114
K2_NFg0_060:
    s_bitcmp1_b32 s64, 6
    s_cbranch_scc0 K2_NFg0_061
    v_cvt_f64_f32 v[106:107], v93
    v_mov_b32 v93, 0
    ds_add_f64 v116, v[106:107] offset:0
    v_add_u32 v116, 1024, v116
K2_NFg0_061:
    v_pk_fma_f32 v[92:93], v[16:17], v[82:83], v[92:93]
    s_bitcmp1_b32 s40, 7
    s_cbranch_scc0 K2_NFg0_070
    v_cvt_f64_f32 v[106:107], v92
    v_mov_b32 v92, 0
    ds_add_f64 v114, v[106:107] offset:0
    v_add_u32 v114, 1024, v114
K2_NFg0_070:
    s_bitcmp1_b32 s64, 7
    s_cbranch_scc0 K2_NFg0_071
    v_cvt_f64_f32 v[106:107], v93
    v_mov_b32 v93, 0
    ds_add_f64 v116, v[106:107] offset:0
    v_add_u32 v116, 1024, v116
K2_NFg0_071:
    s_branch K2_RTg0_06
K2_FLg0_10:
    v_pk_fma_f32 v[94:95], v[18:19], v[80:81], v[94:95]
    s_bitcmp1_b32 s40, 0
    s_cbranch_scc0 K2_NFg0_100
    v_cvt_f64_f32 v[106:107], v94
    v_mov_b32 v94, 0
    ds_add_f64 v115, v[106:107] offset:512
    v_add_u32 v115, 1024, v115
K2_NFg0_100:
    s_bitcmp1_b32 s64, 0
    s_cbranch_scc0 K2_NFg0_101
    v_cvt_f64_f32 v[106:107], v95
    v_mov_b32 v95, 0
    ds_add_f64 v117, v[106:107] offset:512
    v_add_u32 v117, 1024, v117
K2_NFg0_101:
    v_pk_fma_f32 v[94:95], v[20:21], v[82:83], v[94:95]
    s_bitcmp1_b32 s40, 1
    s_cbranch_scc0 K2_NFg0_110
    v_cvt_f64_f32 v[106:107], v94
    v_mov_b32 v94, 0
    ds_add_f64 v115, v[106:107] offset:512
    v_add_u32 v115, 1024, v115
K2_NFg0_110:
    s_bitcmp1_b32 s64, 1
    s_cbranch_scc0 K2_NFg0_111
    v_cvt_f64_f32 v[106:107], v95
    v_mov_b32 v95, 0
    ds_add_f64 v117, v[106:107] offset:512
    v_add_u32 v117, 1024, v117
K2_NFg0_111:
    v_pk_fma_f32 v[94:95], v[22:23], v[84:85], v[94:95]
    s_bitcmp1_b32 s40, 2
    s_cbranch_scc0 K2_NFg0_120
    v_cvt_f64_f32 v[106:107], v94
    v_mov_b32 v94, 0
    ds_add_f64 v115, v[106:107] offset:512
    v_add_u32 v115, 1024, v115
K2_NFg0_120:
    s_bitcmp1_b32 s64, 2
    s_cbranch_scc0 K2_NFg0_121
    v_cvt_f64_f32 v[106:107], v95
    v_mov_b32 v95, 0
    ds_add_f64 v117, v[106:107] offset:512
    v_add_u32 v117, 1024, v117
K2_NFg0_121:
    s_branch K2_RTg0_10
K2_FLg0_13:
    v_pk_fma_f32 v[94:95], v[24:25], v[80:81], v[94:95]
    s_bitcmp1_b32 s40, 3
    s_cbranch_scc0 K2_NFg0_130
    v_cvt_f64_f32 v[106:107], v94
    v_mov_b32 v94, 0
    ds_add_f64 v115, v[106:107] offset:512
    v_add_u32 v115, 1024, v115
K2_NFg0_130:
    s_bitcmp1_b32 s64, 3
    s_cbranch_scc0 K2_NFg0_131
    v_cvt_f64_f32 v[106:107], v95
    v_mov_b32 v95, 0
    ds_add_f64 v117, v[106:107] offset:512
    v_add_u32 v117, 1024, v117
K2_NFg0_131:
    v_pk_fma_f32 v[94:95], v[26:27], v[82:83], v[94:95]
    s_bitcmp1_b32 s40, 4
    s_cbranch_scc0 K2_NFg0_140
    v_cvt_f64_f32 v[106:107], v94
    v_mov_b32 v94, 0
    ds_add_f64 v115, v[106:107] offset:512
    v_add_u32 v115, 1024, v115
K2_NFg0_140:
    s_bitcmp1_b32 s64, 4
    s_cbranch_scc0 K2_NFg0_141
    v_cvt_f64_f32 v[106:107], v95
    v_mov_b32 v95, 0
    ds_add_f64 v117, v[106:107] offset:512
    v_add_u32 v117, 1024, v117
K2_NFg0_141:
    v_pk_fma_f32 v[94:95], v[28:29], v[84:85], v[94:95]
    s_bitcmp1_b32 s40, 5
    s_cbranch_scc0 K2_NFg0_150
    v_cvt_f64_f32 v[106:107], v94
    v_mov_b32 v94, 0
    ds_add_f64 v115, v[106:107] offset:512
    v_add_u32 v115, 1024, v115
K2_NFg0_150:
    s_bitcmp1_b32 s64, 5
    s_cbranch_scc0 K2_NFg0_151
    v_cvt_f64_f32 v[106:107], v95
    v_mov_b32 v95, 0
    ds_add_f64 v117, v[106:107] offset:512
    v_add_u32 v117, 1024, v117
K2_NFg0_151:
    s_branch K2_RTg0_13
K2_FLg0_16:
    v_pk_fma_f32 v[94:95], v[30:31], v[80:81], v[94:95]
    s_bitcmp1_b32 s40, 6
    s_cbranch_scc0 K2_NFg0_160
    v_cvt_f64_f32 v[106:107], v94
    v_mov_b32 v94, 0
    ds_add_f64 v115, v[106:107] offset:512
    v_add_u32 v115, 1024, v115
K2_NFg0_160:
    s_bitcmp1_b32 s64, 6
    s_cbranch_scc0 K2_NFg0_161
    v_cvt_f64_f32 v[106:107], v95
    v_mov_b32 v95, 0
    ds_add_f64 v117, v[106:107] offset:512
    v_add_u32 v117, 1024, v117
K2_NFg0_161:
    v_pk_fma_f32 v[94:95], v[32:33], v[82:83], v[94:95]
    s_bitcmp1_b32 s40, 7
    s_cbranch_scc0 K2_NFg0_170
    v_cvt_f64_f32 v[106:107], v94
    v_mov_b32 v94, 0
    ds_add_f64 v115, v[106:107] offset:512
    v_add_u32 v115, 1024, v115
K2_NFg0_170:
    s_bitcmp1_b32 s64, 7
    s_cbranch_scc0 K2_NFg0_171
    v_cvt_f64_f32 v[106:107], v95
    v_mov_b32 v95, 0
    ds_add_f64 v117, v[106:107] offset:512
    v_add_u32 v117, 1024, v117
K2_NFg0_171:
    s_branch K2_RTg0_16
K2_FLg1_00:
    v_pk_fma_f32 v[92:93], v[2:3], v[80:81], v[92:93]
    s_bitcmp1_b32 s40, 8
    s_cbranch_scc0 K2_NFg1_000
    v_cvt_f64_f32 v[106:107], v92
    v_mov_b32 v92, 0
    ds_add_f64 v114, v[106:107] offset:0
    v_add_u32 v114, 1024, v114
K2_NFg1_000:
    s_bitcmp1_b32 s64, 8
    s_cbranch_scc0 K2_NFg1_001
    v_cvt_f64_f32 v[106:107], v93
    v_mov_b32 v93, 0
    ds_add_f64 v116, v[106:107] offset:0
    v_add_u32 v116, 1024, v116
K2_NFg1_001:
    v_pk_fma_f32 v[92:93], v[4:5], v[82:83], v[92:93]
    s_bitcmp1_b32 s40, 9
    s_cbranch_scc0 K2_NFg1_010
    v_cvt_f64_f32 v[106:107], v92
    v_mov_b32 v92, 0
    ds_add_f64 v114, v[106:107] offset:0
    v_add_u32 v114, 1024, v114
K2_NFg1_010:
    s_bitcmp1_b32 s64, 9
    s_cbranch_scc0 K2_NFg1_011
    v_cvt_f64_f32 v[106:107], v93
    v_mov_b32 v93, 0
    ds_add_f64 v116, v[106:107] offset:0
    v_add_u32 v116, 1024, v116
K2_NFg1_011:
    v_pk_fma_f32 v[92:93], v[6:7], v[84:85], v[92:93]
    s_bitcmp1_b32 s40, 10
    s_cbranch_scc0 K2_NFg1_020
    v_cvt_f64_f32 v[106:107], v92
    v_mov_b32 v92, 0
    ds_add_f64 v114, v[106:107] offset:0
    v_add_u32 v114, 1024, v114
K2_NFg1_020:
    s_bitcmp1_b32 s64, 10
    s_cbranch_scc0 K2_NFg1_021
    v_cvt_f64_f32 v[106:107], v93
    v_mov_b32 v93, 0
    ds_add_f64 v116, v[106:107] offset:0
    v_add_u32 v116, 1024, v116
K2_NFg1_021:
    s_branch K2_RTg1_00
K2_FLg1_03:
    v_pk_fma_f32 v[92:93], v[8:9], v[80:81], v[92:93]
    s_bitcmp1_b32 s40, 11
    s_cbranch_scc0 K2_NFg1_030
    v_cvt_f64_f32 v[106:107], v92
    v_mov_b32 v92, 0
    ds_add_f64 v114, v[106:107] offset:0
    v_add_u32 v114, 1024, v114
K2_NFg1_030:
    s_bitcmp1_b32 s64, 11
    s_cbranch_scc0 K2_NFg1_031
    v_cvt_f64_f32 v[106:107], v93
    v_mov_b32 v93, 0
    ds_add_f64 v116, v[106:107] offset:0
    v_add_u32 v116, 1024, v116
K2_NFg1_031:
    v_pk_fma_f32 v[92:93], v[10:11], v[82:83], v[92:93]
    s_bitcmp1_b32 s40, 12
    s_cbranch_scc0 K2_NFg1_040
    v_cvt_f64_f32 v[106:107], v92
    v_mov_b32 v92, 0
    ds_add_f64 v114, v[106:107] offset:0
    v_add_u32 v114, 1024, v114
K2_NFg1_040:
    s_bitcmp1_b32 s64, 12
    s_cbranch_scc0 K2_NFg1_041
    v_cvt_f64_f32 v[106:107], v93
    v_mov_b32 v93, 0
    ds_add_f64 v116, v[106:107] offset:0
    v_add_u32 v116, 1024, v116
K2_NFg1_041:
    v_pk_fma_f32 v[92:93], v[12:13], v[84:85], v[92:93]
    s_bitcmp1_b32 s40, 13
    s_cbranch_scc0 K2_NFg1_050
    v_cvt_f64_f32 v[106:107], v92
    v_mov_b32 v92, 0
    ds_add_f64 v114, v[106:107] offset:0
    v_add_u32 v114, 1024, v114
K2_NFg1_050:
    s_bitcmp1_b32 s64, 13
    s_cbranch_scc0 K2_NFg1_051
    v_cvt_f64_f32 v[106:107], v93
    v_mov_b32 v93, 0
    ds_add_f64 v116, v[106:107] offset:0
    v_add_u32 v116, 1024, v116
K2_NFg1_051:
    s_branch K2_RTg1_03
K2_FLg1_06:
    v_pk_fma_f32 v[92:93], v[14:15], v[80:81], v[92:93]
    s_bitcmp1_b32 s40, 14
    s_cbranch_scc0 K2_NFg1_060
    v_cvt_f64_f32 v[106:107], v92
    v_mov_b32 v92, 0
    ds_add_f64 v114, v[106:107] offset:0
    v_add_u32 v114, 1024, v114
K2_NFg1_060:
    s_bitcmp1_b32 s64, 14
    s_cbranch_scc0 K2_NFg1_061
    v_cvt_f64_f32 v[106:107], v93
    v_mov_b32 v93, 0
    ds_add_f64 v116, v[106:107] offset:0
    v_add_u32 v116, 1024, v116
K2_NFg1_061:
    v_pk_fma_f32 v[92:93], v[16:17], v[82:83], v[92:93]
    s_bitcmp1_b32 s40, 15
    s_cbranch_scc0 K2_NFg1_070
    v_cvt_f64_f32 v[106:107], v92
    v_mov_b32 v92, 0
    ds_add_f64 v114, v[106:107] offset:0
    v_add_u32 v114, 1024, v114
K2_NFg1_070:
    s_bitcmp1_b32 s64, 15
    s_cbranch_scc0 K2_NFg1_071
    v_cvt_f64_f32 v[106:107], v93
    v_mov_b32 v93, 0
    ds_add_f64 v116, v[106:107] offset:0
    v_add_u32 v116, 1024, v116
K2_NFg1_071:
    s_branch K2_RTg1_06
K2_FLg1_10:
    v_pk_fma_f32 v[94:95], v[18:19], v[80:81], v[94:95]
    s_bitcmp1_b32 s40, 8
    s_cbranch_scc0 K2_NFg1_100
    v_cvt_f64_f32 v[106:107], v94
    v_mov_b32 v94, 0
    ds_add_f64 v115, v[106:107] offset:512
    v_add_u32 v115, 1024, v115
K2_NFg1_100:
    s_bitcmp1_b32 s64, 8
    s_cbranch_scc0 K2_NFg1_101
    v_cvt_f64_f32 v[106:107], v95
    v_mov_b32 v95, 0
    ds_add_f64 v117, v[106:107] offset:512
    v_add_u32 v117, 1024, v117
K2_NFg1_101:
    v_pk_fma_f32 v[94:95], v[20:21], v[82:83], v[94:95]
    s_bitcmp1_b32 s40, 9
    s_cbranch_scc0 K2_NFg1_110
    v_cvt_f64_f32 v[106:107], v94
    v_mov_b32 v94, 0
    ds_add_f64 v115, v[106:107] offset:512
    v_add_u32 v115, 1024, v115
K2_NFg1_110:
    s_bitcmp1_b32 s64, 9
    s_cbranch_scc0 K2_NFg1_111
    v_cvt_f64_f32 v[106:107], v95
    v_mov_b32 v95, 0
    ds_add_f64 v117, v[106:107] offset:512
    v_add_u32 v117, 1024, v117
K2_NFg1_111:
    v_pk_fma_f32 v[94:95], v[22:23], v[84:85], v[94:95]
    s_bitcmp1_b32 s40, 10
    s_cbranch_scc0 K2_NFg1_120
    v_cvt_f64_f32 v[106:107], v94
    v_mov_b32 v94, 0
    ds_add_f64 v115, v[106:107] offset:512
    v_add_u32 v115, 1024, v115
K2_NFg1_120:
    s_bitcmp1_b32 s64, 10
    s_cbranch_scc0 K2_NFg1_121
    v_cvt_f64_f32 v[106:107], v95
    v_mov_b32 v95, 0
    ds_add_f64 v117, v[106:107] offset:512
    v_add_u32 v117, 1024, v117
K2_NFg1_121:
    s_branch K2_RTg1_10
K2_FLg1_13:
    v_pk_fma_f32 v[94:95], v[24:25], v[80:81], v[94:95]
    s_bitcmp1_b32 s40, 11
    s_cbranch_scc0 K2_NFg1_130
    v_cvt_f64_f32 v[106:107], v94
    v_mov_b32 v94, 0
    ds_add_f64 v115, v[106:107] offset:512
    v_add_u32 v115, 1024, v115
K2_NFg1_130:
    s_bitcmp1_b32 s64, 11
    s_cbranch_scc0 K2_NFg1_131
    v_cvt_f64_f32 v[106:107], v95
    v_mov_b32 v95, 0
    ds_add_f64 v117, v[106:107] offset:512
    v_add_u32 v117, 1024, v117
K2_NFg1_131:
    v_pk_fma_f32 v[94:95], v[26:27], v[82:83], v[94:95]
    s_bitcmp1_b32 s40, 12
    s_cbranch_scc0 K2_NFg1_140
    v_cvt_f64_f32 v[106:107], v94
    v_mov_b32 v94, 0
    ds_add_f64 v115, v[106:107] offset:512
    v_add_u32 v115, 1024, v115
K2_NFg1_140:
    s_bitcmp1_b32 s64, 12
    s_cbranch_scc0 K2_NFg1_141
    v_cvt_f64_f32 v[106:107], v95
    v_mov_b32 v95, 0
    ds_add_f64 v117, v[106:107] offset:512
    v_add_u32 v117, 1024, v117
K2_NFg1_141:
    v_pk_fma_f32 v[94:95], v[28:29], v[84:85], v[94:95]
    s_bitcmp1_b32 s40, 13
    s_cbranch_scc0 K2_NFg1_150
    v_cvt_f64_f32 v[106:107], v94
    v_mov_b32 v94, 0
    ds_add_f64 v115, v[106:107] offset:512
    v_add_u32 v115, 1024, v115
K2_NFg1_150:
    s_bitcmp1_b32 s64, 13
    s_cbranch_scc0 K2_NFg1_151
    v_cvt_f64_f32 v[106:107], v95
    v_mov_b32 v95, 0
    ds_add_f64 v117, v[106:107] offset:512
    v_add_u32 v117, 1024, v117
K2_NFg1_151:
    s_branch K2_RTg1_13
K2_FLg1_16:
    v_pk_fma_f32 v[94:95], v[30:31], v[80:81], v[94:95]
    s_bitcmp1_b32 s40, 14
    s_cbranch_scc0 K2_NFg1_160
    v_cvt_f64_f32 v[106:107], v94
    v_mov_b32 v94, 0
    ds_add_f64 v115, v[106:107] offset:512
    v_add_u32 v115, 1024, v115
K2_NFg1_160:
    s_bitcmp1_b32 s64, 14
    s_cbranch_scc0 K2_NFg1_161
    v_cvt_f64_f32 v[106:107], v95
    v_mov_b32 v95, 0
    ds_add_f64 v117, v[106:107] offset:512
    v_add_u32 v117, 1024, v117
K2_NFg1_161:
    v_pk_fma_f32 v[94:95], v[32:33], v[82:83], v[94:95]
    s_bitcmp1_b32 s40, 15
    s_cbranch_scc0 K2_NFg1_170
    v_cvt_f64_f32 v[106:107], v94
    v_mov_b32 v94, 0
    ds_add_f64 v115, v[106:107] offset:512
    v_add_u32 v115, 1024, v115
K2_NFg1_170:
    s_bitcmp1_b32 s64, 15
    s_cbranch_scc0 K2_NFg1_171
    v_cvt_f64_f32 v[106:107], v95
    v_mov_b32 v95, 0
    ds_add_f64 v117, v[106:107] offset:512
    v_add_u32 v117, 1024, v117
K2_NFg1_171:
    s_branch K2_RTg1_16
K2_FLg2_00:
    v_pk_fma_f32 v[92:93], v[2:3], v[80:81], v[92:93]
    s_bitcmp1_b32 s40, 16
    s_cbranch_scc0 K2_NFg2_000
    v_cvt_f64_f32 v[106:107], v92
    v_mov_b32 v92, 0
    ds_add_f64 v114, v[106:107] offset:0
    v_add_u32 v114, 1024, v114
K2_NFg2_000:
    s_bitcmp1_b32 s64, 16
    s_cbranch_scc0 K2_NFg2_001
    v_cvt_f64_f32 v[106:107], v93
    v_mov_b32 v93, 0
    ds_add_f64 v116, v[106:107] offset:0
    v_add_u32 v116, 1024, v116
K2_NFg2_001:
    v_pk_fma_f32 v[92:93], v[4:5], v[82:83], v[92:93]
    s_bitcmp1_b32 s40, 17
    s_cbranch_scc0 K2_NFg2_010
    v_cvt_f64_f32 v[106:107], v92
    v_mov_b32 v92, 0
    ds_add_f64 v114, v[106:107] offset:0
    v_add_u32 v114, 1024, v114
K2_NFg2_010:
    s_bitcmp1_b32 s64, 17
    s_cbranch_scc0 K2_NFg2_011
    v_cvt_f64_f32 v[106:107], v93
    v_mov_b32 v93, 0
    ds_add_f64 v116, v[106:107] offset:0
    v_add_u32 v116, 1024, v116
K2_NFg2_011:
    v_pk_fma_f32 v[92:93], v[6:7], v[84:85], v[92:93]
    s_bitcmp1_b32 s40, 18
    s_cbranch_scc0 K2_NFg2_020
    v_cvt_f64_f32 v[106:107], v92
    v_mov_b32 v92, 0
    ds_add_f64 v114, v[106:107] offset:0
    v_add_u32 v114, 1024, v114
K2_NFg2_020:
    s_bitcmp1_b32 s64, 18
    s_cbranch_scc0 K2_NFg2_021
    v_cvt_f64_f32 v[106:107], v93
    v_mov_b32 v93, 0
    ds_add_f64 v116, v[106:107] offset:0
    v_add_u32 v116, 1024, v116
K2_NFg2_021:
    s_branch K2_RTg2_00
K2_FLg2_03:
    v_pk_fma_f32 v[92:93], v[8:9], v[80:81], v[92:93]
    s_bitcmp1_b32 s40, 19
    s_cbranch_scc0 K2_NFg2_030
    v_cvt_f64_f32 v[106:107], v92
    v_mov_b32 v92, 0
    ds_add_f64 v114, v[106:107] offset:0
    v_add_u32 v114, 1024, v114
K2_NFg2_030:
    s_bitcmp1_b32 s64, 19
    s_cbranch_scc0 K2_NFg2_031
    v_cvt_f64_f32 v[106:107], v93
    v_mov_b32 v93, 0
    ds_add_f64 v116, v[106:107] offset:0
    v_add_u32 v116, 1024, v116
K2_NFg2_031:
    v_pk_fma_f32 v[92:93], v[10:11], v[82:83], v[92:93]
    s_bitcmp1_b32 s40, 20
    s_cbranch_scc0 K2_NFg2_040
    v_cvt_f64_f32 v[106:107], v92
    v_mov_b32 v92, 0
    ds_add_f64 v114, v[106:107] offset:0
    v_add_u32 v114, 1024, v114
K2_NFg2_040:
    s_bitcmp1_b32 s64, 20
    s_cbranch_scc0 K2_NFg2_041
    v_cvt_f64_f32 v[106:107], v93
    v_mov_b32 v93, 0
    ds_add_f64 v116, v[106:107] offset:0
    v_add_u32 v116, 1024, v116
K2_NFg2_041:
    v_pk_fma_f32 v[92:93], v[12:13], v[84:85], v[92:93]
    s_bitcmp1_b32 s40, 21
    s_cbranch_scc0 K2_NFg2_050
    v_cvt_f64_f32 v[106:107], v92
    v_mov_b32 v92, 0
    ds_add_f64 v114, v[106:107] offset:0
    v_add_u32 v114, 1024, v114
K2_NFg2_050:
    s_bitcmp1_b32 s64, 21
    s_cbranch_scc0 K2_NFg2_051
    v_cvt_f64_f32 v[106:107], v93
    v_mov_b32 v93, 0
    ds_add_f64 v116, v[106:107] offset:0
    v_add_u32 v116, 1024, v116
K2_NFg2_051:
    s_branch K2_RTg2_03
K2_FLg2_06:
    v_pk_fma_f32 v[92:93], v[14:15], v[80:81], v[92:93]
    s_bitcmp1_b32 s40, 22
    s_cbranch_scc0 K2_NFg2_060
    v_cvt_f64_f32 v[106:107], v92
    v_mov_b32 v92, 0
    ds_add_f64 v114, v[106:107] offset:0
    v_add_u32 v114, 1024, v114
K2_NFg2_060:
    s_bitcmp1_b32 s64, 22
    s_cbranch_scc0 K2_NFg2_061
    v_cvt_f64_f32 v[106:107], v93
    v_mov_b32 v93, 0
    ds_add_f64 v116, v[106:107] offset:0
    v_add_u32 v116, 1024, v116
K2_NFg2_061:
    v_pk_fma_f32 v[92:93], v[16:17], v[82:83], v[92:93]
    s_bitcmp1_b32 s40, 23
    s_cbranch_scc0 K2_NFg2_070
    v_cvt_f64_f32 v[106:107], v92
    v_mov_b32 v92, 0
    ds_add_f64 v114, v[106:107] offset:0
    v_add_u32 v114, 1024, v114
K2_NFg2_070:
    s_bitcmp1_b32 s64, 23
    s_cbranch_scc0 K2_NFg2_071
    v_cvt_f64_f32 v[106:107], v93
    v_mov_b32 v93, 0
    ds_add_f64 v116, v[106:107] offset:0
    v_add_u32 v116, 1024, v116
K2_NFg2_071:
    s_branch K2_RTg2_06
K2_FLg2_10:
    v_pk_fma_f32 v[94:95], v[18:19], v[80:81], v[94:95]
    s_bitcmp1_b32 s40, 16
    s_cbranch_scc0 K2_NFg2_100
    v_cvt_f64_f32 v[106:107], v94
    v_mov_b32 v94, 0
    ds_add_f64 v115, v[106:107] offset:512
    v_add_u32 v115, 1024, v115
K2_NFg2_100:
    s_bitcmp1_b32 s64, 16
    s_cbranch_scc0 K2_NFg2_101
    v_cvt_f64_f32 v[106:107], v95
    v_mov_b32 v95, 0
    ds_add_f64 v117, v[106:107] offset:512
    v_add_u32 v117, 1024, v117
K2_NFg2_101:
    v_pk_fma_f32 v[94:95], v[20:21], v[82:83], v[94:95]
    s_bitcmp1_b32 s40, 17
    s_cbranch_scc0 K2_NFg2_110
    v_cvt_f64_f32 v[106:107], v94
    v_mov_b32 v94, 0
    ds_add_f64 v115, v[106:107] offset:512
    v_add_u32 v115, 1024, v115
K2_NFg2_110:
    s_bitcmp1_b32 s64, 17
    s_cbranch_scc0 K2_NFg2_111
    v_cvt_f64_f32 v[106:107], v95
    v_mov_b32 v95, 0
    ds_add_f64 v117, v[106:107] offset:512
    v_add_u32 v117, 1024, v117
K2_NFg2_111:
    v_pk_fma_f32 v[94:95], v[22:23], v[84:85], v[94:95]
    s_bitcmp1_b32 s40, 18
    s_cbranch_scc0 K2_NFg2_120
    v_cvt_f64_f32 v[106:107], v94
    v_mov_b32 v94, 0
    ds_add_f64 v115, v[106:107] offset:512
    v_add_u32 v115, 1024, v115
K2_NFg2_120:
    s_bitcmp1_b32 s64, 18
    s_cbranch_scc0 K2_NFg2_121
    v_cvt_f64_f32 v[106:107], v95
    v_mov_b32 v95, 0
    ds_add_f64 v117, v[106:107] offset:512
    v_add_u32 v117, 1024, v117
K2_NFg2_121:
    s_branch K2_RTg2_10
K2_FLg2_13:
    v_pk_fma_f32 v[94:95], v[24:25], v[80:81], v[94:95]
    s_bitcmp1_b32 s40, 19
    s_cbranch_scc0 K2_NFg2_130
    v_cvt_f64_f32 v[106:107], v94
    v_mov_b32 v94, 0
    ds_add_f64 v115, v[106:107] offset:512
    v_add_u32 v115, 1024, v115
K2_NFg2_130:
    s_bitcmp1_b32 s64, 19
    s_cbranch_scc0 K2_NFg2_131
    v_cvt_f64_f32 v[106:107], v95
    v_mov_b32 v95, 0
    ds_add_f64 v117, v[106:107] offset:512
    v_add_u32 v117, 1024, v117
K2_NFg2_131:
    v_pk_fma_f32 v[94:95], v[26:27], v[82:83], v[94:95]
    s_bitcmp1_b32 s40, 20
    s_cbranch_scc0 K2_NFg2_140
    v_cvt_f64_f32 v[106:107], v94
    v_mov_b32 v94, 0
    ds_add_f64 v115, v[106:107] offset:512
    v_add_u32 v115, 1024, v115
K2_NFg2_140:
    s_bitcmp1_b32 s64, 20
    s_cbranch_scc0 K2_NFg2_141
    v_cvt_f64_f32 v[106:107], v95
    v_mov_b32 v95, 0
    ds_add_f64 v117, v[106:107] offset:512
    v_add_u32 v117, 1024, v117
K2_NFg2_141:
    v_pk_fma_f32 v[94:95], v[28:29], v[84:85], v[94:95]
    s_bitcmp1_b32 s40, 21
    s_cbranch_scc0 K2_NFg2_150
    v_cvt_f64_f32 v[106:107], v94
    v_mov_b32 v94, 0
    ds_add_f64 v115, v[106:107] offset:512
    v_add_u32 v115, 1024, v115
K2_NFg2_150:
    s_bitcmp1_b32 s64, 21
    s_cbranch_scc0 K2_NFg2_151
    v_cvt_f64_f32 v[106:107], v95
    v_mov_b32 v95, 0
    ds_add_f64 v117, v[106:107] offset:512
    v_add_u32 v117, 1024, v117
K2_NFg2_151:
    s_branch K2_RTg2_13
K2_FLg2_16:
    v_pk_fma_f32 v[94:95], v[30:31], v[80:81], v[94:95]
    s_bitcmp1_b32 s40, 22
    s_cbranch_scc0 K2_NFg2_160
    v_cvt_f64_f32 v[106:107], v94
    v_mov_b32 v94, 0
    ds_add_f64 v115, v[106:107] offset:512
    v_add_u32 v115, 1024, v115
K2_NFg2_160:
    s_bitcmp1_b32 s64, 22
    s_cbranch_scc0 K2_NFg2_161
    v_cvt_f64_f32 v[106:107], v95
    v_mov_b32 v95, 0
    ds_add_f64 v117, v[106:107] offset:512
    v_add_u32 v117, 1024, v117
K2_NFg2_161:
    v_pk_fma_f32 v[94:95], v[32:33], v[82:83], v[94:95]
    s_bitcmp1_b32 s40, 23
    s_cbranch_scc0 K2_NFg2_170
    v_cvt_f64_f32 v[106:107], v94
    v_mov_b32 v94, 0
    ds_add_f64 v115, v[106:107] offset:512
    v_add_u32 v115, 1024, v115
K2_NFg2_170:
    s_bitcmp1_b32 s64, 23
    s_cbranch_scc0 K2_NFg2_171
    v_cvt_f64_f32 v[106:107], v95
    v_mov_b32 v95, 0
    ds_add_f64 v117, v[106:107] offset:512
    v_add_u32 v117, 1024, v117
K2_NFg2_171:
    s_branch K2_RTg2_16
K2_FLg3_00:
    v_pk_fma_f32 v[92:93], v[2:3], v[80:81], v[92:93]
    s_bitcmp1_b32 s40, 24
    s_cbranch_scc0 K2_NFg3_000
    v_cvt_f64_f32 v[106:107], v92
    v_mov_b32 v92, 0
    ds_add_f64 v114, v[106:107] offset:0
    v_add_u32 v114, 1024, v114
K2_NFg3_000:
    s_bitcmp1_b32 s64, 24
    s_cbranch_scc0 K2_NFg3_001
    v_cvt_f64_f32 v[106:107], v93
    v_mov_b32 v93, 0
    ds_add_f64 v116, v[106:107] offset:0
    v_add_u32 v116, 1024, v116
K2_NFg3_001:
    v_pk_fma_f32 v[92:93], v[4:5], v[82:83], v[92:93]
    s_bitcmp1_b32 s40, 25
    s_cbranch_scc0 K2_NFg3_010
    v_cvt_f64_f32 v[106:107], v92
    v_mov_b32 v92, 0
    ds_add_f64 v114, v[106:107] offset:0
    v_add_u32 v114, 1024, v114
K2_NFg3_010:
    s_bitcmp1_b32 s64, 25
    s_cbranch_scc0 K2_NFg3_011
    v_cvt_f64_f32 v[106:107], v93
    v_mov_b32 v93, 0
    ds_add_f64 v116, v[106:107] offset:0
    v_add_u32 v116, 1024, v116
K2_NFg3_011:
    v_pk_fma_f32 v[92:93], v[6:7], v[84:85], v[92:93]
    s_bitcmp1_b32 s40, 26
    s_cbranch_scc0 K2_NFg3_020
    v_cvt_f64_f32 v[106:107], v92
    v_mov_b32 v92, 0
    ds_add_f64 v114, v[106:107] offset:0
    v_add_u32 v114, 1024, v114
K2_NFg3_020:
    s_bitcmp1_b32 s64, 26
    s_cbranch_scc0 K2_NFg3_021
    v_cvt_f64_f32 v[106:107], v93
    v_mov_b32 v93, 0
    ds_add_f64 v116, v[106:107] offset:0
    v_add_u32 v116, 1024, v116
K2_NFg3_021:
    s_branch K2_RTg3_00
K2_FLg3_03:
    v_pk_fma_f32 v[92:93], v[8:9], v[80:81], v[92:93]
    s_bitcmp1_b32 s40, 27
    s_cbranch_scc0 K2_NFg3_030
    v_cvt_f64_f32 v[106:107], v92
    v_mov_b32 v92, 0
    ds_add_f64 v114, v[106:107] offset:0
    v_add_u32 v114, 1024, v114
K2_NFg3_030:
    s_bitcmp1_b32 s64, 27
    s_cbranch_scc0 K2_NFg3_031
    v_cvt_f64_f32 v[106:107], v93
    v_mov_b32 v93, 0
    ds_add_f64 v116, v[106:107] offset:0
    v_add_u32 v116, 1024, v116
K2_NFg3_031:
    v_pk_fma_f32 v[92:93], v[10:11], v[82:83], v[92:93]
    s_bitcmp1_b32 s40, 28
    s_cbranch_scc0 K2_NFg3_040
    v_cvt_f64_f32 v[106:107], v92
    v_mov_b32 v92, 0
    ds_add_f64 v114, v[106:107] offset:0
    v_add_u32 v114, 1024, v114
K2_NFg3_040:
    s_bitcmp1_b32 s64, 28
    s_cbranch_scc0 K2_NFg3_041
    v_cvt_f64_f32 v[106:107], v93
    v_mov_b32 v93, 0
    ds_add_f64 v116, v[106:107] offset:0
    v_add_u32 v116, 1024, v116
K2_NFg3_041:
    v_pk_fma_f32 v[92:93], v[12:13], v[84:85], v[92:93]
    s_bitcmp1_b32 s40, 29
    s_cbranch_scc0 K2_NFg3_050
    v_cvt_f64_f32 v[106:107], v92
    v_mov_b32 v92, 0
    ds_add_f64 v114, v[106:107] offset:0
    v_add_u32 v114, 1024, v114
K2_NFg3_050:
    s_bitcmp1_b32 s64, 29
    s_cbranch_scc0 K2_NFg3_051
    v_cvt_f64_f32 v[106:107], v93
    v_mov_b32 v93, 0
    ds_add_f64 v116, v[106:107] offset:0
    v_add_u32 v116, 1024, v116
K2_NFg3_051:
    s_branch K2_RTg3_03
K2_FLg3_06:
    v_pk_fma_f32 v[92:93], v[14:15], v[80:81], v[92:93]
    s_bitcmp1_b32 s40, 30
    s_cbranch_scc0 K2_NFg3_060
    v_cvt_f64_f32 v[106:107], v92
    v_mov_b32 v92, 0
    ds_add_f64 v114, v[106:107] offset:0
    v_add_u32 v114, 1024, v114
K2_NFg3_060:
    s_bitcmp1_b32 s64, 30
    s_cbranch_scc0 K2_NFg3_061
    v_cvt_f64_f32 v[106:107], v93
    v_mov_b32 v93, 0
    ds_add_f64 v116, v[106:107] offset:0
    v_add_u32 v116, 1024, v116
K2_NFg3_061:
    v_pk_fma_f32 v[92:93], v[16:17], v[82:83], v[92:93]
    s_bitcmp1_b32 s40, 31
    s_cbranch_scc0 K2_NFg3_070
    v_cvt_f64_f32 v[106:107], v92
    v_mov_b32 v92, 0
    ds_add_f64 v114, v[106:107] offset:0
    v_add_u32 v114, 1024, v114
K2_NFg3_070:
    s_bitcmp1_b32 s64, 31
    s_cbranch_scc0 K2_NFg3_071
    v_cvt_f64_f32 v[106:107], v93
    v_mov_b32 v93, 0
    ds_add_f64 v116, v[106:107] offset:0
    v_add_u32 v116, 1024, v116
K2_NFg3_071:
    s_branch K2_RTg3_06
K2_FLg3_10:
    v_pk_fma_f32 v[94:95], v[18:19], v[80:81], v[94:95]
    s_bitcmp1_b32 s40, 24
    s_cbranch_scc0 K2_NFg3_100
    v_cvt_f64_f32 v[106:107], v94
    v_mov_b32 v94, 0
    ds_add_f64 v115, v[106:107] offset:512
    v_add_u32 v115, 1024, v115
K2_NFg3_100:
    s_bitcmp1_b32 s64, 24
    s_cbranch_scc0 K2_NFg3_101
    v_cvt_f64_f32 v[106:107], v95
    v_mov_b32 v95, 0
    ds_add_f64 v117, v[106:107] offset:512
    v_add_u32 v117, 1024, v117
K2_NFg3_101:
    v_pk_fma_f32 v[94:95], v[20:21], v[82:83], v[94:95]
    s_bitcmp1_b32 s40, 25
    s_cbranch_scc0 K2_NFg3_110
    v_cvt_f64_f32 v[106:107], v94
    v_mov_b32 v94, 0
    ds_add_f64 v115, v[106:107] offset:512
    v_add_u32 v115, 1024, v115
K2_NFg3_110:
    s_bitcmp1_b32 s64, 25
    s_cbranch_scc0 K2_NFg3_111
    v_cvt_f64_f32 v[106:107], v95
    v_mov_b32 v95, 0
    ds_add_f64 v117, v[106:107] offset:512
    v_add_u32 v117, 1024, v117
K2_NFg3_111:
    v_pk_fma_f32 v[94:95], v[22:23], v[84:85], v[94:95]
    s_bitcmp1_b32 s40, 26
    s_cbranch_scc0 K2_NFg3_120
    v_cvt_f64_f32 v[106:107], v94
    v_mov_b32 v94, 0
    ds_add_f64 v115, v[106:107] offset:512
    v_add_u32 v115, 1024, v115
K2_NFg3_120:
    s_bitcmp1_b32 s64, 26
    s_cbranch_scc0 K2_NFg3_121
    v_cvt_f64_f32 v[106:107], v95
    v_mov_b32 v95, 0
    ds_add_f64 v117, v[106:107] offset:512
    v_add_u32 v117, 1024, v117
K2_NFg3_121:
    s_branch K2_RTg3_10
K2_FLg3_13:
    v_pk_fma_f32 v[94:95], v[24:25], v[80:81], v[94:95]
    s_bitcmp1_b32 s40, 27
    s_cbranch_scc0 K2_NFg3_130
    v_cvt_f64_f32 v[106:107], v94
    v_mov_b32 v94, 0
    ds_add_f64 v115, v[106:107] offset:512
    v_add_u32 v115, 1024, v115
K2_NFg3_130:
    s_bitcmp1_b32 s64, 27
    s_cbranch_scc0 K2_NFg3_131
    v_cvt_f64_f32 v[106:107], v95
    v_mov_b32 v95, 0
    ds_add_f64 v117, v[106:107] offset:512
    v_add_u32 v117, 1024, v117
K2_NFg3_131:
    v_pk_fma_f32 v[94:95], v[26:27], v[82:83], v[94:95]
    s_bitcmp1_b32 s40, 28
    s_cbranch_scc0 K2_NFg3_140
    v_cvt_f64_f32 v[106:107], v94
    v_mov_b32 v94, 0
    ds_add_f64 v115, v[106:107] offset:512
    v_add_u32 v115, 1024, v115
K2_NFg3_140:
    s_bitcmp1_b32 s64, 28
    s_cbranch_scc0 K2_NFg3_141
    v_cvt_f64_f32 v[106:107], v95
    v_mov_b32 v95, 0
    ds_add_f64 v117, v[106:107] offset:512
    v_add_u32 v117, 1024, v117
K2_NFg3_141:
    v_pk_fma_f32 v[94:95], v[28:29], v[84:85], v[94:95]
    s_bitcmp1_b32 s40, 29
    s_cbranch_scc0 K2_NFg3_150
    v_cvt_f64_f32 v[106:107], v94
    v_mov_b32 v94, 0
    ds_add_f64 v115, v[106:107] offset:512
    v_add_u32 v115, 1024, v115
K2_NFg3_150:
    s_bitcmp1_b32 s64, 29
    s_cbranch_scc0 K2_NFg3_151
    v_cvt_f64_f32 v[106:107], v95
    v_mov_b32 v95, 0
    ds_add_f64 v117, v[106:107] offset:512
    v_add_u32 v117, 1024, v117
K2_NFg3_151:
    s_branch K2_RTg3_13
K2_FLg3_16:
    v_pk_fma_f32 v[94:95], v[30:31], v[80:81], v[94:95]
    s_bitcmp1_b32 s40, 30
    s_cbranch_scc0 K2_NFg3_160
    v_cvt_f64_f32 v[106:107], v94
    v_mov_b32 v94, 0
    ds_add_f64 v115, v[106:107] offset:512
    v_add_u32 v115, 1024, v115
K2_NFg3_160:
    s_bitcmp1_b32 s64, 30
    s_cbranch_scc0 K2_NFg3_161
    v_cvt_f64_f32 v[106:107], v95
    v_mov_b32 v95, 0
    ds_add_f64 v117, v[106:107] offset:512
    v_add_u32 v117, 1024, v117
K2_NFg3_161:
    v_pk_fma_f32 v[94:95], v[32:33], v[82:83], v[94:95]
    s_bitcmp1_b32 s40, 31
    s_cbranch_scc0 K2_NFg3_170
    v_cvt_f64_f32 v[106:107], v94
    v_mov_b32 v94, 0
    ds_add_f64 v115, v[106:107] offset:512
    v_add_u32 v115, 1024, v115
K2_NFg3_170:
    s_bitcmp1_b32 s64, 31
    s_cbranch_scc0 K2_NFg3_171
    v_cvt_f64_f32 v[106:107], v95
    v_mov_b32 v95, 0
    ds_add_f64 v117, v[106:107] offset:512
    v_add_u32 v117, 1024, v117
K2_NFg3_171:
    s_branch K2_RTg3_16
K2_FLg4_00:
    v_pk_fma_f32 v[92:93], v[2:3], v[80:81], v[92:93]
    s_bitcmp1_b32 s41, 0
    s_cbranch_scc0 K2_NFg4_000
    v_cvt_f64_f32 v[106:107], v92
    v_mov_b32 v92, 0
    ds_add_f64 v114, v[106:107] offset:0
    v_add_u32 v114, 1024, v114
K2_NFg4_000:
    s_bitcmp1_b32 s65, 0
    s_cbranch_scc0 K2_NFg4_001
    v_cvt_f64_f32 v[106:107], v93
    v_mov_b32 v93, 0
    ds_add_f64 v116, v[106:107] offset:0
    v_add_u32 v116, 1024, v116
K2_NFg4_001:
    v_pk_fma_f32 v[92:93], v[4:5], v[82:83], v[92:93]
    s_bitcmp1_b32 s41, 1
    s_cbranch_scc0 K2_NFg4_010
    v_cvt_f64_f32 v[106:107], v92
    v_mov_b32 v92, 0
    ds_add_f64 v114, v[106:107] offset:0
    v_add_u32 v114, 1024, v114
K2_NFg4_010:
    s_bitcmp1_b32 s65, 1
    s_cbranch_scc0 K2_NFg4_011
    v_cvt_f64_f32 v[106:107], v93
    v_mov_b32 v93, 0
    ds_add_f64 v116, v[106:107] offset:0
    v_add_u32 v116, 1024, v116
K2_NFg4_011:
    v_pk_fma_f32 v[92:93], v[6:7], v[84:85], v[92:93]
    s_bitcmp1_b32 s41, 2
    s_cbranch_scc0 K2_NFg4_020
    v_cvt_f64_f32 v[106:107], v92
    v_mov_b32 v92, 0
    ds_add_f64 v114, v[106:107] offset:0
    v_add_u32 v114, 1024, v114
K2_NFg4_020:
    s_bitcmp1_b32 s65, 2
    s_cbranch_scc0 K2_NFg4_021
    v_cvt_f64_f32 v[106:107], v93
    v_mov_b32 v93, 0
    ds_add_f64 v116, v[106:107] offset:0
    v_add_u32 v116, 1024, v116
K2_NFg4_021:
    s_branch K2_RTg4_00
K2_FLg4_03:
    v_pk_fma_f32 v[92:93], v[8:9], v[80:81], v[92:93]
    s_bitcmp1_b32 s41, 3
    s_cbranch_scc0 K2_NFg4_030
    v_cvt_f64_f32 v[106:107], v92
    v_mov_b32 v92, 0
    ds_add_f64 v114, v[106:107] offset:0
    v_add_u32 v114, 1024, v114
K2_NFg4_030:
    s_bitcmp1_b32 s65, 3
    s_cbranch_scc0 K2_NFg4_031
    v_cvt_f64_f32 v[106:107], v93
    v_mov_b32 v93, 0
    ds_add_f64 v116, v[106:107] offset:0
    v_add_u32 v116, 1024, v116
K2_NFg4_031:
    v_pk_fma_f32 v[92:93], v[10:11], v[82:83], v[92:93]
    s_bitcmp1_b32 s41, 4
    s_cbranch_scc0 K2_NFg4_040
    v_cvt_f64_f32 v[106:107], v92
    v_mov_b32 v92, 0
    ds_add_f64 v114, v[106:107] offset:0
    v_add_u32 v114, 1024, v114
K2_NFg4_040:
    s_bitcmp1_b32 s65, 4
    s_cbranch_scc0 K2_NFg4_041
    v_cvt_f64_f32 v[106:107], v93
    v_mov_b32 v93, 0
    ds_add_f64 v116, v[106:107] offset:0
    v_add_u32 v116, 1024, v116
K2_NFg4_041:
    v_pk_fma_f32 v[92:93], v[12:13], v[84:85], v[92:93]
    s_bitcmp1_b32 s41, 5
    s_cbranch_scc0 K2_NFg4_050
    v_cvt_f64_f32 v[106:107], v92
    v_mov_b32 v92, 0
    ds_add_f64 v114, v[106:107] offset:0
    v_add_u32 v114, 1024, v114
K2_NFg4_050:
    s_bitcmp1_b32 s65, 5
    s_cbranch_scc0 K2_NFg4_051
    v_cvt_f64_f32 v[106:107], v93
    v_mov_b32 v93, 0
    ds_add_f64 v116, v[106:107] offset:0
    v_add_u32 v116, 1024, v116
K2_NFg4_051:
    s_branch K2_RTg4_03
K2_FLg4_06:
    v_pk_fma_f32 v[92:93], v[14:15], v[80:81], v[92:93]
    s_bitcmp1_b32 s41, 6
    s_cbranch_scc0 K2_NFg4_060
    v_cvt_f64_f32 v[106:107], v92
    v_mov_b32 v92, 0
    ds_add_f64 v114, v[106:107] offset:0
    v_add_u32 v114, 1024, v114
K2_NFg4_060:
    s_bitcmp1_b32 s65, 6
    s_cbranch_scc0 K2_NFg4_061
    v_cvt_f64_f32 v[106:107], v93
    v_mov_b32 v93, 0
    ds_add_f64 v116, v[106:107] offset:0
    v_add_u32 v116, 1024, v116
K2_NFg4_061:
    v_pk_fma_f32 v[92:93], v[16:17], v[82:83], v[92:93]
    s_bitcmp1_b32 s41, 7
    s_cbranch_scc0 K2_NFg4_070
    v_cvt_f64_f32 v[106:107], v92
    v_mov_b32 v92, 0
    ds_add_f64 v114, v[106:107] offset:0
    v_add_u32 v114, 1024, v114
K2_NFg4_070:
    s_bitcmp1_b32 s65, 7
    s_cbranch_scc0 K2_NFg4_071
    v_cvt_f64_f32 v[106:107], v93
    v_mov_b32 v93, 0
    ds_add_f64 v116, v[106:107] offset:0
    v_add_u32 v116, 1024, v116
K2_NFg4_071:
    s_branch K2_RTg4_06
K2_FLg4_10:
    v_pk_fma_f32 v[94:95], v[18:19], v[80:81], v[94:95]
    s_bitcmp1_b32 s41, 0
    s_cbranch_scc0 K2_NFg4_100
    v_cvt_f64_f32 v[106:107], v94
    v_mov_b32 v94, 0
    ds_add_f64 v115, v[106:107] offset:512
    v_add_u32 v115, 1024, v115
K2_NFg4_100:
    s_bitcmp1_b32 s65, 0
    s_cbranch_scc0 K2_NFg4_101
    v_cvt_f64_f32 v[106:107], v95
    v_mov_b32 v95, 0
    ds_add_f64 v117, v[106:107] offset:512
    v_add_u32 v117, 1024, v117
K2_NFg4_101:
    v_pk_fma_f32 v[94:95], v[20:21], v[82:83], v[94:95]
    s_bitcmp1_b32 s41, 1
    s_cbranch_scc0 K2_NFg4_110
    v_cvt_f64_f32 v[106:107], v94
    v_mov_b32 v94, 0
    ds_add_f64 v115, v[106:107] offset:512
    v_add_u32 v115, 1024, v115
K2_NFg4_110:
    s_bitcmp1_b32 s65, 1
    s_cbranch_scc0 K2_NFg4_111
    v_cvt_f64_f32 v[106:107], v95
    v_mov_b32 v95, 0
    ds_add_f64 v117, v[106:107] offset:512
    v_add_u32 v117, 1024, v117
K2_NFg4_111:
    v_pk_fma_f32 v[94:95], v[22:23], v[84:85], v[94:95]
    s_bitcmp1_b32 s41, 2
    s_cbranch_scc0 K2_NFg4_120
    v_cvt_f64_f32 v[106:107], v94
    v_mov_b32 v94, 0
    ds_add_f64 v115, v[106:107] offset:512
    v_add_u32 v115, 1024, v115
K2_NFg4_120:
    s_bitcmp1_b32 s65, 2
    s_cbranch_scc0 K2_NFg4_121
    v_cvt_f64_f32 v[106:107], v95
    v_mov_b32 v95, 0
    ds_add_f64 v117, v[106:107] offset:512
    v_add_u32 v117, 1024, v117
K2_NFg4_121:
    s_branch K2_RTg4_10
K2_FLg4_13:
    v_pk_fma_f32 v[94:95], v[24:25], v[80:81], v[94:95]
    s_bitcmp1_b32 s41, 3
    s_cbranch_scc0 K2_NFg4_130
    v_cvt_f64_f32 v[106:107], v94
    v_mov_b32 v94, 0
    ds_add_f64 v115, v[106:107] offset:512
    v_add_u32 v115, 1024, v115
K2_NFg4_130:
    s_bitcmp1_b32 s65, 3
    s_cbranch_scc0 K2_NFg4_131
    v_cvt_f64_f32 v[106:107], v95
    v_mov_b32 v95, 0
    ds_add_f64 v117, v[106:107] offset:512
    v_add_u32 v117, 1024, v117
K2_NFg4_131:
    v_pk_fma_f32 v[94:95], v[26:27], v[82:83], v[94:95]
    s_bitcmp1_b32 s41, 4
    s_cbranch_scc0 K2_NFg4_140
    v_cvt_f64_f32 v[106:107], v94
    v_mov_b32 v94, 0
    ds_add_f64 v115, v[106:107] offset:512
    v_add_u32 v115, 1024, v115
K2_NFg4_140:
    s_bitcmp1_b32 s65, 4
    s_cbranch_scc0 K2_NFg4_141
    v_cvt_f64_f32 v[106:107], v95
    v_mov_b32 v95, 0
    ds_add_f64 v117, v[106:107] offset:512
    v_add_u32 v117, 1024, v117
K2_NFg4_141:
    v_pk_fma_f32 v[94:95], v[28:29], v[84:85], v[94:95]
    s_bitcmp1_b32 s41, 5
    s_cbranch_scc0 K2_NFg4_150
    v_cvt_f64_f32 v[106:107], v94
    v_mov_b32 v94, 0
    ds_add_f64 v115, v[106:107] offset:512
    v_add_u32 v115, 1024, v115
K2_NFg4_150:
    s_bitcmp1_b32 s65, 5
    s_cbranch_scc0 K2_NFg4_151
    v_cvt_f64_f32 v[106:107], v95
    v_mov_b32 v95, 0
    ds_add_f64 v117, v[106:107] offset:512
    v_add_u32 v117, 1024, v117
K2_NFg4_151:
    s_branch K2_RTg4_13
K2_FLg4_16:
    v_pk_fma_f32 v[94:95], v[30:31], v[80:81], v[94:95]
    s_bitcmp1_b32 s41, 6
    s_cbranch_scc0 K2_NFg4_160
    v_cvt_f64_f32 v[106:107], v94
    v_mov_b32 v94, 0
    ds_add_f64 v115, v[106:107] offset:512
    v_add_u32 v115, 1024, v115
K2_NFg4_160:
    s_bitcmp1_b32 s65, 6
    s_cbranch_scc0 K2_NFg4_161
    v_cvt_f64_f32 v[106:107], v95
    v_mov_b32 v95, 0
    ds_add_f64 v117, v[106:107] offset:512
    v_add_u32 v117, 1024, v117
K2_NFg4_161:
    v_pk_fma_f32 v[94:95], v[32:33], v[82:83], v[94:95]
    s_bitcmp1_b32 s41, 7
    s_cbranch_scc0 K2_NFg4_170
    v_cvt_f64_f32 v[106:107], v94
    v_mov_b32 v94, 0
    ds_add_f64 v115, v[106:107] offset:512
    v_add_u32 v115, 1024, v115
K2_NFg4_170:
    s_bitcmp1_b32 s65, 7
    s_cbranch_scc0 K2_NFg4_171
    v_cvt_f64_f32 v[106:107], v95
    v_mov_b32 v95, 0
    ds_add_f64 v117, v[106:107] offset:512
    v_add_u32 v117, 1024, v117
K2_NFg4_171:
    s_branch K2_RTg4_16
K2_FLg5_00:
    v_pk_fma_f32 v[92:93], v[2:3], v[80:81], v[92:93]
    s_bitcmp1_b32 s41, 8
    s_cbranch_scc0 K2_NFg5_000
    v_cvt_f64_f32 v[106:107], v92
    v_mov_b32 v92, 0
    ds_add_f64 v114, v[106:107] offset:0
    v_add_u32 v114, 1024, v114
K2_NFg5_000:
    s_bitcmp1_b32 s65, 8
    s_cbranch_scc0 K2_NFg5_001
    v_cvt_f64_f32 v[106:107], v93
    v_mov_b32 v93, 0
    ds_add_f64 v116, v[106:107] offset:0
    v_add_u32 v116, 1024, v116
K2_NFg5_001:
    v_pk_fma_f32 v[92:93], v[4:5], v[82:83], v[92:93]
    s_bitcmp1_b32 s41, 9
    s_cbranch_scc0 K2_NFg5_010
    v_cvt_f64_f32 v[106:107], v92
    v_mov_b32 v92, 0
    ds_add_f64 v114, v[106:107] offset:0
    v_add_u32 v114, 1024, v114
K2_NFg5_010:
    s_bitcmp1_b32 s65, 9
    s_cbranch_scc0 K2_NFg5_011
    v_cvt_f64_f32 v[106:107], v93
    v_mov_b32 v93, 0
    ds_add_f64 v116, v[106:107] offset:0
    v_add_u32 v116, 1024, v116
K2_NFg5_011:
    v_pk_fma_f32 v[92:93], v[6:7], v[84:85], v[92:93]
    s_bitcmp1_b32 s41, 10
    s_cbranch_scc0 K2_NFg5_020
    v_cvt_f64_f32 v[106:107], v92
    v_mov_b32 v92, 0
    ds_add_f64 v114, v[106:107] offset:0
    v_add_u32 v114, 1024, v114
K2_NFg5_020:
    s_bitcmp1_b32 s65, 10
    s_cbranch_scc0 K2_NFg5_021
    v_cvt_f64_f32 v[106:107], v93
    v_mov_b32 v93, 0
    ds_add_f64 v116, v[106:107] offset:0
    v_add_u32 v116, 1024, v116
K2_NFg5_021:
    s_branch K2_RTg5_00
K2_FLg5_03:
    v_pk_fma_f32 v[92:93], v[8:9], v[80:81], v[92:93]
    s_bitcmp1_b32 s41, 11
    s_cbranch_scc0 K2_NFg5_030
    v_cvt_f64_f32 v[106:107], v92
    v_mov_b32 v92, 0
    ds_add_f64 v114, v[106:107] offset:0
    v_add_u32 v114, 1024, v114
K2_NFg5_030:
    s_bitcmp1_b32 s65, 11
    s_cbranch_scc0 K2_NFg5_031
    v_cvt_f64_f32 v[106:107], v93
    v_mov_b32 v93, 0
    ds_add_f64 v116, v[106:107] offset:0
    v_add_u32 v116, 1024, v116
K2_NFg5_031:
    v_pk_fma_f32 v[92:93], v[10:11], v[82:83], v[92:93]
    s_bitcmp1_b32 s41, 12
    s_cbranch_scc0 K2_NFg5_040
    v_cvt_f64_f32 v[106:107], v92
    v_mov_b32 v92, 0
    ds_add_f64 v114, v[106:107] offset:0
    v_add_u32 v114, 1024, v114
K2_NFg5_040:
    s_bitcmp1_b32 s65, 12
    s_cbranch_scc0 K2_NFg5_041
    v_cvt_f64_f32 v[106:107], v93
    v_mov_b32 v93, 0
    ds_add_f64 v116, v[106:107] offset:0
    v_add_u32 v116, 1024, v116
K2_NFg5_041:
    v_pk_fma_f32 v[92:93], v[12:13], v[84:85], v[92:93]
    s_bitcmp1_b32 s41, 13
    s_cbranch_scc0 K2_NFg5_050
    v_cvt_f64_f32 v[106:107], v92
    v_mov_b32 v92, 0
    ds_add_f64 v114, v[106:107] offset:0
    v_add_u32 v114, 1024, v114
K2_NFg5_050:
    s_bitcmp1_b32 s65, 13
    s_cbranch_scc0 K2_NFg5_051
    v_cvt_f64_f32 v[106:107], v93
    v_mov_b32 v93, 0
    ds_add_f64 v116, v[106:107] offset:0
    v_add_u32 v116, 1024, v116
K2_NFg5_051:
    s_branch K2_RTg5_03
K2_FLg5_10:
    v_pk_fma_f32 v[94:95], v[18:19], v[80:81], v[94:95]
    s_bitcmp1_b32 s41, 8
    s_cbranch_scc0 K2_NFg5_100
    v_cvt_f64_f32 v[106:107], v94
    v_mov_b32 v94, 0
    ds_add_f64 v115, v[106:107] offset:512
    v_add_u32 v115, 1024, v115
K2_NFg5_100:
    s_bitcmp1_b32 s65, 8
    s_cbranch_scc0 K2_NFg5_101
    v_cvt_f64_f32 v[106:107], v95
    v_mov_b32 v95, 0
    ds_add_f64 v117, v[106:107] offset:512
    v_add_u32 v117, 1024, v117
K2_NFg5_101:
    v_pk_fma_f32 v[94:95], v[20:21], v[82:83], v[94:95]
    s_bitcmp1_b32 s41, 9
    s_cbranch_scc0 K2_NFg5_110
    v_cvt_f64_f32 v[106:107], v94
    v_mov_b32 v94, 0
    ds_add_f64 v115, v[106:107] offset:512
    v_add_u32 v115, 1024, v115
K2_NFg5_110:
    s_bitcmp1_b32 s65, 9
    s_cbranch_scc0 K2_NFg5_111
    v_cvt_f64_f32 v[106:107], v95
    v_mov_b32 v95, 0
    ds_add_f64 v117, v[106:107] offset:512
    v_add_u32 v117, 1024, v117
K2_NFg5_111:
    v_pk_fma_f32 v[94:95], v[22:23], v[84:85], v[94:95]
    s_bitcmp1_b32 s41, 10
    s_cbranch_scc0 K2_NFg5_120
    v_cvt_f64_f32 v[106:107], v94
    v_mov_b32 v94, 0
    ds_add_f64 v115, v[106:107] offset:512
    v_add_u32 v115, 1024, v115
K2_NFg5_120:
    s_bitcmp1_b32 s65, 10
    s_cbranch_scc0 K2_NFg5_121
    v_cvt_f64_f32 v[106:107], v95
    v_mov_b32 v95, 0
    ds_add_f64 v117, v[106:107] offset:512
    v_add_u32 v117, 1024, v117
K2_NFg5_121:
    s_branch K2_RTg5_10
K2_FLg5_13:
    v_pk_fma_f32 v[94:95], v[24:25], v[80:81], v[94:95]
    s_bitcmp1_b32 s41, 11
    s_cbranch_scc0 K2_NFg5_130
    v_cvt_f64_f32 v[106:107], v94
    v_mov_b32 v94, 0
    ds_add_f64 v115, v[106:107] offset:512
    v_add_u32 v115, 1024, v115
K2_NFg5_130:
    s_bitcmp1_b32 s65, 11
    s_cbranch_scc0 K2_NFg5_131
    v_cvt_f64_f32 v[106:107], v95
    v_mov_b32 v95, 0
    ds_add_f64 v117, v[106:107] offset:512
    v_add_u32 v117, 1024, v117
K2_NFg5_131:
    v_pk_fma_f32 v[94:95], v[26:27], v[82:83], v[94:95]
    s_bitcmp1_b32 s41, 12
    s_cbranch_scc0 K2_NFg5_140
    v_cvt_f64_f32 v[106:107], v94
    v_mov_b32 v94, 0
    ds_add_f64 v115, v[106:107] offset:512
    v_add_u32 v115, 1024, v115
K2_NFg5_140:
    s_bitcmp1_b32 s65, 12
    s_cbranch_scc0 K2_NFg5_141
    v_cvt_f64_f32 v[106:107], v95
    v_mov_b32 v95, 0
    ds_add_f64 v117, v[106:107] offset:512
    v_add_u32 v117, 1024, v117
K2_NFg5_141:
    v_pk_fma_f32 v[94:95], v[28:29], v[84:85], v[94:95]
    s_bitcmp1_b32 s41, 13
    s_cbranch_scc0 K2_NFg5_150
    v_cvt_f64_f32 v[106:107], v94
    v_mov_b32 v94, 0
    ds_add_f64 v115, v[106:107] offset:512
    v_add_u32 v115, 1024, v115
K2_NFg5_150:
    s_bitcmp1_b32 s65, 13
    s_cbranch_scc0 K2_NFg5_151
    v_cvt_f64_f32 v[106:107], v95
    v_mov_b32 v95, 0
    ds_add_f64 v117, v[106:107] offset:512
    v_add_u32 v117, 1024, v117
K2_NFg5_151:
    s_branch K2_RTg5_13
K2_BAD:
    v_mov_b32 v112, 0
    v_mov_b32 v113, 1
    ds_write_b32 v112, v113 offset:260
    s_branch K2_BADX
K2_BADM:
    s_mov_b32 s54, 1
    s_branch K2_BADMX
K2_REDO:
    s_waitcnt vmcnt(0) lgkmcnt(0)
    s_barrier
    s_mov_b32 s66, 1
    s_mov_b32 s68, 3
    s_branch K2_INIT
K2_RC:
    s_mov_b32 s8, s16
    s_or_b32 s9, s17, 0x1000000
    s_mov_b32 s10, 10032
    s_mov_b32 s11, 0x00020000
    s_lshl_b32 s35, s32, 12
    s_add_u32 s35, s35, 83968
    s_mov_b32 m0, s35
    s_mov_b32 s39, 0
    s_mov_b32 s42, 0x0f0f0f0f
    s_mov_b32 s43, 0xf0f0f0f0
    v_xor_b32 v79, v108, v109
    v_lshlrev_b32 v79, 4, v79
    v_add_u32 v73, 3072, v79
    v_add_u32 v75, 2048, v79
    v_add_u32 v77, 1024, v79
    v_xor_b32 v77, 128, v77
    v_xor_b32 v79, 128, v79
    s_mov_b32 s44, 328
    s_mov_b32 s63, 0x4e800000
    v_and_b32 v102, 3, v0
    v_lshlrev_b32 v103, 3, v108
    v_lshl_add_u32 v103, v102, 3, v103
    v_and_b32 v106, 8, v111
    v_mul_u32_u24 v106, 40, v106
    v_xor_b32 v103, v103, v106
    v_and_b32 v106, 4, v111
    v_mul_u32_u24 v106, 544, v106
    v_xor_b32 v103, v103, v106
    v_add_u32 v96, s35, v103
    v_xor_b32 v97, 128, v96
    v_add_u32 v103, v108, v102
    v_mov_b32 v101, 149504
    v_lshl_add_u32 v101, v103, 3, v101
    v_lshlrev_b32 v102, 4, v102
    v_lshlrev_b64 v[62:63], v102, s[60:61]
    v_lshrrev_b32 v103, 2, v1
    v_and_b32 v103, 6, v103
    v_bfe_u32 v102, v1, 1, 1
    v_or_b32 v103, v103, v102
    v_lshlrev_b32 v110, 4, v103
    v_add_u32 v110, 8192, v110
    s_and_b32 s45, s32, 3
    s_lshr_b32 s46, s32, 2
    s_lshl2_add_u32 s45, s45, 3
    s_sub_u32 s59, s45, s46
    v_mov_b64 v[58:59], 0
    v_mov_b64 v[60:61], 0
    v_and_b32 v103, 7, v1
    v_lshlrev_b32 v105, v103, 1
    s_mov_b32 s26, 2560000
    s_mov_b32 s27, 0x00020000
    s_lshl_b32 s45, s32, 4
    v_lshlrev_b32 v67, 2, v1
    v_xor_b32 v67, s45, v67
    s_lshl_b32 s45, s32, 8
    s_add_u32 s45, s45, 83968
    v_add_u32 v67, s45, v67
    v_mul_u32_u24 v68, 272, v109
    v_lshl_add_u32 v68, v108, 1, v68
    s_lshl_b32 s45, s32, 5
    s_lshr_b32 s46, s32, 3
    s_mul_i32 s46, s46, 8448
    s_add_u32 s45, s45, s46
    s_add_u32 s45, s45, 100352
    v_add_u32 v68, s45, v68
    v_lshrrev_b32 v69, 4, v0
    v_mul_u32_u24 v69, 272, v69
    v_lshl_add_u32 v69, v109, 4, v69
    v_add_u32 v69, 100352, v69
    s_and_b32 s45, s2, 7
    s_mul_i32 s45, s45, 2048
    s_add_u32 s45, s45, 7995392
    v_lshl_add_u32 v38, v1, 4, s45
    s_mov_b32 s46, 0xEA543210
    s_mov_b32 s47, 0xFBD9C876
    s_lshl_b32 s45, s32, 2
    s_lshr_b64 s[46:47], s[46:47], s45
    s_and_b32 s3, s46, 15
    s_mov_b32 s4, 0x9e37b5a7
    s_mov_b32 s5, 0x85ebca6b
    s_mov_b32 s6, 0xc2b3ae35
    s_mov_b32 s7, 0x27d5eb2f
    s_mov_b32 s20, 0x165767b1
    s_mov_b32 s21, 0xd3a3646d
    s_mov_b32 s22, 0xfd7146c5
    s_mov_b32 s23, 0xb55b4f09
    s_mov_b32 s28, 1
    s_and_b32 s64, s71, 0xffc00003
    s_lshl_b32 s65, s71, 12
    s_bfe_u32 s67, s71, 0x20014
    s_and_b32 s65, s65, 0xc00003
    s_or_b32 s65, s65, s67
    v_mov_b32 v40, s70
    v_mov_b32 v71, 0
    v_mov_b32 v30, 0
    v_mov_b32 v33, 0
    s_bfm_b64 exec, s34, 0
    v_mov_b32 v71, 28
    s_mov_b64 exec, -1
    v_mov_b32 v39, 4
    v_lshlrev_b32 v113, 2, v1
    v_and_b32 v44, 4, v111
    v_and_b32 v45, 8, v111
    v_add_u32 v44, 512, v44
    v_lshrrev_b32 v46, 3, v1
    v_add_u32 v46, 320, v46
    v_and_b32 v47, 1, v1
    v_lshlrev_b32 v48, 3, v1
    v_add_u32 v48, 31744, v48
    v_lshlrev_b32 v49, 4, v1
    v_add_u32 v49, 162624, v49
    v_mov_b64 v[92:93], 0
    v_mov_b32 v88, 1.0
    v_mov_b32 v89, 1.0
    v_mov_b64 v[94:95], 0
    v_mov_b32 v90, 1.0
    v_mov_b32 v91, 1.0
    v_mov_b32 v118, 0
    v_mov_b64 v[120:121], 0
    v_mov_b64 v[122:123], 0
    ds_write_b128 v66, v[120:123] offset:32768
    ds_write_b128 v66, v[120:123] offset:49152
    s_cmp_ge_u32 s32, 8
    s_cbranch_scc1 K2_I1
    v_add_u32 v117, 65536, v66
    ds_write_b128 v117, v[120:123]
K2_I1:
    s_mov_b32 s52, -1
    s_branch K2_PAIR
K2_SPLIT:
    s_cmp_ge_u32 s56, 0x1000000
    s_cselect_b32 s52, -1, s52
    s_waitcnt vmcnt(0) lgkmcnt(0)
    s_barrier
    s_branch K2_PAIR
K2_MORE:
    s_waitcnt vmcnt(0) lgkmcnt(0)
    s_barrier
    s_cmp_eq_u32 s52, 0
    s_cbranch_scc1 K2_NEXT
    s_cmp_lt_u32 s52, 4
    s_cbranch_scc1 K2_PAIR
    s_cmp_eq_u32 s50, 0
    s_cbranch_scc1 K2_FIN
K2_NEXT:
    s_mov_b32 s52, -1
    s_add_u32 s49, s49, 512
K2_PAIR:
    s_mov_b32 s28, 0
    s_add_u32 s52, s52, 1
    v_lshlrev_b32 v112, 4, v0
    v_mov_b64 v[120:121], 0
    v_mov_b64 v[122:123], 0
    ds_write_b128 v112, v[120:123]
    ds_write_b128 v112, v[120:123] offset:16384
    s_waitcnt lgkmcnt(0)
    s_barrier
    s_and_b32 s45, s32, 14
    s_cmp_lg_u32 s45, 10
    s_cbranch_scc1 K2_PT
    s_and_b32 s45, s32, 1
    s_lshl_b32 s45, s45, 6
    v_add_u32 v70, s45, v1
    v_mul_u32_u24 v64, 2048, v70
    v_xor_b32 v65, 64, v70
    v_mul_u32_u24 v65, 2048, v65
    s_mov_b32 s12, s16
    s_mov_b32 s13, s17
    s_mov_b32 s14, 7602176
    s_mov_b32 s15, 0x00020000
    buffer_load_dwordx2 v[10:11], v64, s[12:15], s29 offen sc1
    buffer_load_dwordx2 v[12:13], v65, s[12:15], s29 offen sc1
    s_mov_b32 s47, 0xf000f000
    s_waitcnt vmcnt(0)
    v_xor_b32 v2, s71, v10
    v_xor_b32 v3, s70, v11
    v_and_or_b32 v2, v2, s47, v3
    v_cmp_ne_u32 vcc, 0, v2
    v_xor_b32 v2, s71, v12
    v_xor_b32 v3, s70, v13
    v_and_or_b32 v2, v2, s47, v3
    v_cmp_ne_u32 s[40:41], 0, v2
    v_cndmask_b32 v10, v10, 0, vcc
    v_cndmask_b32 v12, v12, 0, s[40:41]
    v_bfe_u32 v2, v10, 16, 12
    v_bfe_u32 v6, v12, 16, 12
    v_add_u32 v3, 3, v2
    v_add_u32 v6, 3, v6
    v_lshrrev_b32 v3, 2, v3
    v_lshrrev_b32 v6, 2, v6
    v_lshl_or_b32 v4, v6, 16, v3
    v_and_b32 v5, 0xfff, v10
    v_mul_u32_u24 v7, 13312, v70
    v_add_u32_dpp v4, v4, v4 row_shr:1 row_mask:0xf bank_mask:0xf bound_ctrl:0
    v_lshl_add_u32 v5, v5, 2, v7
    v_cmp_lt_u32 vcc, 8, v3
    v_add_u32_dpp v4, v4, v4 row_shr:2 row_mask:0xf bank_mask:0xf bound_ctrl:0
    v_mov_b32 v8, 304
    v_mov_b32 v9, 1
    v_add_u32_dpp v4, v4, v4 row_shr:4 row_mask:0xf bank_mask:0xf bound_ctrl:0
    s_movk_i32 s50, 72
    s_movk_i32 s51, 84
    v_add_u32_dpp v4, v4, v4 row_shr:8 row_mask:0xf bank_mask:0xf bound_ctrl:0
    s_nop 1
    v_add_u32_dpp v4, v4, v4 row_bcast:15 row_mask:0xa bank_mask:0xf
    s_nop 1
    v_add_u32_dpp v4, v4, v4 row_bcast:31 row_mask:0xc bank_mask:0xf
    s_nop 0
    v_readlane_b32 s45, v4, 63
    v_and_b32 v4, 0xffff, v4
    v_sub_u32 v4, v4, v3
    s_lshr_b32 s47, s45, 16
    s_and_b32 s46, s45, 0xffff
    s_add_u32 s46, s46, s47
    s_bitcmp1_b32 s32, 0
    s_cselect_b32 s47, s47, 0
    s_sub_u32 s47, s47, s49
    v_add_u32 v4, s47, v4
    v_sub_u32 v6, 0, v4
    v_max_i32 v6, 0, v6
    v_add_u32 v4, v4, v6
    v_lshl_add_u32 v5, v6, 4, v5
    v_lshlrev_b32 v6, 2, v6
    v_sub_u32 v2, v2, v6
    v_lshlrev_b32 v4, 2, v4
K1_BLb:
    v_cmpx_lt_i32 vcc, 0, v2
    v_cmpx_gt_u32 vcc, 2048, v4
    s_cbranch_execz K1_BMb
    v_min_u32 v6, 4, v2
    v_add_u32 v6, v5, v6
    ds_write_b32 v4, v6 offset:30720
    v_add_u32 v4, 4, v4
    v_add_u32 v5, 16, v5
    v_add_u32 v2, -4, v2
    s_branch K1_BLb
K1_BMb:
    s_mov_b64 exec, 1
    s_add_u32 s47, s49, 512
    s_cmp_le_u32 s46, s47
    s_cbranch_scc1 K1_BNb
    v_mov_b32 v4, 0
    ds_write_b32 v4, v9 offset:256
K1_BNb:
    s_mov_b64 exec, -1
K2_PT:
    s_waitcnt lgkmcnt(0)
    s_barrier
    v_mov_b32 v40, s70
    s_and_b32 s64, s71, 0xffc00003
    s_lshl_b32 s65, s71, 12
    s_bfe_u32 s67, s71, 0x20014
    s_and_b32 s65, s65, 0xc00003
    s_or_b32 s65, s65, s67
    s_mov_b64 s[30:31], 0
    v_mov_b32 v32, 0
    s_cmp_lt_u32 s3, 8
    s_cbranch_scc1 K2_RECYb
    s_lshl_b32 s45, s3, 8
    v_lshl_add_u32 v112, v1, 2, s45
    v_mov_b32 v114, 0
    ds_read_b32 v30, v112 offset:28672
    ds_write_b32 v112, v114 offset:28672
    s_mov_b32 s45, 9437184
    s_mov_b32 s46, 11534336
    s_mov_b32 s51, 131072
    s_waitcnt lgkmcnt(1)
    v_and_b32 v32, 15, v30
    v_cmpx_ne_u32 s[30:31], 0, v30
    v_and_b32 v30, -16, v30
    s_cbranch_execz K2_LRb
    buffer_load_dwordx4 v[2:5], v30, s[16:19], s45 offen sc1
    v_lshlrev_b32 v33, 1, v30
    buffer_load_dwordx4 v[18:21], v33, s[16:19], s46 offen sc1
    buffer_load_dwordx4 v[22:25], v33, s[16:19], s46 offen offset:16 sc1
K2_RECPb:
    s_waitcnt vmcnt(0)
    v_xor_b32 v114, s65, v3
    v_xor_b32 v112, s64, v2
    v_and_b32 v114, 0xc00003, v114
    v_or_b32 v112, v114, v112
    v_dot2_u32_u16 v6, v18, s4, v40
    v_dot2_u32_u16 v6, v19, s5, v6
    v_dot2_u32_u16 v6, v20, s6, v6
    v_dot2_u32_u16 v6, v21, s7, v6
    v_dot2_u32_u16 v6, v22, s20, v6
    v_dot2_u32_u16 v6, v23, s21, v6
    v_dot2_u32_u16 v6, v24, s22, v6
    v_dot2_u32_u16 v6, v25, s23, v6
    v_alignbit_b32 v7, v6, v6, 20
    v_bitop3_b32 v112, v4, v6, v112 bitop3:0xbe
    v_lshlrev_b32 v6, 22, v6
    v_bitop3_b32 v112, v5, v7, v112 bitop3:0xbe
    v_xor_b32 v6, v6, v3
    v_and_b32 v6, 0xff000000, v6
    v_or_b32 v112, v6, v112
    v_and_b32 v112, 0xffc00003, v112
    v_cmp_ne_u32 vcc, 0, v112
    s_cbranch_vccnz K2_RECWb
K2_RECYb:
K2_LRb:
    s_mov_b64 exec, -1
    s_cmp_eq_u32 s52, 0
    s_cbranch_scc1 K2_PA
    s_sub_u32 s47, s52, 1
    s_cmp_eq_u32 s47, 1
    s_cselect_b64 vcc, -1, 0
    v_cndmask_b32 v2, v2, v3, vcc
    v_cndmask_b32 v18, v18, v20, vcc
    v_cndmask_b32 v19, v19, v21, vcc
    s_cmp_eq_u32 s47, 2
    s_cselect_b64 vcc, -1, 0
    v_cndmask_b32 v2, v2, v4, vcc
    v_cndmask_b32 v18, v18, v22, vcc
    v_cndmask_b32 v19, v19, v23, vcc
    s_cmp_eq_u32 s47, 3
    s_cselect_b64 vcc, -1, 0
    v_cndmask_b32 v2, v2, v5, vcc
    v_cndmask_b32 v18, v18, v24, vcc
    v_cndmask_b32 v19, v19, v25, vcc
    v_subrev_u32 v32, s47, v32
    v_min_i32 v32, 1, v32
    v_cmp_lt_i32 s[30:31], 0, v32
K2_PA:
    v_mov_b32 v39, 4
    v_lshlrev_b32 v113, 2, v1
    v_and_b32 v44, 4, v111
    v_and_b32 v45, 8, v111
    v_add_u32 v44, 512, v44
    v_lshrrev_b32 v46, 3, v1
    v_add_u32 v46, 320, v46
    v_and_b32 v47, 1, v1
    v_lshlrev_b32 v48, 3, v1
    v_add_u32 v48, 31744, v48
    v_lshlrev_b32 v49, 4, v1
    v_add_u32 v49, 162624, v49
    v_mov_b64 v[92:93], 0
    v_mov_b32 v88, 1.0
    v_mov_b32 v89, 1.0
    v_mov_b64 v[94:95], 0
    v_mov_b32 v90, 1.0
    v_mov_b32 v91, 1.0
    v_mov_b32 v118, 0
    s_cmp_eq_u64 s[30:31], 0
    s_cbranch_scc1 K2_C1s
    s_branch K2_CNT
K2_RECWb:
    s_sub_u32 s51, s51, 1
    s_cbranch_scc1 K2_RECTb
    s_sleep 2
    s_mov_b64 exec, vcc
    buffer_load_dwordx4 v[2:5], v30, s[16:19], s45 offen sc1
    v_lshlrev_b32 v33, 1, v30
    buffer_load_dwordx4 v[18:21], v33, s[16:19], s46 offen sc1
    buffer_load_dwordx4 v[22:25], v33, s[16:19], s46 offen offset:16 sc1
    s_mov_b64 exec, s[30:31]
    s_branch K2_RECPb
K2_RECTb:
    v_cndmask_b32 v32, v32, 0, vcc
    s_branch K2_RECYb
.section .rodata,"a"
.p2align 6
.amdhsa_kernel standalone__mpnn_edge_mlp__graph_kernel
  .amdhsa_next_free_vgpr 128
  .amdhsa_next_free_sgpr 72
  .amdhsa_accum_offset 128
  .amdhsa_group_segment_fixed_size 0
  .amdhsa_kernarg_size 72
  .amdhsa_user_sgpr_count 2
  .amdhsa_user_sgpr_kernarg_segment_ptr 1
  .amdhsa_system_sgpr_workgroup_id_x 1
.end_amdhsa_kernel
```
